```python
import torch

def _softmax(x, axis=-1):
    return torch.softmax(x, dim=axis)
def _gelu(x):
    return torch.nn.functional.gelu(x, approximate="tanh")
def _silu(x):
    return torch.nn.functional.silu(x)
def _sigmoid(x):
    return torch.sigmoid(x)
def _layernorm(x, axis=-1, eps=1e-5):
    m = x.mean(dim=axis, keepdim=True)
    v = x.var(dim=axis, keepdim=True, unbiased=False)
    return (x - m) / torch.sqrt(v + eps)
def _scatter_add(tgt, idx, src, axis=0):
    return tgt.clone().index_add_(axis, idx, src)
def _segment_sum(src, seg, n):
    out = torch.zeros((n,) + src.shape[1:], dtype=src.dtype)
    return out.index_add_(0, seg, src)
def _pad(x, pw):
    flat = tuple(v for pair in reversed(pw) for v in pair)
    return torch.nn.functional.pad(x, flat)

kernel_name = 'standalone__mixer_s_mlp__sampling'

def setup_inputs():

    _w = (lambda a: (lambda t: t.to(torch.bfloat16) if t.is_floating_point() else t)(torch.as_tensor(a)))
    B, S, D, F = 32, 32, 576, 4608
    return {
        "x":  _w((lambda *s: torch.randn(*s, dtype=torch.bfloat16) * 0.4)(B, S, D)),
        "w1": _w((lambda *s: torch.randn(*s, dtype=torch.bfloat16) * 3.2)(D, D) * (D ** -0.5)),
        "w2": _w((lambda *s: torch.randn(*s, dtype=torch.bfloat16) * 3.2)(D, D) * (D ** -0.5)),
        "w3": _w((lambda *s: torch.randn(*s, dtype=torch.bfloat16) * 3.2)(D, F) * (D ** -0.5)),
        "w4": _w((lambda *s: torch.randn(*s, dtype=torch.bfloat16) * 0.8)(F, D) * (F ** -0.5)),
    }

def reference(x, w1, w2, w3, w4):
    B, S, D = x.shape
    h = _gelu(_layernorm(x, axis=-1) @ w1)
    c = D // 4
    g0 = _pad(h[:, :, 0*c:1*c], ((0, 0), (1, 0), (0, 0)))[:, :S, :]
    g1 = _pad(h[:, :, 1*c:2*c], ((0, 0), (0, 1), (0, 0)))[:, 1:, :]
    g2 = _pad(h[:, :, 2*c:3*c], ((0, 0), (2, 0), (0, 0)))[:, :S, :]
    g3 = _pad(h[:, :, 3*c:   ], ((0, 0), (0, 2), (0, 0)))[:, 2:, :]
    hs = torch.concatenate([g0, g1, g2, g3], axis=-1) @ w2
    x1 = x + hs
    h2 = _gelu(_layernorm(x1, axis=-1) @ w3) @ w4
    return x1 + h2
```

```asm
; @launch grid=(256,1,1) block=(512,1,1) lds=163840
.amdgcn_target "amdgcn-amd-amdhsa--gfx950"
.text
.globl standalone__mixer_s_mlp__sampling_kernel
.p2align 8
.type standalone__mixer_s_mlp__sampling_kernel,@function
standalone__mixer_s_mlp__sampling_kernel:
    s_cmp_ge_u32 s2, 256
    s_cbranch_scc1 L_end
    s_load_dwordx16 s[4:19], s[0:1], 0
    s_getpc_b64 s[66:67]
L_pc:
    v_and_b32 v1, 63, v0
    v_lshrrev_b32 v2, 6, v0
    s_and_b32 s58, s2, 7
    s_lshr_b32 s59, s2, 3
    v_readfirstlane_b32 s81, v2
    s_lshl_b32 s64, s59, 11
    v_lshlrev_b32 v12, 2, v0
    v_add_u32 v12, s64, v12
    v_min_u32 v12, L_code_end-L_pc-4, v12
    global_load_dword v7, v12, s[66:67]
    v_lshlrev_b32 v4, 4, v1
    v_lshrrev_b32 v2, 4, v1
    v_and_b32 v3, 15, v1
    s_and_b32 s57, s81, 3
    s_lshl_b32 s83, s57, 10
    v_mov_b32 v9, 0
    s_add_u32 s48, s66, L_tab-L_pc
    s_addc_u32 s49, s67, 0
    s_lshl_b32 s50, s81, 2
    s_add_u32 s50, s50, 162816
    v_mov_b32 v11, 162816
    v_mov_b32 v10, s50
    ds_write_b32 v10, v9
    ds_write_b32 v10, v9 offset:32
    s_lshr_b32 s62, s59, 2
    s_and_b32 s63, s59, 3
    s_cmp_ge_u32 s59, 9
    s_cselect_b32 s60, 1, 0
    s_mul_i32 s64, s60, 9
    s_sub_u32 s61, s59, s64
    s_cmp_ge_u32 s59, 18
    s_cbranch_scc1 L_repack
    s_cmp_ge_u32 s81, 4
    s_cbranch_scc1 L_h_act
    s_lshl_b32 s69, s58, 3
    s_lshl_b32 s64, s60, 2
    s_add_u32 s69, s69, s64
    s_add_u32 s69, s69, s57
    v_lshlrev_b32 v12, 6, v1
    s_lshl_b32 s64, s59, 2
    s_add_u32 s64, s64, s57
    s_lshl_b32 s70, s64, 12
    s_add_u32 s70, s70, 110592
    s_waitcnt lgkmcnt(0)
    s_load_dword s3, s[18:19], 0
    s_barrier
    s_mov_b32 s24, s6
    s_mov_b32 s25, s7
    s_mov_b32 s26, 663552
    s_mov_b32 s27, 0x20000
    buffer_load_dword v7, v12, s[24:27], s70 offen
    s_mov_b32 s20, s4
    s_mov_b32 s21, s5
    s_mov_b32 s22, 1179648
    s_mov_b32 s23, 0x20000
    s_mov_b32 s32, s10
    s_mov_b32 s33, s11
    s_mov_b32 s34, 5308416
    s_mov_b32 s35, 0x20000
    s_mov_b32 s36, s12
    s_mov_b32 s37, s13
    s_mov_b32 s38, 5308416
    s_mov_b32 s39, 0x20000
    s_mov_b32 s84, 0
    s_mov_b32 s85, 4096
    s_mov_b32 s86, 8192
    s_mov_b32 s87, 12288
    s_mov_b32 s88, 16384
    s_mov_b32 s28, s8
    s_mov_b32 s29, s9
    s_mov_b32 s30, 663552
    s_mov_b32 s31, 0x20000
    s_mov_b32 s40, s14
    s_mov_b32 s41, s15
    s_mov_b32 s42, 1179648
    s_mov_b32 s43, 0x20000
    s_mov_b32 s44, s18
    s_mov_b32 s45, s19
    s_mov_b32 s46, 268435456
    s_mov_b32 s47, 0x20000
    s_add_u32 s52, s18, 917504
    s_addc_u32 s53, s19, 0
    s_mov_b32 s54, 26345472
    s_mov_b32 s55, 0x20000
    v_add_u32 v5, 0x10000, v4
    v_add_u32 v6, 0x20000, v4
    v_min_u32 v8, 17, v1
    v_lshlrev_b32 v8, 7, v8
    s_waitcnt lgkmcnt(0)
    s_waitcnt lgkmcnt(0)
    s_add_u32 s3, s3, 0x10000001
    s_and_b32 s82, s3, 0xff
    s_mul_i32 s56, s3, 0x9e3779b1
    s_xor_b32 s56, s56, 0x5bd1e995
    s_getreg_b32 s65, hwreg(HW_REG_XCC_ID)
    s_and_b32 s65, s65, 15
    s_add_u32 s80, s65, s56
    v_mov_b32 v80, 0x3f803f80
    v_mov_b32 v81, 0x3f803f80
    v_mov_b32 v82, 0x3f803f80
    v_mov_b32 v83, 0x3f803f80
    s_and_b32 s68, s57, 1
    s_lshr_b32 s67, s57, 1
    v_lshlrev_b32 v12, 7, v3
    v_lshrrev_b32 v13, 1, v3
    s_xor_b32 s64, s57, 0
    s_lshl_b32 s64, s64, 11
    s_add_u32 s64, s64, 73728
    v_add_u32 v14, 0, v2
    v_xor_b32 v14, v14, v13
    v_lshl_add_u32 v14, v14, 4, v12
    v_add_u32 v100, s64, v14
    v_add_u32 v14, 4, v2
    v_xor_b32 v14, v14, v13
    v_lshl_add_u32 v14, v14, 4, v12
    v_add_u32 v101, s64, v14
    s_xor_b32 s64, s57, 1
    s_lshl_b32 s64, s64, 11
    s_add_u32 s64, s64, 73728
    v_add_u32 v14, 0, v2
    v_xor_b32 v14, v14, v13
    v_lshl_add_u32 v14, v14, 4, v12
    v_add_u32 v102, s64, v14
    v_add_u32 v14, 4, v2
    v_xor_b32 v14, v14, v13
    v_lshl_add_u32 v14, v14, 4, v12
    v_add_u32 v103, s64, v14
    v_lshrrev_b32 v12, 2, v1
    v_lshlrev_b32 v12, 7, v12
    v_and_b32 v13, 3, v1
    v_lshl_add_u32 v12, v13, 3, v12
    v_bfe_u32 v13, v1, 3, 2
    s_xor_b32 s64, s67, 0
    s_lshl_b32 s65, s68, 1
    s_add_u32 s64, s64, s65
    v_xor_b32 v14, s64, v13
    v_lshl_add_u32 v104, v14, 5, v12
    v_add_u32 v105, 36864, v104
    s_xor_b32 s64, s67, 1
    s_lshl_b32 s65, s68, 1
    s_add_u32 s64, s64, s65
    v_xor_b32 v14, s64, v13
    v_lshl_add_u32 v106, v14, 5, v12
    v_add_u32 v107, 36864, v106
    s_lshl_b32 s64, s57, 11
    s_lshl_b32 s65, s61, 13
    s_add_u32 s64, s64, s65
    s_add_u32 s64, s64, 73728
    v_lshlrev_b32 v12, 7, v3
    v_add_u32 v12, s64, v12
    v_and_b32 v13, 1, v2
    v_lshl_add_u32 v12, v13, 3, v12
    v_lshrrev_b32 v13, 1, v3
    v_lshrrev_b32 v14, 1, v2
    v_xor_b32 v13, v13, v14
    v_xor_b32 v14, 0, v13
    v_lshl_add_u32 v16, v14, 4, v12
    v_xor_b32 v14, 2, v13
    v_lshl_add_u32 v17, v14, 4, v12
    v_xor_b32 v14, 4, v13
    v_lshl_add_u32 v18, v14, 4, v12
    v_xor_b32 v14, 6, v13
    v_lshl_add_u32 v19, v14, 4, v12
    s_mul_i32 s64, s69, 18
    s_lshl_b32 s65, s61, 1
    s_add_u32 s64, s64, s65
    s_lshl_b32 s77, s64, 10
    s_lshl_b32 s64, s68, 10
    s_add_u32 s72, s77, s64
    s_mul_i32 s64, s68, 36864
    s_sub_u32 s73, s72, s64
    s_add_u32 s73, s73, 18432
    s_lshr_b32 s64, s69, 1
    s_lshl_b32 s76, s64, 12
    s_mul_i32 s64, s68, 9
    s_add_u32 s64, s64, s61
    s_lshl_b32 s64, s64, 7
    s_add_u32 s75, s64, s76
    s_lshl_b32 s64, s61, 1
    s_add_u32 s64, s64, s68
    s_lshl_b32 s64, s64, 7
    s_add_u32 s71, s64, s76
    s_add_u32 s71, s71, 393216
    s_mul_i32 s74, s69, 18432
    s_lshl_b32 s64, s61, 2
    s_lshl_b32 s65, s68, 1
    s_add_u32 s64, s64, s65
    s_add_u32 s64, s64, 0
    s_mul_i32 s64, s64, 7282
    s_lshr_b32 s64, s64, 16
    s_lshr_b32 s65, s64, 1
    s_add_u32 s65, s65, 1
    s_sub_u32 s66, 0, s65
    s_bitcmp1_b32 s64, 0
    s_cselect_b32 s65, s66, s65
    v_subrev_u32 v12, s65, v3
    v_and_b32 v13, 15, v12
    v_lshl_add_u32 v13, v2, 4, v13
    v_lshlrev_b32 v108, 2, v13
    v_cmp_gt_u32 s[92:93], 16, v12
    s_xor_b32 s64, s68, 0
    s_lshl_b32 s64, s64, 4
    v_add_u32 v13, s64, v12
    v_cmp_gt_u32 s[94:95], 32, v13
    s_xor_b32 s64, s68, 1
    s_lshl_b32 s64, s64, 4
    v_add_u32 v13, s64, v12
    v_cmp_gt_u32 s[100:101], 32, v13
    s_lshl_b32 s64, s61, 2
    s_lshl_b32 s65, s68, 1
    s_add_u32 s64, s64, s65
    s_add_u32 s64, s64, 1
    s_mul_i32 s64, s64, 7282
    s_lshr_b32 s64, s64, 16
    s_lshr_b32 s65, s64, 1
    s_add_u32 s65, s65, 1
    s_sub_u32 s66, 0, s65
    s_bitcmp1_b32 s64, 0
    s_cselect_b32 s65, s66, s65
    v_subrev_u32 v12, s65, v3
    v_and_b32 v13, 15, v12
    v_lshl_add_u32 v13, v2, 4, v13
    v_lshlrev_b32 v109, 2, v13
    v_cmp_gt_u32 s[96:97], 16, v12
    s_xor_b32 s64, s68, 0
    s_lshl_b32 s64, s64, 4
    v_add_u32 v13, s64, v12
    v_cmp_gt_u32 s[98:99], 32, v13
    s_xor_b32 s64, s68, 1
    s_lshl_b32 s64, s64, 4
    v_add_u32 v13, s64, v12
    v_cmp_gt_u32 s[78:79], 32, v13
    s_mov_b32 s89, 0
    s_nop 2
    s_branch Lw_2
Lw_1:
Lw_2:
    ds_read_b128 v[20:23], v11 offset:48
    s_add_u32 s89, s89, 1
    s_cmp_gt_u32 s89, 1000000
    s_cbranch_scc1 L_end
    s_waitcnt lgkmcnt(0)
    v_min_u32 v20, v20, v21
    v_min3_u32 v20, v20, v22, v23
    s_nop 0
    v_readfirstlane_b32 s64, v20
    s_nop 0
    s_cmp_lt_u32 s64, 4
    s_nop 1
    s_cbranch_scc1 Lw_1
    ds_read_b128 v[112:115], v100 offset:0
    ds_read_b128 v[184:187], v102 offset:0
    ds_read_b64_tr_b16 v[24:25], v104 offset:0
    ds_read_b64_tr_b16 v[26:27], v104 offset:2048
    ds_read_b64_tr_b16 v[28:29], v106 offset:0
    ds_read_b64_tr_b16 v[30:31], v106 offset:2048
    ds_read_b128 v[116:119], v101 offset:0
    ds_read_b128 v[188:191], v103 offset:0
    ds_read_b64_tr_b16 v[32:33], v104 offset:4096
    ds_read_b64_tr_b16 v[34:35], v104 offset:6144
    ds_read_b128 v[20:23], v11 offset:48
    ds_read_b64_tr_b16 v[36:37], v106 offset:4096
    ds_read_b64_tr_b16 v[38:39], v106 offset:6144
    s_waitcnt lgkmcnt(9)
    v_mfma_f32_16x16x32_bf16 v[48:51], v[24:27], v[112:115], 0
    s_waitcnt lgkmcnt(2)
    v_min_u32 v20, v20, v21
    v_min3_u32 v20, v20, v22, v23
    s_nop 0
    v_readfirstlane_b32 s64, v20
    s_nop 0
    s_cmp_ge_u32 s64, 8
    s_cbranch_scc0 Ls_s3
Ls_r3:
    ds_read_b128 v[120:123], v100 offset:8192
    ds_read_b128 v[192:195], v102 offset:8192
    ds_read_b64_tr_b16 v[40:41], v104 offset:8192
    ds_read_b128 v[124:127], v101 offset:8192
    ds_read_b128 v[196:199], v103 offset:8192
    v_mfma_f32_16x16x32_bf16 v[52:55], v[24:27], v[184:187], 0
    ds_read_b64_tr_b16 v[42:43], v104 offset:10240
    v_mfma_f32_16x16x32_bf16 v[64:67], v[24:27], v[80:83], 0
    v_mfma_f32_16x16x32_bf16 v[72:75], v[80:83], v[112:115], 0
    v_mfma_f32_16x16x32_bf16 v[76:79], v[112:115], v[112:115], 0
    v_mfma_f32_16x16x32_bf16 v[72:75], v[80:83], v[116:119], v[72:75]
    v_mfma_f32_16x16x32_bf16 v[76:79], v[116:119], v[116:119], v[76:79]
    v_mfma_f32_16x16x32_bf16 v[56:59], v[28:31], v[112:115], 0
    ds_read_b64_tr_b16 v[44:45], v106 offset:8192
    v_mfma_f32_16x16x32_bf16 v[60:63], v[28:31], v[184:187], 0
    ds_read_b64_tr_b16 v[46:47], v106 offset:10240
    s_waitcnt lgkmcnt(7)
    v_mfma_f32_16x16x32_bf16 v[72:75], v[80:83], v[120:123], v[72:75]
    v_mfma_f32_16x16x32_bf16 v[76:79], v[120:123], v[120:123], v[76:79]
    s_waitcnt lgkmcnt(4)
    v_mfma_f32_16x16x32_bf16 v[72:75], v[80:83], v[124:127], v[72:75]
    v_mfma_f32_16x16x32_bf16 v[76:79], v[124:127], v[124:127], v[76:79]
    v_mfma_f32_16x16x32_bf16 v[48:51], v[32:35], v[116:119], v[48:51]
    ds_read_b64_tr_b16 v[24:25], v104 offset:12288
    v_mfma_f32_16x16x32_bf16 v[52:55], v[32:35], v[188:191], v[52:55]
    ds_read_b64_tr_b16 v[26:27], v104 offset:14336
    ds_read_b128 v[20:23], v11 offset:48
    v_mfma_f32_16x16x32_bf16 v[64:67], v[32:35], v[80:83], v[64:67]
    v_mfma_f32_16x16x32_bf16 v[56:59], v[36:39], v[116:119], v[56:59]
    ds_read_b64_tr_b16 v[28:29], v106 offset:12288
    v_mfma_f32_16x16x32_bf16 v[60:63], v[36:39], v[188:191], v[60:63]
    ds_read_b64_tr_b16 v[30:31], v106 offset:14336
    s_waitcnt lgkmcnt(7)
    v_mfma_f32_16x16x32_bf16 v[48:51], v[40:43], v[120:123], v[48:51]
    s_waitcnt lgkmcnt(2)
    v_min_u32 v20, v20, v21
    v_min3_u32 v20, v20, v22, v23
    s_nop 0
    v_readfirstlane_b32 s64, v20
    s_nop 0
    s_cmp_ge_u32 s64, 14
    s_cbranch_scc0 Ls_s4
Ls_r4:
    ds_read_b128 v[128:131], v100 offset:16384
    ds_read_b128 v[200:203], v102 offset:16384
    ds_read_b64_tr_b16 v[32:33], v104 offset:16384
    ds_read_b128 v[132:135], v101 offset:16384
    ds_read_b128 v[204:207], v103 offset:16384
    v_mfma_f32_16x16x32_bf16 v[52:55], v[40:43], v[192:195], v[52:55]
    ds_read_b64_tr_b16 v[34:35], v104 offset:18432
    v_mfma_f32_16x16x32_bf16 v[64:67], v[40:43], v[80:83], v[64:67]
    ds_read_b128 v[136:139], v100 offset:24576
    ds_read_b128 v[208:211], v102 offset:24576
    s_waitcnt lgkmcnt(7)
    v_mfma_f32_16x16x32_bf16 v[72:75], v[80:83], v[128:131], v[72:75]
    ds_read_b128 v[140:143], v101 offset:24576
    ds_read_b128 v[212:215], v103 offset:24576
    v_mfma_f32_16x16x32_bf16 v[76:79], v[128:131], v[128:131], v[76:79]
    s_waitcnt lgkmcnt(6)
    v_mfma_f32_16x16x32_bf16 v[72:75], v[80:83], v[132:135], v[72:75]
    v_mfma_f32_16x16x32_bf16 v[76:79], v[132:135], v[132:135], v[76:79]
    v_mfma_f32_16x16x32_bf16 v[56:59], v[44:47], v[120:123], v[56:59]
    ds_read_b64_tr_b16 v[36:37], v106 offset:16384
    v_mfma_f32_16x16x32_bf16 v[60:63], v[44:47], v[192:195], v[60:63]
    ds_read_b64_tr_b16 v[38:39], v106 offset:18432
    s_waitcnt lgkmcnt(5)
    v_mfma_f32_16x16x32_bf16 v[72:75], v[80:83], v[136:139], v[72:75]
    v_mfma_f32_16x16x32_bf16 v[76:79], v[136:139], v[136:139], v[76:79]
    s_waitcnt lgkmcnt(3)
    v_mfma_f32_16x16x32_bf16 v[72:75], v[80:83], v[140:143], v[72:75]
    v_mfma_f32_16x16x32_bf16 v[76:79], v[140:143], v[140:143], v[76:79]
    v_mfma_f32_16x16x32_bf16 v[48:51], v[24:27], v[124:127], v[48:51]
    ds_read_b64_tr_b16 v[40:41], v104 offset:20480
    v_mfma_f32_16x16x32_bf16 v[52:55], v[24:27], v[196:199], v[52:55]
    ds_read_b64_tr_b16 v[42:43], v104 offset:22528
    ds_read_b128 v[20:23], v11 offset:48
    v_mfma_f32_16x16x32_bf16 v[64:67], v[24:27], v[80:83], v[64:67]
    v_mfma_f32_16x16x32_bf16 v[56:59], v[28:31], v[124:127], v[56:59]
    ds_read_b64_tr_b16 v[44:45], v106 offset:20480
    v_mfma_f32_16x16x32_bf16 v[60:63], v[28:31], v[196:199], v[60:63]
    ds_read_b64_tr_b16 v[46:47], v106 offset:22528
    v_mfma_f32_16x16x32_bf16 v[48:51], v[32:35], v[128:131], v[48:51]
    s_waitcnt lgkmcnt(2)
    v_min_u32 v20, v20, v21
    v_min3_u32 v20, v20, v22, v23
    s_nop 0
    v_readfirstlane_b32 s64, v20
    s_nop 0
    s_cmp_ge_u32 s64, 20
    s_cbranch_scc0 Ls_s5
Ls_r5:
    ds_read_b64_tr_b16 v[24:25], v104 offset:24576
    ds_read_b128 v[144:147], v100 offset:32768
    ds_read_b128 v[216:219], v102 offset:32768
    v_mfma_f32_16x16x32_bf16 v[52:55], v[32:35], v[200:203], v[52:55]
    ds_read_b64_tr_b16 v[26:27], v104 offset:26624
    v_mfma_f32_16x16x32_bf16 v[64:67], v[32:35], v[80:83], v[64:67]
    ds_read_b128 v[148:151], v101 offset:32768
    ds_read_b128 v[220:223], v103 offset:32768
    s_waitcnt lgkmcnt(4)
    v_mfma_f32_16x16x32_bf16 v[72:75], v[80:83], v[144:147], v[72:75]
    ds_read_b128 v[152:155], v100 offset:40960
    ds_read_b128 v[224:227], v102 offset:40960
    ds_read_b128 v[156:159], v101 offset:40960
    ds_read_b128 v[228:231], v103 offset:40960
    v_mfma_f32_16x16x32_bf16 v[76:79], v[144:147], v[144:147], v[76:79]
    s_waitcnt lgkmcnt(5)
    v_mfma_f32_16x16x32_bf16 v[72:75], v[80:83], v[148:151], v[72:75]
    v_mfma_f32_16x16x32_bf16 v[76:79], v[148:151], v[148:151], v[76:79]
    v_mfma_f32_16x16x32_bf16 v[56:59], v[36:39], v[128:131], v[56:59]
    ds_read_b64_tr_b16 v[28:29], v106 offset:24576
    v_mfma_f32_16x16x32_bf16 v[60:63], v[36:39], v[200:203], v[60:63]
    ds_read_b64_tr_b16 v[30:31], v106 offset:26624
    s_waitcnt lgkmcnt(5)
    v_mfma_f32_16x16x32_bf16 v[72:75], v[80:83], v[152:155], v[72:75]
    v_mfma_f32_16x16x32_bf16 v[76:79], v[152:155], v[152:155], v[76:79]
    s_waitcnt lgkmcnt(3)
    v_mfma_f32_16x16x32_bf16 v[72:75], v[80:83], v[156:159], v[72:75]
    v_mfma_f32_16x16x32_bf16 v[76:79], v[156:159], v[156:159], v[76:79]
    v_mfma_f32_16x16x32_bf16 v[48:51], v[40:43], v[132:135], v[48:51]
    ds_read_b64_tr_b16 v[32:33], v104 offset:28672
    v_mfma_f32_16x16x32_bf16 v[52:55], v[40:43], v[204:207], v[52:55]
    ds_read_b64_tr_b16 v[34:35], v104 offset:30720
    ds_read_b128 v[20:23], v11 offset:48
    v_mfma_f32_16x16x32_bf16 v[64:67], v[40:43], v[80:83], v[64:67]
    v_mfma_f32_16x16x32_bf16 v[56:59], v[44:47], v[132:135], v[56:59]
    ds_read_b64_tr_b16 v[36:37], v106 offset:28672
    v_mfma_f32_16x16x32_bf16 v[60:63], v[44:47], v[204:207], v[60:63]
    ds_read_b64_tr_b16 v[38:39], v106 offset:30720
    v_mfma_f32_16x16x32_bf16 v[48:51], v[24:27], v[136:139], v[48:51]
    s_waitcnt lgkmcnt(2)
    v_min_u32 v20, v20, v21
    v_min3_u32 v20, v20, v22, v23
    s_nop 0
    v_readfirstlane_b32 s64, v20
    s_nop 0
    s_cmp_ge_u32 s64, 26
    s_cbranch_scc0 Ls_s6
Ls_r6:
    ds_read_b64_tr_b16 v[40:41], v104 offset:32768
    ds_read_b128 v[160:163], v100 offset:49152
    ds_read_b128 v[232:235], v102 offset:49152
    v_mfma_f32_16x16x32_bf16 v[52:55], v[24:27], v[208:211], v[52:55]
    ds_read_b64_tr_b16 v[42:43], v104 offset:34816
    v_mfma_f32_16x16x32_bf16 v[64:67], v[24:27], v[80:83], v[64:67]
    ds_read_b128 v[164:167], v101 offset:49152
    ds_read_b128 v[236:239], v103 offset:49152
    s_waitcnt lgkmcnt(4)
    v_mfma_f32_16x16x32_bf16 v[72:75], v[80:83], v[160:163], v[72:75]
    ds_read_b128 v[168:171], v100 offset:57344
    ds_read_b128 v[240:243], v102 offset:57344
    ds_read_b128 v[172:175], v101 offset:57344
    ds_read_b128 v[244:247], v103 offset:57344
    v_mfma_f32_16x16x32_bf16 v[76:79], v[160:163], v[160:163], v[76:79]
    s_waitcnt lgkmcnt(5)
    v_mfma_f32_16x16x32_bf16 v[72:75], v[80:83], v[164:167], v[72:75]
    v_mfma_f32_16x16x32_bf16 v[76:79], v[164:167], v[164:167], v[76:79]
    v_mfma_f32_16x16x32_bf16 v[56:59], v[28:31], v[136:139], v[56:59]
    ds_read_b64_tr_b16 v[44:45], v106 offset:32768
    v_mfma_f32_16x16x32_bf16 v[60:63], v[28:31], v[208:211], v[60:63]
    ds_read_b64_tr_b16 v[46:47], v106 offset:34816
    s_waitcnt lgkmcnt(5)
    v_mfma_f32_16x16x32_bf16 v[72:75], v[80:83], v[168:171], v[72:75]
    v_mfma_f32_16x16x32_bf16 v[76:79], v[168:171], v[168:171], v[76:79]
    s_waitcnt lgkmcnt(3)
    v_mfma_f32_16x16x32_bf16 v[72:75], v[80:83], v[172:175], v[72:75]
    v_mfma_f32_16x16x32_bf16 v[76:79], v[172:175], v[172:175], v[76:79]
    v_mfma_f32_16x16x32_bf16 v[48:51], v[32:35], v[140:143], v[48:51]
    ds_read_b64_tr_b16 v[24:25], v105 offset:0
    v_mfma_f32_16x16x32_bf16 v[52:55], v[32:35], v[212:215], v[52:55]
    ds_read_b64_tr_b16 v[26:27], v105 offset:2048
    ds_read_b128 v[20:23], v11 offset:48
    v_mfma_f32_16x16x32_bf16 v[64:67], v[32:35], v[80:83], v[64:67]
    v_mfma_f32_16x16x32_bf16 v[56:59], v[36:39], v[140:143], v[56:59]
    ds_read_b64_tr_b16 v[28:29], v107 offset:0
    v_mfma_f32_16x16x32_bf16 v[60:63], v[36:39], v[212:215], v[60:63]
    ds_read_b64_tr_b16 v[30:31], v107 offset:2048
    v_mfma_f32_16x16x32_bf16 v[48:51], v[40:43], v[144:147], v[48:51]
    s_waitcnt lgkmcnt(2)
    v_min_u32 v20, v20, v21
    v_min3_u32 v20, v20, v22, v23
    s_nop 0
    v_readfirstlane_b32 s64, v20
    s_nop 0
    s_cmp_ge_u32 s64, 30
    s_cbranch_scc0 Ls_s7
Ls_r7:
    ds_read_b64_tr_b16 v[32:33], v105 offset:4096
    v_add_u32 v0, 65536, v100
    ds_read_b128 v[176:179], v0
    v_add_u32 v0, 65536, v102
    ds_read_b128 v[248:251], v0
    v_mfma_f32_16x16x32_bf16 v[52:55], v[40:43], v[216:219], v[52:55]
    ds_read_b64_tr_b16 v[34:35], v105 offset:6144
    v_mfma_f32_16x16x32_bf16 v[64:67], v[40:43], v[80:83], v[64:67]
    v_add_u32 v0, 65536, v101
    ds_read_b128 v[180:183], v0
    v_add_u32 v0, 65536, v103
    ds_read_b128 v[252:255], v0
    s_waitcnt lgkmcnt(4)
    v_mfma_f32_16x16x32_bf16 v[72:75], v[80:83], v[176:179], v[72:75]
    v_mfma_f32_16x16x32_bf16 v[76:79], v[176:179], v[176:179], v[76:79]
    s_waitcnt lgkmcnt(1)
    v_mfma_f32_16x16x32_bf16 v[72:75], v[80:83], v[180:183], v[72:75]
    v_mfma_f32_16x16x32_bf16 v[76:79], v[180:183], v[180:183], v[76:79]
    ds_read_b64 v[84:85], v16
    ds_read_b64 v[86:87], v17
    ds_read_b64 v[88:89], v18
    ds_read_b64 v[90:91], v19
    v_mfma_f32_16x16x32_bf16 v[56:59], v[44:47], v[144:147], v[56:59]
    ds_read_b64_tr_b16 v[36:37], v107 offset:4096
    v_and_b32 v12, 3, v3
    v_mfma_f32_16x16x32_bf16 v[60:63], v[44:47], v[216:219], v[60:63]
    ds_read_b64_tr_b16 v[38:39], v107 offset:6144
    s_waitcnt lgkmcnt(2)
    s_add_u32 m0, s50, 0
    v_mov_b32 v0, 4
    s_mov_b64 exec, 1
    global_load_lds_dword v0, s[48:49]
    s_mov_b64 exec, -1
    v_mfma_f32_16x16x32_bf16 v[48:51], v[24:27], v[148:151], v[48:51]
    ds_read_b64_tr_b16 v[40:41], v105 offset:8192
    v_cmp_eq_u32 vcc, 1, v12
    v_mfma_f32_16x16x32_bf16 v[52:55], v[24:27], v[220:223], v[52:55]
    ds_read_b64_tr_b16 v[42:43], v105 offset:10240
    ds_read_b128 v[20:23], v11 offset:48
    v_mfma_f32_16x16x32_bf16 v[64:67], v[24:27], v[80:83], v[64:67]
    v_cndmask_b32 v76, v76, v77, vcc
    v_mfma_f32_16x16x32_bf16 v[56:59], v[28:31], v[148:151], v[56:59]
    ds_read_b64_tr_b16 v[44:45], v107 offset:8192
    v_cmp_eq_u32 vcc, 2, v12
    v_mfma_f32_16x16x32_bf16 v[60:63], v[28:31], v[220:223], v[60:63]
    ds_read_b64_tr_b16 v[46:47], v107 offset:10240
    v_mfma_f32_16x16x32_bf16 v[48:51], v[32:35], v[152:155], v[48:51]
    s_waitcnt lgkmcnt(2)
    v_min_u32 v20, v20, v21
    v_min3_u32 v20, v20, v22, v23
    s_nop 0
    v_readfirstlane_b32 s64, v20
    s_nop 0
    s_cmp_ge_u32 s64, 33
    s_cbranch_scc0 Ls_s8
Ls_r8:
    ds_read_b64_tr_b16 v[24:25], v105 offset:12288
    v_cndmask_b32 v76, v76, v78, vcc
    v_mfma_f32_16x16x32_bf16 v[52:55], v[32:35], v[224:227], v[52:55]
    ds_read_b64_tr_b16 v[26:27], v105 offset:14336
    v_mfma_f32_16x16x32_bf16 v[64:67], v[32:35], v[80:83], v[64:67]
    v_cmp_eq_u32 vcc, 3, v12
    v_mfma_f32_16x16x32_bf16 v[56:59], v[36:39], v[152:155], v[56:59]
    ds_read_b64_tr_b16 v[28:29], v107 offset:12288
    v_cndmask_b32 v76, v76, v79, vcc
    v_mfma_f32_16x16x32_bf16 v[60:63], v[36:39], v[224:227], v[60:63]
    ds_read_b64_tr_b16 v[30:31], v107 offset:14336
    v_mfma_f32_16x16x32_bf16 v[48:51], v[40:43], v[156:159], v[48:51]
    ds_read_b64_tr_b16 v[32:33], v105 offset:16384
    v_lshrrev_b32 v12, 2, v3
    v_mfma_f32_16x16x32_bf16 v[52:55], v[40:43], v[228:231], v[52:55]
    ds_read_b64_tr_b16 v[34:35], v105 offset:18432
    v_mfma_f32_16x16x32_bf16 v[64:67], v[40:43], v[80:83], v[64:67]
    v_cmp_eq_u32 vcc, v12, v2
    s_waitcnt lgkmcnt(6)
    v_mfma_f32_16x16x32_bf16 v[56:59], v[44:47], v[156:159], v[56:59]
    ds_read_b64_tr_b16 v[36:37], v107 offset:16384
    v_cndmask_b32 v76, 0, v76, vcc
    v_mfma_f32_16x16x32_bf16 v[60:63], v[44:47], v[228:231], v[60:63]
    ds_read_b64_tr_b16 v[38:39], v107 offset:18432
    s_waitcnt lgkmcnt(6)
    v_mfma_f32_16x16x32_bf16 v[48:51], v[24:27], v[160:163], v[48:51]
    ds_read_b64_tr_b16 v[40:41], v105 offset:20480
    v_mov_b32 v12, v76
    v_mfma_f32_16x16x32_bf16 v[52:55], v[24:27], v[232:235], v[52:55]
    ds_read_b64_tr_b16 v[42:43], v105 offset:22528
    ds_read_b128 v[20:23], v11 offset:48
    v_mfma_f32_16x16x32_bf16 v[64:67], v[24:27], v[80:83], v[64:67]
    v_permlane16_swap_b32 v76, v12
    s_waitcnt lgkmcnt(7)
    v_mfma_f32_16x16x32_bf16 v[56:59], v[28:31], v[160:163], v[56:59]
    ds_read_b64_tr_b16 v[44:45], v107 offset:20480
    v_add_f32 v76, v76, v12
    v_mfma_f32_16x16x32_bf16 v[60:63], v[28:31], v[232:235], v[60:63]
    ds_read_b64_tr_b16 v[46:47], v107 offset:22528
    s_waitcnt lgkmcnt(7)
    v_mfma_f32_16x16x32_bf16 v[48:51], v[32:35], v[164:167], v[48:51]
    s_waitcnt lgkmcnt(2)
    v_min_u32 v20, v20, v21
    v_min3_u32 v20, v20, v22, v23
    s_nop 0
    v_readfirstlane_b32 s64, v20
    s_nop 0
    s_cmp_ge_u32 s64, 36
    s_cbranch_scc0 Ls_s9
Ls_r9:
    ds_read_b64_tr_b16 v[24:25], v105 offset:24576
    v_mov_b32 v12, v76
    v_mfma_f32_16x16x32_bf16 v[52:55], v[32:35], v[236:239], v[52:55]
    ds_read_b64_tr_b16 v[26:27], v105 offset:26624
    v_mfma_f32_16x16x32_bf16 v[64:67], v[32:35], v[80:83], v[64:67]
    v_permlane32_swap_b32 v76, v12
    v_mfma_f32_16x16x32_bf16 v[56:59], v[36:39], v[164:167], v[56:59]
    ds_read_b64_tr_b16 v[28:29], v107 offset:24576
    v_add_f32 v76, v76, v12
    v_mfma_f32_16x16x32_bf16 v[60:63], v[36:39], v[236:239], v[60:63]
    ds_read_b64_tr_b16 v[30:31], v107 offset:26624
    v_mfma_f32_16x16x32_bf16 v[48:51], v[40:43], v[168:171], v[48:51]
    ds_read_b64_tr_b16 v[32:33], v105 offset:28672
    v_mul_f32 v72, 0x3ae38e39, v72
    v_mfma_f32_16x16x32_bf16 v[52:55], v[40:43], v[240:243], v[52:55]
    ds_read_b64_tr_b16 v[34:35], v105 offset:30720
    v_mfma_f32_16x16x32_bf16 v[64:67], v[40:43], v[80:83], v[64:67]
    v_mul_f32 v12, v72, v72
    s_waitcnt lgkmcnt(6)
    v_mfma_f32_16x16x32_bf16 v[56:59], v[44:47], v[168:171], v[56:59]
    ds_read_b64_tr_b16 v[36:37], v107 offset:28672
    v_mov_b32 v94, 0x3ae38e39
    v_mfma_f32_16x16x32_bf16 v[60:63], v[44:47], v[240:243], v[60:63]
    ds_read_b64_tr_b16 v[38:39], v107 offset:30720
    s_waitcnt lgkmcnt(6)
    v_mfma_f32_16x16x32_bf16 v[48:51], v[24:27], v[172:175], v[48:51]
    ds_read_b64_tr_b16 v[40:41], v105 offset:32768
    v_fma_f32 v76, v76, v94, -v12
    v_mfma_f32_16x16x32_bf16 v[52:55], v[24:27], v[244:247], v[52:55]
    ds_read_b64_tr_b16 v[42:43], v105 offset:34816
    v_mfma_f32_16x16x32_bf16 v[64:67], v[24:27], v[80:83], v[64:67]
    v_max_f32 v76, 0, v76
    s_waitcnt lgkmcnt(6)
    v_mfma_f32_16x16x32_bf16 v[56:59], v[28:31], v[172:175], v[56:59]
    ds_read_b64_tr_b16 v[44:45], v107 offset:32768
    v_cvt_pk_bf16_f32 v76, v76, v76
    v_mfma_f32_16x16x32_bf16 v[60:63], v[28:31], v[244:247], v[60:63]
    ds_read_b64_tr_b16 v[46:47], v107 offset:34816
    s_waitcnt lgkmcnt(6)
    v_mfma_f32_16x16x32_bf16 v[48:51], v[32:35], v[176:179], v[48:51]
    v_lshlrev_b32 v76, 16, v76
    v_add_f32 v76, 0x3727c5ac, v76
    v_mfma_f32_16x16x32_bf16 v[52:55], v[32:35], v[248:251], v[52:55]
    v_cvt_pk_bf16_f32 v76, v76, v76
    v_mfma_f32_16x16x32_bf16 v[64:67], v[32:35], v[80:83], v[64:67]
    v_lshlrev_b32 v76, 16, v76
    s_waitcnt lgkmcnt(4)
    v_mfma_f32_16x16x32_bf16 v[56:59], v[36:39], v[176:179], v[56:59]
    v_sqrt_f32 v93, v76
    s_nop 0
    v_cvt_pk_bf16_f32 v93, v93, v93
    v_mfma_f32_16x16x32_bf16 v[60:63], v[36:39], v[248:251], v[60:63]
    v_lshlrev_b32 v93, 16, v93
    s_waitcnt lgkmcnt(2)
    v_mfma_f32_16x16x32_bf16 v[48:51], v[40:43], v[180:183], v[48:51]
    v_cvt_pk_bf16_f32 v72, v72, v72
    v_lshlrev_b32 v72, 16, v72
    v_mfma_f32_16x16x32_bf16 v[52:55], v[40:43], v[252:255], v[52:55]
    v_sub_f32 v92, 0, v72
    v_mfma_f32_16x16x32_bf16 v[64:67], v[40:43], v[80:83], v[64:67]
    v_rcp_f32 v12, v93
    s_waitcnt lgkmcnt(0)
    v_mfma_f32_16x16x32_bf16 v[56:59], v[44:47], v[180:183], v[56:59]
    v_mul_f32 v94, 0xc0135761, v12
    v_mul_f32 v95, v12, v12
    v_mfma_f32_16x16x32_bf16 v[60:63], v[44:47], v[252:255], v[60:63]
    v_mul_f32 v95, v95, v12
    v_mul_f32 v95, 0xbdd2d3e8, v95
    s_lshl_b32 s65, s57, 8
    s_add_u32 s65, s65, 156672
    v_lshl_add_u32 v16, v3, 4, s65
    v_xor_b32 v17, 256, v16
    s_lshl_b32 s65, s57, 6
    v_lshl_add_u32 v18, v2, 4, v11
    v_add_u32 v18, s65, v18
    v_xor_b32 v19, 128, v18
    ds_write_b128 v16, v[92:95]
    ds_write_b128 v18, v[64:67] offset:256
    s_waitcnt vmcnt(0)
    v_mov_b32 v0, 2
    ds_write_b32 v10, v0
    v_pk_fma_f32 v[48:49], v[64:65], v[92:93], v[48:49] op_sel_hi:[1,0,1]
    v_pk_fma_f32 v[50:51], v[66:67], v[92:93], v[50:51] op_sel_hi:[1,0,1]
    v_pk_mul_f32 v[112:113], v[48:49], v[48:49]
    v_pk_mul_f32 v[114:115], v[50:51], v[50:51]
    v_pk_fma_f32 v[112:113], v[112:113], v[94:95], v[94:95] op_sel:[0,1,0] op_sel_hi:[1,1,0]
    v_pk_fma_f32 v[114:115], v[114:115], v[94:95], v[94:95] op_sel:[0,1,0] op_sel_hi:[1,1,0]
    v_pk_mul_f32 v[112:113], v[112:113], v[48:49]
    v_pk_mul_f32 v[114:115], v[114:115], v[50:51]
    v_exp_f32 v112, v112
    v_exp_f32 v113, v113
    v_exp_f32 v114, v114
    v_exp_f32 v115, v115
    v_pk_fma_f32 v[112:113], v[112:113], v[92:93], v[92:93] op_sel:[0,1,1] op_sel_hi:[1,1,1]
    v_pk_fma_f32 v[114:115], v[114:115], v[92:93], v[92:93] op_sel:[0,1,1] op_sel_hi:[1,1,1]
    v_rcp_f32 v112, v112
    v_rcp_f32 v113, v113
    v_rcp_f32 v114, v114
    v_rcp_f32 v115, v115
    v_pk_mul_f32 v[48:49], v[48:49], v[112:113]
    v_pk_mul_f32 v[50:51], v[50:51], v[114:115]
    s_mov_b32 s89, 0
    s_nop 0
    s_branch Lw_11
Lw_10:
Lw_11:
    ds_read_b128 v[12:15], v11 offset:0
    s_add_u32 s89, s89, 1
    s_cmp_gt_u32 s89, 1000000
    s_cbranch_scc1 L_end
    s_waitcnt lgkmcnt(0)
    v_min_u32 v12, v12, v13
    v_min3_u32 v12, v12, v14, v15
    s_nop 0
    v_readfirstlane_b32 s64, v12
    s_nop 0
    s_cmp_lt_u32 s64, 2
    s_nop 1
    s_cbranch_scc1 Lw_10
    ds_read_b128 v[96:99], v17
    ds_read_b128 v[68:71], v19 offset:256
    s_waitcnt lgkmcnt(0)
    v_pk_fma_f32 v[52:53], v[64:65], v[96:97], v[52:53] op_sel_hi:[1,0,1]
    v_pk_fma_f32 v[54:55], v[66:67], v[96:97], v[54:55] op_sel_hi:[1,0,1]
    v_pk_fma_f32 v[56:57], v[68:69], v[92:93], v[56:57] op_sel_hi:[1,0,1]
    v_pk_fma_f32 v[58:59], v[70:71], v[92:93], v[58:59] op_sel_hi:[1,0,1]
    v_pk_fma_f32 v[60:61], v[68:69], v[96:97], v[60:61] op_sel_hi:[1,0,1]
    v_pk_fma_f32 v[62:63], v[70:71], v[96:97], v[62:63] op_sel_hi:[1,0,1]
    v_pk_mul_f32 v[112:113], v[52:53], v[52:53]
    v_pk_mul_f32 v[114:115], v[54:55], v[54:55]
    v_pk_mul_f32 v[116:117], v[56:57], v[56:57]
    v_pk_mul_f32 v[118:119], v[58:59], v[58:59]
    v_pk_mul_f32 v[120:121], v[60:61], v[60:61]
    v_pk_mul_f32 v[122:123], v[62:63], v[62:63]
    v_pk_fma_f32 v[112:113], v[112:113], v[98:99], v[98:99] op_sel:[0,1,0] op_sel_hi:[1,1,0]
    v_pk_fma_f32 v[114:115], v[114:115], v[98:99], v[98:99] op_sel:[0,1,0] op_sel_hi:[1,1,0]
    v_pk_fma_f32 v[116:117], v[116:117], v[94:95], v[94:95] op_sel:[0,1,0] op_sel_hi:[1,1,0]
    v_pk_fma_f32 v[118:119], v[118:119], v[94:95], v[94:95] op_sel:[0,1,0] op_sel_hi:[1,1,0]
    v_pk_fma_f32 v[120:121], v[120:121], v[98:99], v[98:99] op_sel:[0,1,0] op_sel_hi:[1,1,0]
    v_pk_fma_f32 v[122:123], v[122:123], v[98:99], v[98:99] op_sel:[0,1,0] op_sel_hi:[1,1,0]
    v_pk_mul_f32 v[112:113], v[112:113], v[52:53]
    v_pk_mul_f32 v[114:115], v[114:115], v[54:55]
    v_pk_mul_f32 v[116:117], v[116:117], v[56:57]
    v_pk_mul_f32 v[118:119], v[118:119], v[58:59]
    v_pk_mul_f32 v[120:121], v[120:121], v[60:61]
    v_pk_mul_f32 v[122:123], v[122:123], v[62:63]
    v_exp_f32 v112, v112
    v_exp_f32 v113, v113
    v_exp_f32 v114, v114
    v_exp_f32 v115, v115
    v_exp_f32 v116, v116
    v_exp_f32 v117, v117
    v_exp_f32 v118, v118
    v_exp_f32 v119, v119
    v_exp_f32 v120, v120
    v_exp_f32 v121, v121
    v_exp_f32 v122, v122
    v_exp_f32 v123, v123
    v_pk_fma_f32 v[112:113], v[112:113], v[96:97], v[96:97] op_sel:[0,1,1] op_sel_hi:[1,1,1]
    v_pk_fma_f32 v[114:115], v[114:115], v[96:97], v[96:97] op_sel:[0,1,1] op_sel_hi:[1,1,1]
    v_pk_fma_f32 v[116:117], v[116:117], v[92:93], v[92:93] op_sel:[0,1,1] op_sel_hi:[1,1,1]
    v_pk_fma_f32 v[118:119], v[118:119], v[92:93], v[92:93] op_sel:[0,1,1] op_sel_hi:[1,1,1]
    v_pk_fma_f32 v[120:121], v[120:121], v[96:97], v[96:97] op_sel:[0,1,1] op_sel_hi:[1,1,1]
    v_pk_fma_f32 v[122:123], v[122:123], v[96:97], v[96:97] op_sel:[0,1,1] op_sel_hi:[1,1,1]
    v_rcp_f32 v112, v112
    v_rcp_f32 v113, v113
    v_rcp_f32 v114, v114
    v_rcp_f32 v115, v115
    v_rcp_f32 v116, v116
    v_rcp_f32 v117, v117
    v_rcp_f32 v118, v118
    v_rcp_f32 v119, v119
    v_rcp_f32 v120, v120
    v_rcp_f32 v121, v121
    v_rcp_f32 v122, v122
    v_rcp_f32 v123, v123
    v_pk_mul_f32 v[52:53], v[52:53], v[112:113]
    v_pk_mul_f32 v[54:55], v[54:55], v[114:115]
    v_pk_mul_f32 v[56:57], v[56:57], v[116:117]
    v_pk_mul_f32 v[58:59], v[58:59], v[118:119]
    v_pk_mul_f32 v[60:61], v[60:61], v[120:121]
    v_pk_mul_f32 v[62:63], v[62:63], v[122:123]
    v_cvt_pk_bf16_f32 v132, v48, v49
    v_cvt_pk_bf16_f32 v133, v50, v51
    v_cvt_pk_bf16_f32 v134, v52, v53
    v_cvt_pk_bf16_f32 v135, v54, v55
    v_cvt_pk_bf16_f32 v136, v56, v57
    v_cvt_pk_bf16_f32 v137, v58, v59
    v_cvt_pk_bf16_f32 v138, v60, v61
    v_cvt_pk_bf16_f32 v139, v62, v63
    s_cmp_eq_u32 s67, 0
    s_nop 0
    s_cbranch_scc1 Lsw_12
    v_swap_b32 v132, v136
    v_swap_b32 v133, v137
    v_swap_b32 v134, v138
    v_swap_b32 v135, v139
    s_nop 2
Lsw_12:
    ds_bpermute_b32 v140, v108, v132
    ds_bpermute_b32 v141, v108, v133
    ds_bpermute_b32 v142, v108, v134
    ds_bpermute_b32 v143, v108, v135
    ds_bpermute_b32 v144, v109, v136
    ds_bpermute_b32 v145, v109, v137
    ds_bpermute_b32 v146, v109, v138
    ds_bpermute_b32 v147, v109, v139
    v_mov_b32 v0, 3
    ds_write_b32 v10, v0
    s_waitcnt lgkmcnt(0)
    v_cndmask_b32 v92, v142, v140, s[92:93]
    v_cndmask_b32 v92, 0, v92, s[94:95]
    v_cndmask_b32 v93, v143, v141, s[92:93]
    v_cndmask_b32 v93, 0, v93, s[94:95]
    v_cndmask_b32 v94, v146, v144, s[96:97]
    v_cndmask_b32 v94, 0, v94, s[98:99]
    v_cndmask_b32 v95, v147, v145, s[96:97]
    v_cndmask_b32 v95, 0, v95, s[98:99]
    buffer_store_dwordx4 v[92:95], v4, s[52:55], s72 offen
    v_cndmask_b32 v96, v140, v142, s[92:93]
    v_cndmask_b32 v96, 0, v96, s[100:101]
    v_cndmask_b32 v97, v141, v143, s[92:93]
    v_cndmask_b32 v97, 0, v97, s[100:101]
    v_cndmask_b32 v98, v144, v146, s[96:97]
    v_cndmask_b32 v98, 0, v98, s[78:79]
    v_cndmask_b32 v99, v145, v147, s[96:97]
    v_cndmask_b32 v99, 0, v99, s[78:79]
    buffer_store_dwordx4 v[96:99], v4, s[52:55], s73 offen
    v_lshrrev_b32 v12, 2, v1
    v_lshlrev_b32 v12, 7, v12
    v_and_b32 v13, 3, v1
    v_lshl_add_u32 v12, v13, 3, v12
    v_bfe_u32 v13, v1, 3, 2
    v_add_u32 v12, 73728, v12
    v_xor_b32 v14, 0, v13
    v_lshl_add_u32 v100, v14, 5, v12
    v_add_u32 v101, 36864, v100
    v_xor_b32 v14, 1, v13
    v_lshl_add_u32 v102, v14, 5, v12
    v_add_u32 v103, 36864, v102
    v_xor_b32 v14, 2, v13
    v_lshl_add_u32 v104, v14, 5, v12
    v_add_u32 v105, 36864, v104
    v_xor_b32 v14, 3, v13
    v_lshl_add_u32 v106, v14, 5, v12
    v_add_u32 v107, 36864, v106
    v_add_u32 v108, s74, v4
    ds_read_b128 v[20:23], v11 offset:16
    v_mov_b32 v12, s80
    v_mov_b32 v13, s80
    v_mov_b32 v14, s80
    v_mov_b32 v15, s80
    s_waitcnt vmcnt(0)
    s_mov_b64 exec, 0xff
    buffer_store_dwordx4 v[12:15], v4, s[44:47], s71 offen
    s_mov_b64 exec, -1
    s_add_u32 s72, s72, 25165824
    s_add_u32 s73, s73, 25165824
    s_mov_b32 s70, 0
    s_waitcnt lgkmcnt(0)
    v_min_u32 v20, v20, v21
    v_min3_u32 v20, v20, v22, v23
    s_nop 0
    v_readfirstlane_b32 s64, v20
    s_nop 0
    s_cmp_ge_u32 s64, 7
    s_cbranch_scc0 Ls_s13
Ls_r13:
    ds_read_b64_tr_b16 v[184:185], v100 offset:0
    ds_read_b64_tr_b16 v[186:187], v100 offset:2048
    ds_read_b64_tr_b16 v[188:189], v102 offset:0
    ds_read_b64_tr_b16 v[190:191], v102 offset:2048
    ds_read_b64_tr_b16 v[192:193], v104 offset:0
    ds_read_b64_tr_b16 v[194:195], v104 offset:2048
    ds_read_b64_tr_b16 v[196:197], v106 offset:0
    ds_read_b64_tr_b16 v[198:199], v106 offset:2048
    ds_read_b64_tr_b16 v[200:201], v100 offset:4096
    ds_read_b64_tr_b16 v[202:203], v100 offset:6144
    ds_read_b64_tr_b16 v[204:205], v102 offset:4096
    ds_read_b64_tr_b16 v[206:207], v102 offset:6144
    ds_read_b64_tr_b16 v[208:209], v104 offset:4096
    ds_read_b64_tr_b16 v[210:211], v104 offset:6144
    s_waitcnt lgkmcnt(12)
    ds_read_b64_tr_b16 v[212:213], v106 offset:4096
    ds_read_b64_tr_b16 v[214:215], v106 offset:6144
    s_waitcnt lgkmcnt(12)
    ds_read_b64_tr_b16 v[216:217], v100 offset:8192
    ds_read_b64_tr_b16 v[218:219], v100 offset:10240
    s_waitcnt lgkmcnt(12)
    ds_read_b64_tr_b16 v[220:221], v102 offset:8192
    ds_read_b64_tr_b16 v[222:223], v102 offset:10240
    s_waitcnt lgkmcnt(12)
    ds_read_b64_tr_b16 v[224:225], v104 offset:8192
    ds_read_b64_tr_b16 v[226:227], v104 offset:10240
    s_waitcnt lgkmcnt(12)
    ds_read_b64_tr_b16 v[228:229], v106 offset:8192
    ds_read_b64_tr_b16 v[230:231], v106 offset:10240
    s_waitcnt lgkmcnt(12)
    ds_read_b64_tr_b16 v[232:233], v100 offset:12288
    ds_read_b64_tr_b16 v[234:235], v100 offset:14336
    s_waitcnt lgkmcnt(12)
    ds_read_b64_tr_b16 v[236:237], v102 offset:12288
    ds_read_b64_tr_b16 v[238:239], v102 offset:14336
    s_waitcnt lgkmcnt(12)
    ds_read_b64_tr_b16 v[240:241], v104 offset:12288
    ds_read_b64_tr_b16 v[242:243], v104 offset:14336
    s_waitcnt lgkmcnt(12)
    ds_read_b64_tr_b16 v[244:245], v106 offset:12288
    ds_read_b64_tr_b16 v[246:247], v106 offset:14336
    s_waitcnt lgkmcnt(12)
    ds_read_b64_tr_b16 v[248:249], v100 offset:16384
    ds_read_b64_tr_b16 v[250:251], v100 offset:18432
    s_waitcnt lgkmcnt(12)
    ds_read_b64_tr_b16 v[252:253], v102 offset:16384
    ds_read_b64_tr_b16 v[254:255], v102 offset:18432
    s_waitcnt lgkmcnt(12)
    ds_read_b64_tr_b16 v[24:25], v104 offset:16384
    ds_read_b64_tr_b16 v[26:27], v104 offset:18432
    s_waitcnt lgkmcnt(12)
    ds_read_b64_tr_b16 v[28:29], v106 offset:16384
    ds_read_b64_tr_b16 v[30:31], v106 offset:18432
    s_waitcnt lgkmcnt(12)
    ds_read_b64_tr_b16 v[32:33], v100 offset:20480
    ds_read_b64_tr_b16 v[34:35], v100 offset:22528
    s_waitcnt lgkmcnt(12)
    ds_read_b64_tr_b16 v[36:37], v102 offset:20480
    ds_read_b64_tr_b16 v[38:39], v102 offset:22528
    s_waitcnt lgkmcnt(12)
    ds_read_b64_tr_b16 v[40:41], v104 offset:20480
    ds_read_b64_tr_b16 v[42:43], v104 offset:22528
    s_waitcnt lgkmcnt(12)
    ds_read_b64_tr_b16 v[44:45], v106 offset:20480
    ds_read_b64_tr_b16 v[46:47], v106 offset:22528
    s_add_u32 s64, s76, 393216
    s_mov_b32 s89, 0
    s_branch Lpoll_15
Lpoll_14:
    s_sleep 1
Lpoll_15:
    s_and_b32 s65, s89, 7
    s_cmp_eq_u32 s65, 7
    s_cselect_b32 s67, 25165824, 0
    s_add_u32 s65, s64, s67
    buffer_load_dword v12, v8, s[44:47], s65 offen sc1
    s_add_u32 s89, s89, 1
    s_cmp_gt_u32 s89, 100000
    s_cbranch_scc1 L_end
    s_waitcnt vmcnt(0)
    s_cmp_lg_u32 s89, 5
    s_cbranch_scc1 Lpoll_16
    v_mov_b32 v0, v12
    buffer_store_dwordx4 v[92:95], v4, s[52:55], s72 offen sc1
    buffer_store_dwordx4 v[96:99], v4, s[52:55], s73 offen sc1
    v_mov_b32 v12, s80
    v_mov_b32 v13, s80
    v_mov_b32 v14, s80
    v_mov_b32 v15, s80
    s_add_u32 s65, s71, 25165824
    s_waitcnt vmcnt(0)
    s_mov_b64 exec, 0xff
    buffer_store_dwordx4 v[12:15], v4, s[44:47], s65 offen sc1
    s_mov_b64 exec, -1
    s_mov_b32 s70, 1
    v_mov_b32 v12, v0
    s_nop 2
Lpoll_16:
    s_cmp_eq_u32 s67, 0
    s_cselect_b32 s65, s80, s56
    s_cselect_b32 s66, 1, 16
    v_subrev_u32 v12, s65, v12
    v_cmp_le_u32 vcc, s66, v12
    s_nop 3
    s_cbranch_vccnz Lpoll_14
    v_add_u32 v108, s67, v108
    buffer_load_dwordx4 v[112:115], v108, s[52:55], s84 offen offset:0 sc1
    buffer_load_dwordx4 v[116:119], v108, s[52:55], s84 offen offset:1024 sc1
    buffer_load_dwordx4 v[120:123], v108, s[52:55], s84 offen offset:2048 sc1
    buffer_load_dwordx4 v[124:127], v108, s[52:55], s84 offen offset:3072 sc1
    buffer_load_dwordx4 v[128:131], v108, s[52:55], s85 offen offset:0 sc1
    buffer_load_dwordx4 v[132:135], v108, s[52:55], s85 offen offset:1024 sc1
    buffer_load_dwordx4 v[136:139], v108, s[52:55], s85 offen offset:2048 sc1
    buffer_load_dwordx4 v[140:143], v108, s[52:55], s85 offen offset:3072 sc1
    buffer_load_dwordx4 v[144:147], v108, s[52:55], s86 offen offset:0 sc1
    buffer_load_dwordx4 v[148:151], v108, s[52:55], s86 offen offset:1024 sc1
    buffer_load_dwordx4 v[152:155], v108, s[52:55], s86 offen offset:2048 sc1
    buffer_load_dwordx4 v[156:159], v108, s[52:55], s86 offen offset:3072 sc1
    buffer_load_dwordx4 v[160:163], v108, s[52:55], s87 offen offset:0 sc1
    buffer_load_dwordx4 v[164:167], v108, s[52:55], s87 offen offset:1024 sc1
    buffer_load_dwordx4 v[168:171], v108, s[52:55], s87 offen offset:2048 sc1
    buffer_load_dwordx4 v[172:175], v108, s[52:55], s87 offen offset:3072 sc1
    buffer_load_dwordx4 v[176:179], v108, s[52:55], s88 offen offset:0 sc1
    buffer_load_dwordx4 v[180:183], v108, s[52:55], s88 offen offset:1024 sc1
    s_waitcnt vmcnt(17)
    v_mfma_f32_16x16x32_bf16 v[48:51], v[184:187], v[112:115], 0
    s_waitcnt lgkmcnt(12)
    ds_read_b64_tr_b16 v[184:185], v100 offset:24576
    ds_read_b64_tr_b16 v[186:187], v100 offset:26624
    v_mfma_f32_16x16x32_bf16 v[52:55], v[188:191], v[112:115], 0
    s_waitcnt lgkmcnt(12)
    ds_read_b64_tr_b16 v[188:189], v102 offset:24576
    ds_read_b64_tr_b16 v[190:191], v102 offset:26624
    v_mfma_f32_16x16x32_bf16 v[56:59], v[192:195], v[112:115], 0
    s_waitcnt lgkmcnt(12)
    ds_read_b64_tr_b16 v[192:193], v104 offset:24576
    ds_read_b64_tr_b16 v[194:195], v104 offset:26624
    v_mfma_f32_16x16x32_bf16 v[60:63], v[196:199], v[112:115], 0
    s_waitcnt lgkmcnt(12)
    ds_read_b64_tr_b16 v[196:197], v106 offset:24576
    ds_read_b64_tr_b16 v[198:199], v106 offset:26624
    s_waitcnt vmcnt(16)
    v_mfma_f32_16x16x32_bf16 v[48:51], v[200:203], v[116:119], v[48:51]
    s_waitcnt lgkmcnt(12)
    ds_read_b64_tr_b16 v[200:201], v100 offset:28672
    ds_read_b64_tr_b16 v[202:203], v100 offset:30720
    v_mfma_f32_16x16x32_bf16 v[52:55], v[204:207], v[116:119], v[52:55]
    s_waitcnt lgkmcnt(12)
    ds_read_b64_tr_b16 v[204:205], v102 offset:28672
    ds_read_b64_tr_b16 v[206:207], v102 offset:30720
    v_mfma_f32_16x16x32_bf16 v[56:59], v[208:211], v[116:119], v[56:59]
    s_waitcnt lgkmcnt(12)
    ds_read_b64_tr_b16 v[208:209], v104 offset:28672
    ds_read_b64_tr_b16 v[210:211], v104 offset:30720
    v_mfma_f32_16x16x32_bf16 v[60:63], v[212:215], v[116:119], v[60:63]
    s_waitcnt lgkmcnt(12)
    ds_read_b64_tr_b16 v[212:213], v106 offset:28672
    ds_read_b64_tr_b16 v[214:215], v106 offset:30720
    s_waitcnt vmcnt(15)
    v_mfma_f32_16x16x32_bf16 v[48:51], v[216:219], v[120:123], v[48:51]
    s_waitcnt lgkmcnt(12)
    ds_read_b64_tr_b16 v[216:217], v100 offset:32768
    ds_read_b64_tr_b16 v[218:219], v100 offset:34816
    v_mfma_f32_16x16x32_bf16 v[52:55], v[220:223], v[120:123], v[52:55]
    s_waitcnt lgkmcnt(12)
    ds_read_b64_tr_b16 v[220:221], v102 offset:32768
    ds_read_b64_tr_b16 v[222:223], v102 offset:34816
    v_mfma_f32_16x16x32_bf16 v[56:59], v[224:227], v[120:123], v[56:59]
    s_waitcnt lgkmcnt(12)
    ds_read_b64_tr_b16 v[224:225], v104 offset:32768
    ds_read_b64_tr_b16 v[226:227], v104 offset:34816
    v_mfma_f32_16x16x32_bf16 v[60:63], v[228:231], v[120:123], v[60:63]
    s_waitcnt lgkmcnt(12)
    ds_read_b64_tr_b16 v[228:229], v106 offset:32768
    ds_read_b64_tr_b16 v[230:231], v106 offset:34816
    s_waitcnt vmcnt(14)
    v_mfma_f32_16x16x32_bf16 v[48:51], v[232:235], v[124:127], v[48:51]
    s_waitcnt lgkmcnt(12)
    ds_read_b64_tr_b16 v[232:233], v101 offset:0
    ds_read_b64_tr_b16 v[234:235], v101 offset:2048
    v_mfma_f32_16x16x32_bf16 v[52:55], v[236:239], v[124:127], v[52:55]
    s_waitcnt lgkmcnt(12)
    ds_read_b64_tr_b16 v[236:237], v103 offset:0
    ds_read_b64_tr_b16 v[238:239], v103 offset:2048
    v_mfma_f32_16x16x32_bf16 v[56:59], v[240:243], v[124:127], v[56:59]
    s_waitcnt lgkmcnt(12)
    ds_read_b64_tr_b16 v[240:241], v105 offset:0
    ds_read_b64_tr_b16 v[242:243], v105 offset:2048
    v_mfma_f32_16x16x32_bf16 v[60:63], v[244:247], v[124:127], v[60:63]
    s_waitcnt lgkmcnt(12)
    ds_read_b64_tr_b16 v[244:245], v107 offset:0
    ds_read_b64_tr_b16 v[246:247], v107 offset:2048
    s_waitcnt vmcnt(13)
    v_mfma_f32_16x16x32_bf16 v[48:51], v[248:251], v[128:131], v[48:51]
    s_waitcnt lgkmcnt(12)
    ds_read_b64_tr_b16 v[248:249], v101 offset:4096
    ds_read_b64_tr_b16 v[250:251], v101 offset:6144
    v_mfma_f32_16x16x32_bf16 v[52:55], v[252:255], v[128:131], v[52:55]
    s_waitcnt lgkmcnt(12)
    ds_read_b64_tr_b16 v[252:253], v103 offset:4096
    ds_read_b64_tr_b16 v[254:255], v103 offset:6144
    v_mfma_f32_16x16x32_bf16 v[56:59], v[24:27], v[128:131], v[56:59]
    s_waitcnt lgkmcnt(12)
    ds_read_b64_tr_b16 v[24:25], v105 offset:4096
    ds_read_b64_tr_b16 v[26:27], v105 offset:6144
    v_mfma_f32_16x16x32_bf16 v[60:63], v[28:31], v[128:131], v[60:63]
    s_waitcnt lgkmcnt(12)
    ds_read_b64_tr_b16 v[28:29], v107 offset:4096
    ds_read_b64_tr_b16 v[30:31], v107 offset:6144
    s_waitcnt vmcnt(12)
    v_mfma_f32_16x16x32_bf16 v[48:51], v[32:35], v[132:135], v[48:51]
    s_waitcnt lgkmcnt(12)
    ds_read_b64_tr_b16 v[32:33], v101 offset:8192
    ds_read_b64_tr_b16 v[34:35], v101 offset:10240
    v_mfma_f32_16x16x32_bf16 v[52:55], v[36:39], v[132:135], v[52:55]
    s_waitcnt lgkmcnt(12)
    ds_read_b64_tr_b16 v[36:37], v103 offset:8192
    ds_read_b64_tr_b16 v[38:39], v103 offset:10240
    v_mfma_f32_16x16x32_bf16 v[56:59], v[40:43], v[132:135], v[56:59]
    s_waitcnt lgkmcnt(12)
    ds_read_b64_tr_b16 v[40:41], v105 offset:8192
    ds_read_b64_tr_b16 v[42:43], v105 offset:10240
    v_mfma_f32_16x16x32_bf16 v[60:63], v[44:47], v[132:135], v[60:63]
    s_waitcnt lgkmcnt(12)
    ds_read_b64_tr_b16 v[44:45], v107 offset:8192
    ds_read_b64_tr_b16 v[46:47], v107 offset:10240
    s_waitcnt vmcnt(11)
    v_mfma_f32_16x16x32_bf16 v[48:51], v[184:187], v[136:139], v[48:51]
    s_waitcnt lgkmcnt(12)
    ds_read_b64_tr_b16 v[184:185], v101 offset:12288
    ds_read_b64_tr_b16 v[186:187], v101 offset:14336
    v_mfma_f32_16x16x32_bf16 v[52:55], v[188:191], v[136:139], v[52:55]
    s_waitcnt lgkmcnt(12)
    ds_read_b64_tr_b16 v[188:189], v103 offset:12288
    ds_read_b64_tr_b16 v[190:191], v103 offset:14336
    v_mfma_f32_16x16x32_bf16 v[56:59], v[192:195], v[136:139], v[56:59]
    s_waitcnt lgkmcnt(12)
    ds_read_b64_tr_b16 v[192:193], v105 offset:12288
    ds_read_b64_tr_b16 v[194:195], v105 offset:14336
    v_mfma_f32_16x16x32_bf16 v[60:63], v[196:199], v[136:139], v[60:63]
    s_waitcnt lgkmcnt(12)
    ds_read_b64_tr_b16 v[196:197], v107 offset:12288
    ds_read_b64_tr_b16 v[198:199], v107 offset:14336
    s_waitcnt vmcnt(10)
    v_mfma_f32_16x16x32_bf16 v[48:51], v[200:203], v[140:143], v[48:51]
    s_waitcnt lgkmcnt(12)
    ds_read_b64_tr_b16 v[200:201], v101 offset:16384
    ds_read_b64_tr_b16 v[202:203], v101 offset:18432
    v_mfma_f32_16x16x32_bf16 v[52:55], v[204:207], v[140:143], v[52:55]
    s_waitcnt lgkmcnt(12)
    ds_read_b64_tr_b16 v[204:205], v103 offset:16384
    ds_read_b64_tr_b16 v[206:207], v103 offset:18432
    v_mfma_f32_16x16x32_bf16 v[56:59], v[208:211], v[140:143], v[56:59]
    s_waitcnt lgkmcnt(12)
    ds_read_b64_tr_b16 v[208:209], v105 offset:16384
    ds_read_b64_tr_b16 v[210:211], v105 offset:18432
    v_mfma_f32_16x16x32_bf16 v[60:63], v[212:215], v[140:143], v[60:63]
    s_waitcnt lgkmcnt(12)
    ds_read_b64_tr_b16 v[212:213], v107 offset:16384
    ds_read_b64_tr_b16 v[214:215], v107 offset:18432
    s_waitcnt vmcnt(9)
    v_mfma_f32_16x16x32_bf16 v[48:51], v[216:219], v[144:147], v[48:51]
    s_waitcnt lgkmcnt(12)
    ds_read_b64_tr_b16 v[216:217], v101 offset:20480
    ds_read_b64_tr_b16 v[218:219], v101 offset:22528
    v_mfma_f32_16x16x32_bf16 v[52:55], v[220:223], v[144:147], v[52:55]
    s_waitcnt lgkmcnt(12)
    ds_read_b64_tr_b16 v[220:221], v103 offset:20480
    ds_read_b64_tr_b16 v[222:223], v103 offset:22528
    v_mfma_f32_16x16x32_bf16 v[56:59], v[224:227], v[144:147], v[56:59]
    s_waitcnt lgkmcnt(12)
    ds_read_b64_tr_b16 v[224:225], v105 offset:20480
    ds_read_b64_tr_b16 v[226:227], v105 offset:22528
    v_mfma_f32_16x16x32_bf16 v[60:63], v[228:231], v[144:147], v[60:63]
    s_waitcnt lgkmcnt(12)
    ds_read_b64_tr_b16 v[228:229], v107 offset:20480
    ds_read_b64_tr_b16 v[230:231], v107 offset:22528
    s_waitcnt vmcnt(8)
    v_mfma_f32_16x16x32_bf16 v[48:51], v[232:235], v[148:151], v[48:51]
    s_waitcnt lgkmcnt(12)
    ds_read_b64_tr_b16 v[232:233], v101 offset:24576
    ds_read_b64_tr_b16 v[234:235], v101 offset:26624
    v_mfma_f32_16x16x32_bf16 v[52:55], v[236:239], v[148:151], v[52:55]
    s_waitcnt lgkmcnt(12)
    ds_read_b64_tr_b16 v[236:237], v103 offset:24576
    ds_read_b64_tr_b16 v[238:239], v103 offset:26624
    v_mfma_f32_16x16x32_bf16 v[56:59], v[240:243], v[148:151], v[56:59]
    s_waitcnt lgkmcnt(12)
    ds_read_b64_tr_b16 v[240:241], v105 offset:24576
    ds_read_b64_tr_b16 v[242:243], v105 offset:26624
    v_mfma_f32_16x16x32_bf16 v[60:63], v[244:247], v[148:151], v[60:63]
    s_waitcnt lgkmcnt(12)
    ds_read_b64_tr_b16 v[244:245], v107 offset:24576
    ds_read_b64_tr_b16 v[246:247], v107 offset:26624
    s_waitcnt vmcnt(7)
    v_mfma_f32_16x16x32_bf16 v[48:51], v[248:251], v[152:155], v[48:51]
    s_waitcnt lgkmcnt(12)
    ds_read_b64_tr_b16 v[248:249], v101 offset:28672
    ds_read_b64_tr_b16 v[250:251], v101 offset:30720
    v_mfma_f32_16x16x32_bf16 v[52:55], v[252:255], v[152:155], v[52:55]
    s_waitcnt lgkmcnt(12)
    ds_read_b64_tr_b16 v[252:253], v103 offset:28672
    ds_read_b64_tr_b16 v[254:255], v103 offset:30720
    v_mfma_f32_16x16x32_bf16 v[56:59], v[24:27], v[152:155], v[56:59]
    s_waitcnt lgkmcnt(12)
    ds_read_b64_tr_b16 v[24:25], v105 offset:28672
    ds_read_b64_tr_b16 v[26:27], v105 offset:30720
    v_mfma_f32_16x16x32_bf16 v[60:63], v[28:31], v[152:155], v[60:63]
    s_waitcnt lgkmcnt(12)
    ds_read_b64_tr_b16 v[28:29], v107 offset:28672
    ds_read_b64_tr_b16 v[30:31], v107 offset:30720
    s_waitcnt vmcnt(6)
    v_mfma_f32_16x16x32_bf16 v[48:51], v[32:35], v[156:159], v[48:51]
    s_waitcnt lgkmcnt(12)
    ds_read_b64_tr_b16 v[32:33], v101 offset:32768
    ds_read_b64_tr_b16 v[34:35], v101 offset:34816
    v_mfma_f32_16x16x32_bf16 v[52:55], v[36:39], v[156:159], v[52:55]
    s_waitcnt lgkmcnt(12)
    ds_read_b64_tr_b16 v[36:37], v103 offset:32768
    ds_read_b64_tr_b16 v[38:39], v103 offset:34816
    v_mfma_f32_16x16x32_bf16 v[56:59], v[40:43], v[156:159], v[56:59]
    s_waitcnt lgkmcnt(12)
    ds_read_b64_tr_b16 v[40:41], v105 offset:32768
    ds_read_b64_tr_b16 v[42:43], v105 offset:34816
    v_mfma_f32_16x16x32_bf16 v[60:63], v[44:47], v[156:159], v[60:63]
    s_waitcnt lgkmcnt(12)
    ds_read_b64_tr_b16 v[44:45], v107 offset:32768
    ds_read_b64_tr_b16 v[46:47], v107 offset:34816
    s_waitcnt vmcnt(5)
    v_mfma_f32_16x16x32_bf16 v[48:51], v[184:187], v[160:163], v[48:51]
    v_mfma_f32_16x16x32_bf16 v[52:55], v[188:191], v[160:163], v[52:55]
    v_mfma_f32_16x16x32_bf16 v[56:59], v[192:195], v[160:163], v[56:59]
    v_mfma_f32_16x16x32_bf16 v[60:63], v[196:199], v[160:163], v[60:63]
    s_waitcnt vmcnt(4)
    v_mfma_f32_16x16x32_bf16 v[48:51], v[200:203], v[164:167], v[48:51]
    v_mfma_f32_16x16x32_bf16 v[52:55], v[204:207], v[164:167], v[52:55]
    v_mfma_f32_16x16x32_bf16 v[56:59], v[208:211], v[164:167], v[56:59]
    v_mfma_f32_16x16x32_bf16 v[60:63], v[212:215], v[164:167], v[60:63]
    s_waitcnt vmcnt(3)
    v_mfma_f32_16x16x32_bf16 v[48:51], v[216:219], v[168:171], v[48:51]
    v_mfma_f32_16x16x32_bf16 v[52:55], v[220:223], v[168:171], v[52:55]
    v_mfma_f32_16x16x32_bf16 v[56:59], v[224:227], v[168:171], v[56:59]
    v_mfma_f32_16x16x32_bf16 v[60:63], v[228:231], v[168:171], v[60:63]
    s_waitcnt vmcnt(2)
    v_mfma_f32_16x16x32_bf16 v[48:51], v[232:235], v[172:175], v[48:51]
    v_mfma_f32_16x16x32_bf16 v[52:55], v[236:239], v[172:175], v[52:55]
    v_mfma_f32_16x16x32_bf16 v[56:59], v[240:243], v[172:175], v[56:59]
    v_mfma_f32_16x16x32_bf16 v[60:63], v[244:247], v[172:175], v[60:63]
    s_waitcnt vmcnt(1)
    v_mfma_f32_16x16x32_bf16 v[48:51], v[248:251], v[176:179], v[48:51]
    s_waitcnt lgkmcnt(12)
    v_mfma_f32_16x16x32_bf16 v[52:55], v[252:255], v[176:179], v[52:55]
    s_waitcnt lgkmcnt(10)
    v_mfma_f32_16x16x32_bf16 v[56:59], v[24:27], v[176:179], v[56:59]
    s_waitcnt lgkmcnt(8)
    v_mfma_f32_16x16x32_bf16 v[60:63], v[28:31], v[176:179], v[60:63]
    s_waitcnt vmcnt(0)
    s_waitcnt lgkmcnt(6)
    v_mfma_f32_16x16x32_bf16 v[48:51], v[32:35], v[180:183], v[48:51]
    s_waitcnt lgkmcnt(4)
    v_mfma_f32_16x16x32_bf16 v[52:55], v[36:39], v[180:183], v[52:55]
    s_waitcnt lgkmcnt(2)
    v_mfma_f32_16x16x32_bf16 v[56:59], v[40:43], v[180:183], v[56:59]
    s_waitcnt lgkmcnt(0)
    v_mfma_f32_16x16x32_bf16 v[60:63], v[44:47], v[180:183], v[60:63]
    v_mov_b32 v72, 0
    v_mov_b32 v73, 0
    s_mul_i32 s64, s69, 9
    s_add_u32 s64, s64, s61
    s_mul_i32 s64, s64, 2304
    s_add_u32 s64, s64, 2097152
    v_cvt_pk_bf16_f32 v12, v48, v49
    v_lshlrev_b32 v13, 16, v12
    v_and_b32 v12, 0xffff0000, v12
    v_lshlrev_b32 v14, 16, v84
    v_and_b32 v15, 0xffff0000, v84
    v_add_f32 v13, v13, v14
    v_add_f32 v12, v12, v15
    v_cvt_pk_bf16_f32 v64, v13, v12
    v_cvt_pk_bf16_f32 v12, v50, v51
    v_lshlrev_b32 v13, 16, v12
    v_and_b32 v12, 0xffff0000, v12
    v_lshlrev_b32 v14, 16, v85
    v_and_b32 v15, 0xffff0000, v85
    v_add_f32 v13, v13, v14
    v_add_f32 v12, v12, v15
    v_cvt_pk_bf16_f32 v65, v13, v12
    v_cvt_pk_bf16_f32 v12, v52, v53
    v_lshlrev_b32 v13, 16, v12
    v_and_b32 v12, 0xffff0000, v12
    v_lshlrev_b32 v14, 16, v86
    v_and_b32 v15, 0xffff0000, v86
    v_add_f32 v13, v13, v14
    v_add_f32 v12, v12, v15
    v_cvt_pk_bf16_f32 v66, v13, v12
    v_cvt_pk_bf16_f32 v12, v54, v55
    v_lshlrev_b32 v13, 16, v12
    v_and_b32 v12, 0xffff0000, v12
    v_lshlrev_b32 v14, 16, v87
    v_and_b32 v15, 0xffff0000, v87
    v_add_f32 v13, v13, v14
    v_add_f32 v12, v12, v15
    v_cvt_pk_bf16_f32 v67, v13, v12
    buffer_store_dwordx4 v[64:67], v4, s[44:47], s64 offen offset:0 sc1
    v_cvt_pk_bf16_f32 v12, v56, v57
    v_lshlrev_b32 v13, 16, v12
    v_and_b32 v12, 0xffff0000, v12
    v_lshlrev_b32 v14, 16, v88
    v_and_b32 v15, 0xffff0000, v88
    v_add_f32 v13, v13, v14
    v_add_f32 v12, v12, v15
    v_cvt_pk_bf16_f32 v68, v13, v12
    v_cvt_pk_bf16_f32 v12, v58, v59
    v_lshlrev_b32 v13, 16, v12
    v_and_b32 v12, 0xffff0000, v12
    v_lshlrev_b32 v14, 16, v89
    v_and_b32 v15, 0xffff0000, v89
    v_add_f32 v13, v13, v14
    v_add_f32 v12, v12, v15
    v_cvt_pk_bf16_f32 v69, v13, v12
    v_cvt_pk_bf16_f32 v12, v60, v61
    v_lshlrev_b32 v13, 16, v12
    v_and_b32 v12, 0xffff0000, v12
    v_lshlrev_b32 v14, 16, v90
    v_and_b32 v15, 0xffff0000, v90
    v_add_f32 v13, v13, v14
    v_add_f32 v12, v12, v15
    v_cvt_pk_bf16_f32 v70, v13, v12
    v_cvt_pk_bf16_f32 v12, v62, v63
    v_lshlrev_b32 v13, 16, v12
    v_and_b32 v12, 0xffff0000, v12
    v_lshlrev_b32 v14, 16, v91
    v_and_b32 v15, 0xffff0000, v91
    v_add_f32 v13, v13, v14
    v_add_f32 v12, v12, v15
    v_cvt_pk_bf16_f32 v71, v13, v12
    buffer_store_dwordx4 v[68:71], v4, s[44:47], s64 offen offset:1024 sc1
    v_bitop3_b32 v16, v64, v65, s56 bitop3:0x96
    v_bitop3_b32 v16, v16, v66, v67 bitop3:0x96
    v_bitop3_b32 v16, v16, v68, v69 bitop3:0x96
    v_bitop3_b32 v16, v16, v70, v71 bitop3:0x96
    v_lshlrev_b32 v12, 2, v1
    buffer_store_dword v16, v12, s[44:47], s64 offen offset:2048 sc1
    v_dot2_f32_bf16 v72, v64, v80, v72
    v_dot2_f32_bf16 v73, v64, v64, v73
    v_dot2_f32_bf16 v72, v65, v80, v72
    v_dot2_f32_bf16 v73, v65, v65, v73
    v_dot2_f32_bf16 v72, v66, v80, v72
    v_dot2_f32_bf16 v73, v66, v66, v73
    v_dot2_f32_bf16 v72, v67, v80, v72
    v_dot2_f32_bf16 v73, v67, v67, v73
    v_dot2_f32_bf16 v72, v68, v80, v72
    v_dot2_f32_bf16 v73, v68, v68, v73
    v_dot2_f32_bf16 v72, v69, v80, v72
    v_dot2_f32_bf16 v73, v69, v69, v73
    v_dot2_f32_bf16 v72, v70, v80, v72
    v_dot2_f32_bf16 v73, v70, v70, v73
    v_dot2_f32_bf16 v72, v71, v80, v72
    v_dot2_f32_bf16 v73, v71, v71, v73
    s_nop 1
    v_mov_b32 v12, v72
    s_nop 1
    v_permlane16_swap_b32 v72, v12
    v_add_f32 v72, v72, v12
    v_mov_b32 v12, v72
    s_nop 1
    v_permlane32_swap_b32 v72, v12
    v_add_f32 v72, v72, v12
    v_mov_b32 v12, v73
    s_nop 1
    v_permlane16_swap_b32 v73, v12
    v_add_f32 v73, v73, v12
    v_mov_b32 v12, v73
    s_nop 1
    v_permlane32_swap_b32 v73, v12
    v_add_f32 v73, v73, v12
    s_lshr_b32 s64, s69, 1
    s_mul_i32 s64, s64, 12
    s_add_u32 s64, s64, s61
    s_lshl_b32 s64, s64, 8
    s_and_b32 s65, s69, 1
    s_lshl_b32 s65, s65, 7
    s_add_u32 s64, s64, s65
    s_add_u32 s64, s64, 65536
    v_lshlrev_b32 v12, 3, v3
    v_mov_b32 v13, s82
    s_mov_b32 s65, 0xff
    v_bfi_b32 v72, s65, v13, v72
    v_bfi_b32 v73, s65, v13, v73
    s_mov_b64 exec, 0xffff
    buffer_store_dwordx2 v[72:73], v12, s[44:47], s64 offen sc1
    s_mov_b64 exec, -1
    v_mov_b32 v0, 6
    ds_write_b32 v10, v0
    buffer_store_dwordx4 v[92:95], v4, s[52:55], s72 offen sc1
    buffer_store_dwordx4 v[96:99], v4, s[52:55], s73 offen sc1
    s_mov_b32 s101, s71
    s_branch L_c_mlp
L_h_act:
    s_lshl_b32 s69, s58, 3
    s_lshl_b32 s64, s60, 2
    s_add_u32 s69, s69, s64
    s_add_u32 s69, s69, s57
    s_mul_i32 s71, s69, 18432
    v_lshrrev_b32 v12, 3, v1
    v_lshrrev_b32 v13, 4, v1
    v_and_b32 v14, 7, v1
    v_xor_b32 v13, v13, v14
    v_mul_u32_u24 v50, 1152, v12
    v_lshl_add_u32 v50, v13, 4, v50
    v_xor_b32 v51, 64, v50
    v_add_u32 v51, 9216, v51
    s_lshl_b32 s64, s57, 3
    v_add_u32 v12, s64, v12
    v_and_b32 v13, 6, v12
    v_xor_b32 v13, v13, v14
    v_lshlrev_b32 v13, 4, v13
    v_mul_u32_u24 v49, 1152, v12
    v_add_u32 v49, v49, v13
    v_and_b32 v14, 12, v12
    v_lshlrev_b32 v14, 1, v14
    v_and_b32 v48, 3, v12
    v_add_u32 v14, v14, v48
    v_lshrrev_b32 v12, 4, v12
    v_lshl_add_u32 v12, v12, 2, v14
    v_mul_u32_u24 v48, 1152, v12
    v_add_u32 v48, v48, v13
    s_lshl_b32 s79, s61, 7
    s_mov_b32 s70, s79
    s_lshl_b32 s72, s57, 11
    s_add_u32 s72, s72, 73728
    s_waitcnt lgkmcnt(0)
    s_load_dword s3, s[18:19], 0
    s_barrier
    s_mov_b32 s20, s4
    s_mov_b32 s21, s5
    s_mov_b32 s22, 1179648
    s_mov_b32 s23, 0x20000
    s_mov_b32 s24, s6
    s_mov_b32 s25, s7
    s_mov_b32 s26, 663552
    s_mov_b32 s27, 0x20000
    s_add_u32 m0, s72, 0
    s_nop 0
    buffer_load_dwordx4 v50, s[20:23], s71 offen lds
    s_add_u32 m0, s72, 1024
    s_nop 0
    buffer_load_dwordx4 v51, s[20:23], s71 offen lds
    s_add_u32 s71, s71, 128
    s_add_u32 m0, s83, 0
    s_nop 0
    buffer_load_dwordx4 v48, s[24:27], s70 offen lds
    s_add_u32 s70, s70, 36864
    s_add_u32 m0, s83, 4096
    s_nop 0
    buffer_load_dwordx4 v48, s[24:27], s70 offen lds
    s_add_u32 m0, s50, 32
    v_mov_b32 v0, 16
    s_mov_b64 exec, 1
    global_load_lds_dword v0, s[48:49]
    s_mov_b64 exec, -1
    s_add_u32 s70, s70, 36864
    s_add_u32 m0, s72, 8192
    s_nop 0
    buffer_load_dwordx4 v50, s[20:23], s71 offen lds
    s_add_u32 m0, s72, 9216
    s_nop 0
    buffer_load_dwordx4 v51, s[20:23], s71 offen lds
    s_add_u32 s71, s71, 128
    s_add_u32 m0, s83, 8192
    s_nop 0
    buffer_load_dwordx4 v48, s[24:27], s70 offen lds
    s_add_u32 s70, s70, 36864
    s_add_u32 m0, s83, 12288
    s_nop 0
    buffer_load_dwordx4 v48, s[24:27], s70 offen lds
    s_mov_b32 s32, s10
    s_mov_b32 s33, s11
    s_mov_b32 s34, 5308416
    s_mov_b32 s35, 0x20000
    s_mov_b32 s36, s12
    s_mov_b32 s37, s13
    s_mov_b32 s38, 5308416
    s_mov_b32 s39, 0x20000
    s_mov_b32 s84, 0
    s_mov_b32 s85, 4096
    s_mov_b32 s86, 8192
    s_mov_b32 s87, 12288
    s_mov_b32 s88, 16384
    s_mov_b32 s28, s8
    s_mov_b32 s29, s9
    s_mov_b32 s30, 663552
    s_mov_b32 s31, 0x20000
    s_mov_b32 s40, s14
    s_mov_b32 s41, s15
    s_mov_b32 s42, 1179648
    s_mov_b32 s43, 0x20000
    s_mov_b32 s44, s18
    s_mov_b32 s45, s19
    s_mov_b32 s46, 268435456
    s_mov_b32 s47, 0x20000
    s_add_u32 s52, s18, 917504
    s_addc_u32 s53, s19, 0
    s_mov_b32 s54, 26345472
    s_mov_b32 s55, 0x20000
    v_add_u32 v5, 0x10000, v4
    v_add_u32 v6, 0x20000, v4
    v_min_u32 v8, 17, v1
    v_lshlrev_b32 v8, 7, v8
    s_waitcnt lgkmcnt(0)
    s_waitcnt lgkmcnt(0)
    s_add_u32 s3, s3, 0x10000001
    s_and_b32 s82, s3, 0xff
    s_mul_i32 s56, s3, 0x9e3779b1
    s_xor_b32 s56, s56, 0x5bd1e995
    s_getreg_b32 s65, hwreg(HW_REG_XCC_ID)
    s_and_b32 s65, s65, 15
    s_add_u32 s80, s65, s56
    s_add_u32 m0, s50, 32
    v_mov_b32 v0, 32
    s_mov_b64 exec, 1
    global_load_lds_dword v0, s[48:49]
    s_mov_b64 exec, -1
    s_add_u32 s70, s70, 36864
    s_add_u32 m0, s72, 16384
    s_nop 0
    buffer_load_dwordx4 v50, s[20:23], s71 offen lds
    s_add_u32 m0, s72, 17408
    s_nop 0
    buffer_load_dwordx4 v51, s[20:23], s71 offen lds
    s_add_u32 s71, s71, 128
    s_add_u32 m0, s72, 24576
    s_nop 0
    buffer_load_dwordx4 v50, s[20:23], s71 offen lds
    s_add_u32 m0, s72, 25600
    s_nop 0
    buffer_load_dwordx4 v51, s[20:23], s71 offen lds
    s_add_u32 s71, s71, 128
    s_add_u32 m0, s83, 16384
    s_nop 0
    buffer_load_dwordx4 v48, s[24:27], s70 offen lds
    s_add_u32 s70, s70, 36864
    s_add_u32 m0, s83, 20480
    s_nop 0
    buffer_load_dwordx4 v48, s[24:27], s70 offen lds
    s_add_u32 m0, s50, 32
    v_mov_b32 v0, 56
    s_mov_b64 exec, 1
    global_load_lds_dword v0, s[48:49]
    s_mov_b64 exec, -1
    s_add_u32 s70, s70, 36864
    s_add_u32 m0, s72, 32768
    s_nop 0
    buffer_load_dwordx4 v50, s[20:23], s71 offen lds
    s_add_u32 m0, s72, 33792
    s_nop 0
    buffer_load_dwordx4 v51, s[20:23], s71 offen lds
    s_add_u32 s71, s71, 128
    s_add_u32 m0, s72, 40960
    s_nop 0
    buffer_load_dwordx4 v50, s[20:23], s71 offen lds
    s_add_u32 m0, s72, 41984
    s_nop 0
    buffer_load_dwordx4 v51, s[20:23], s71 offen lds
    s_add_u32 s71, s71, 128
    s_add_u32 m0, s83, 24576
    s_nop 0
    buffer_load_dwordx4 v48, s[24:27], s70 offen lds
    s_add_u32 s70, s70, 36864
    s_add_u32 m0, s83, 28672
    s_nop 0
    buffer_load_dwordx4 v48, s[24:27], s70 offen lds
    s_add_u32 m0, s50, 32
    v_mov_b32 v0, 80
    s_mov_b64 exec, 1
    global_load_lds_dword v0, s[48:49]
    s_mov_b64 exec, -1
    s_add_u32 s70, s70, 36864
    s_add_u32 m0, s72, 49152
    s_nop 0
    buffer_load_dwordx4 v50, s[20:23], s71 offen lds
    s_add_u32 m0, s72, 50176
    s_nop 0
    buffer_load_dwordx4 v51, s[20:23], s71 offen lds
    s_add_u32 s71, s71, 128
    s_add_u32 m0, s72, 57344
    s_nop 0
    buffer_load_dwordx4 v50, s[20:23], s71 offen lds
    s_add_u32 m0, s72, 58368
    s_nop 0
    buffer_load_dwordx4 v51, s[20:23], s71 offen lds
    s_add_u32 s71, s71, 128
    s_add_u32 m0, s83, 32768
    s_nop 0
    buffer_load_dwordx4 v48, s[24:27], s70 offen lds
    s_add_u32 s70, s70, 36864
    s_add_u32 m0, s83, 36864
    s_nop 0
    buffer_load_dwordx4 v48, s[24:27], s70 offen lds
    s_add_u32 m0, s50, 32
    v_mov_b32 v0, 104
    s_mov_b64 exec, 1
    global_load_lds_dword v0, s[48:49]
    s_mov_b64 exec, -1
    s_add_u32 s70, s70, 36864
    s_add_u32 m0, s72, 65536
    s_nop 0
    buffer_load_dwordx4 v50, s[20:23], s71 offen lds
    s_add_u32 m0, s72, 66560
    s_nop 0
    buffer_load_dwordx4 v51, s[20:23], s71 offen lds
    s_add_u32 s71, s71, 128
    s_add_u32 m0, s83, 40960
    s_nop 0
    buffer_load_dwordx4 v48, s[24:27], s70 offen lds
    s_add_u32 s70, s70, 36864
    s_add_u32 m0, s83, 45056
    s_nop 0
    buffer_load_dwordx4 v48, s[24:27], s70 offen lds
    s_add_u32 m0, s50, 32
    v_mov_b32 v0, 120
    s_mov_b64 exec, 1
    global_load_lds_dword v0, s[48:49]
    s_mov_b64 exec, -1
    s_add_u32 s70, s70, 36864
    s_add_u32 m0, s83, 49152
    s_nop 0
    buffer_load_dwordx4 v48, s[24:27], s70 offen lds
    s_add_u32 s70, s70, 36864
    s_add_u32 m0, s83, 53248
    s_nop 0
    buffer_load_dwordx4 v48, s[24:27], s70 offen lds
    s_add_u32 s70, s70, 36864
    s_add_u32 m0, s83, 57344
    s_nop 0
    buffer_load_dwordx4 v48, s[24:27], s70 offen lds
    s_add_u32 m0, s50, 32
    v_mov_b32 v0, 132
    s_mov_b64 exec, 1
    global_load_lds_dword v0, s[48:49]
    s_mov_b64 exec, -1
    s_add_u32 s70, s70, 36864
    s_add_u32 m0, s83, 61440
    s_nop 0
    buffer_load_dwordx4 v48, s[24:27], s70 offen lds
    s_add_u32 s70, s70, 36864
    s_add_u32 m0, s83, 65536
    s_nop 0
    buffer_load_dwordx4 v48, s[24:27], s70 offen lds
    s_add_u32 s70, s70, 36864
    s_add_u32 m0, s83, 69632
    s_nop 0
    buffer_load_dwordx4 v48, s[24:27], s70 offen lds
    s_add_u32 m0, s50, 32
    v_mov_b32 v0, 144
    s_mov_b64 exec, 1
    global_load_lds_dword v0, s[48:49]
    s_mov_b64 exec, -1
    s_add_u32 s70, s70, 36864
    s_mov_b32 s89, 0
    s_branch Lw_18
Lw_17:
    s_sleep 1
Lw_18:
    ds_read_b128 v[12:15], v11 offset:0
    s_add_u32 s89, s89, 1
    s_cmp_gt_u32 s89, 1000000
    s_cbranch_scc1 L_end
    s_waitcnt lgkmcnt(0)
    v_min_u32 v12, v12, v13
    v_min3_u32 v12, v12, v14, v15
    s_nop 0
    v_readfirstlane_b32 s64, v12
    s_nop 0
    s_cmp_lt_u32 s64, 1
    s_nop 1
    s_cbranch_scc1 Lw_17
    s_mov_b32 s70, s79
    s_add_u32 m0, s83, 73728
    s_nop 0
    buffer_load_dwordx4 v49, s[28:31], s70 offen lds
    s_add_u32 s70, s70, 36864
    s_add_u32 m0, s83, 77824
    s_nop 0
    buffer_load_dwordx4 v49, s[28:31], s70 offen lds
    s_add_u32 s70, s70, 36864
    s_add_u32 m0, s83, 81920
    s_nop 0
    buffer_load_dwordx4 v49, s[28:31], s70 offen lds
    s_add_u32 s70, s70, 36864
    s_add_u32 m0, s83, 86016
    s_nop 0
    buffer_load_dwordx4 v49, s[28:31], s70 offen lds
    s_add_u32 s70, s70, 36864
    s_add_u32 m0, s83, 90112
    s_nop 0
    buffer_load_dwordx4 v49, s[28:31], s70 offen lds
    s_add_u32 s70, s70, 36864
    s_add_u32 m0, s83, 94208
    s_nop 0
    buffer_load_dwordx4 v49, s[28:31], s70 offen lds
    s_add_u32 s70, s70, 36864
    s_add_u32 m0, s83, 98304
    s_nop 0
    buffer_load_dwordx4 v49, s[28:31], s70 offen lds
    s_add_u32 s70, s70, 36864
    s_add_u32 m0, s83, 102400
    s_nop 0
    buffer_load_dwordx4 v49, s[28:31], s70 offen lds
    s_add_u32 s70, s70, 36864
    s_add_u32 m0, s83, 106496
    s_nop 0
    buffer_load_dwordx4 v49, s[28:31], s70 offen lds
    s_add_u32 s70, s70, 36864
    s_add_u32 m0, s83, 110592
    s_nop 0
    buffer_load_dwordx4 v49, s[28:31], s70 offen lds
    s_add_u32 s70, s70, 36864
    s_add_u32 m0, s83, 114688
    s_nop 0
    buffer_load_dwordx4 v49, s[28:31], s70 offen lds
    s_add_u32 s70, s70, 36864
    s_add_u32 m0, s83, 118784
    s_nop 0
    buffer_load_dwordx4 v49, s[28:31], s70 offen lds
    s_add_u32 s70, s70, 36864
    s_add_u32 m0, s83, 122880
    s_nop 0
    buffer_load_dwordx4 v49, s[28:31], s70 offen lds
    s_add_u32 s70, s70, 36864
    s_add_u32 m0, s83, 126976
    s_nop 0
    buffer_load_dwordx4 v49, s[28:31], s70 offen lds
    s_add_u32 s70, s70, 36864
    s_add_u32 m0, s83, 131072
    s_nop 0
    buffer_load_dwordx4 v49, s[28:31], s70 offen lds
    s_add_u32 s70, s70, 36864
    s_add_u32 m0, s83, 135168
    s_waitcnt vmcnt(52)
    buffer_load_dwordx4 v49, s[28:31], s70 offen lds
    s_add_u32 s70, s70, 36864
    s_add_u32 m0, s83, 139264
    s_nop 0
    buffer_load_dwordx4 v49, s[28:31], s70 offen lds
    s_add_u32 s70, s70, 36864
    s_add_u32 m0, s83, 143360
    s_nop 0
    buffer_load_dwordx4 v49, s[28:31], s70 offen lds
    s_add_u32 s70, s70, 36864
    s_add_u32 m0, s50, 0
    v_mov_b32 v0, 28
    s_mov_b64 exec, 1
    global_load_lds_dword v0, s[48:49]
    s_mov_b64 exec, -1
    s_branch L_h_mlp
L_repack:
    s_sub_u32 s67, s59, 18
    s_lshl_b32 s68, s67, 3
    s_add_u32 s68, s68, s81
    s_lshl_b32 s69, s81, 13
    v_lshrrev_b32 v48, 3, v1
    v_and_b32 v12, 6, v48
    v_and_b32 v49, 7, v1
    v_xor_b32 v49, v49, v12
    v_lshlrev_b32 v49, 4, v49
    s_lshl_b32 s70, s68, 10
    s_and_b32 s71, s70, 0x7fff
    s_add_u32 s71, s71, 114688
    s_mul_i32 s72, s58, 147456
    s_waitcnt lgkmcnt(0)
    s_load_dword s3, s[18:19], 0
    s_barrier
    s_mov_b32 s20, s4
    s_mov_b32 s21, s5
    s_mov_b32 s22, 1179648
    s_mov_b32 s23, 0x20000
    s_mov_b32 s24, s6
    s_mov_b32 s25, s7
    s_mov_b32 s26, 663552
    s_mov_b32 s27, 0x20000
    s_mov_b32 s28, s8
    s_mov_b32 s29, s9
    s_mov_b32 s30, 663552
    s_mov_b32 s31, 0x20000
    s_add_u32 s64, s70, s72
    buffer_load_dwordx4 v[252:255], v4, s[20:23], s64 offen
    s_add_u32 s64, s71, s72
    buffer_load_dwordx4 v[252:255], v4, s[20:23], s64 offen
    s_add_u32 s64, s70, 405504
    buffer_load_dwordx4 v[252:255], v4, s[24:27], s64 offen
    s_add_u32 s64, s64, 114688
    buffer_load_dwordx4 v[252:255], v4, s[24:27], s64 offen
    s_add_u32 s64, s64, 114688
    buffer_load_dwordx4 v[252:255], v4, s[24:27], s64 offen
    s_add_u32 s64, s64, 114688
    s_mov_b32 s32, s10
    s_mov_b32 s33, s11
    s_mov_b32 s34, 5308416
    s_mov_b32 s35, 0x20000
    s_mov_b32 s36, s12
    s_mov_b32 s37, s13
    s_mov_b32 s38, 5308416
    s_mov_b32 s39, 0x20000
    s_mov_b32 s84, 0
    s_mov_b32 s85, 4096
    s_mov_b32 s86, 8192
    s_mov_b32 s87, 12288
    s_mov_b32 s88, 16384
    s_mov_b32 s28, s8
    s_mov_b32 s29, s9
    s_mov_b32 s30, 663552
    s_mov_b32 s31, 0x20000
    s_mov_b32 s40, s14
    s_mov_b32 s41, s15
    s_mov_b32 s42, 1179648
    s_mov_b32 s43, 0x20000
    s_mov_b32 s44, s18
    s_mov_b32 s45, s19
    s_mov_b32 s46, 268435456
    s_mov_b32 s47, 0x20000
    s_add_u32 s52, s18, 917504
    s_addc_u32 s53, s19, 0
    s_mov_b32 s54, 26345472
    s_mov_b32 s55, 0x20000
    v_add_u32 v5, 0x10000, v4
    v_add_u32 v6, 0x20000, v4
    v_min_u32 v8, 17, v1
    v_lshlrev_b32 v8, 7, v8
    s_waitcnt lgkmcnt(0)
    s_waitcnt lgkmcnt(0)
    s_add_u32 s3, s3, 0x10000001
    s_and_b32 s82, s3, 0xff
    s_mul_i32 s56, s3, 0x9e3779b1
    s_xor_b32 s56, s56, 0x5bd1e995
    s_getreg_b32 s65, hwreg(HW_REG_XCC_ID)
    s_and_b32 s65, s65, 15
    s_add_u32 s80, s65, s56
    s_waitcnt vmcnt(0)
    s_mul_i32 s73, s81, 14
    s_add_u32 s73, s73, s67
    s_lshl_b32 s64, s73, 12
    v_lshlrev_b32 v12, 6, v1
    s_cmp_ge_u32 s73, 92
    s_nop 0
    s_cbranch_scc1 Ltc_19
    s_add_u32 s65, s64, s72
    s_add_u32 s65, s65, 917504
    s_lshl_b32 s66, s58, 14
    s_add_u32 s66, s66, s64
    s_add_u32 s66, s66, 245760
    s_cmp_ge_u32 s73, 36
    s_cselect_b32 s65, s66, s65
    s_sub_u32 s66, s73, 40
    s_lshl_b32 s66, s66, 15
    s_lshl_b32 s74, s58, 12
    s_add_u32 s66, s66, s74
    s_add_u32 s66, s66, 655360
    s_cmp_ge_u32 s73, 40
    s_cselect_b32 s65, s66, s65
    s_mul_i32 s66, s58, 165888
    s_add_u32 s66, s66, s64
    s_add_u32 s66, s66, 1900544
    s_cmp_ge_u32 s73, 48
    s_cselect_b32 s65, s66, s65
    s_mul_i32 s66, s58, 12288
    s_add_u32 s66, s66, s64
    s_add_u32 s66, s66, 4294668288
    s_cmp_ge_u32 s73, 89
    s_cselect_b32 s65, s66, s65
    buffer_load_dword v7, v12, s[44:47], s65 offen sc1
Ltc_19:
    buffer_load_dwordx4 v[252:255], v4, s[28:31], s70 offen
    s_add_u32 s70, s70, 114688
    buffer_load_dwordx4 v[252:255], v4, s[28:31], s70 offen
    s_add_u32 s70, s70, 114688
    buffer_load_dwordx4 v[252:255], v4, s[28:31], s70 offen
    s_add_u32 s70, s70, 114688
    buffer_load_dwordx4 v[252:255], v4, s[28:31], s70 offen
    s_add_u32 s70, s70, 114688
    buffer_load_dwordx4 v[252:255], v4, s[28:31], s70 offen
    s_add_u32 s70, s70, 114688
    buffer_load_dwordx4 v[252:255], v4, s[28:31], s70 offen
    s_add_u32 s70, s70, 114688
    s_barrier
    s_cmp_ge_u32 s81, 4
    s_cbranch_scc1 Lnj_20
    s_waitcnt vmcnt(0)
    s_cmp_lt_u32 s59, 20
    s_cbranch_scc1 Lnj_20
    s_sub_u32 s70, s62, 5
    s_mul_i32 s64, s70, 55296
    s_lshl_b32 s65, s57, 5
    s_add_u32 s65, s65, s64
    v_lshrrev_b32 v12, 2, v1
    v_mul_u32_u24 v52, 288, v12
    v_and_b32 v12, 3, v1
    v_lshl_add_u32 v52, v12, 3, v52
    v_add_u32 v53, s65, v52
    v_add_u32 v54, s64, v52
    s_cmp_eq_u32 s70, 2
    s_cselect_b32 s66, 156672, 0
    s_sub_u32 s66, 46080, s66
    v_add_u32 v55, s66, v53
    v_add_u32 v56, s66, v54
    v_mov_b32 v136, 0x3f803f80
    v_mov_b32 v137, 0x3f803f80
    v_mov_b32 v138, 0x3f803f80
    v_mov_b32 v139, 0x3f803f80
    s_mul_i32 s64, s58, 3
    s_add_u32 s64, s64, s70
    s_mul_i32 s64, s64, 2304
    s_mul_i32 s65, s63, 576
    s_add_u32 s64, s64, s65
    s_add_u32 s72, s64, 163840
    s_lshl_b32 s65, s57, 6
    s_add_u32 s71, s72, s65
    v_mov_b32 v16, s82
    s_mov_b32 s73, 0xff
    v_lshlrev_b32 v17, 4, v2
    s_mov_b32 s89, 0
    s_nop 0
    s_branch Lw_22
Lw_21:
    s_sleep 4
Lw_22:
    ds_read_b128 v[12:15], v11 offset:16
    s_add_u32 s89, s89, 1
    s_cmp_gt_u32 s89, 1000000
    s_cbranch_scc1 L_end
    s_waitcnt lgkmcnt(0)
    v_min_u32 v12, v12, v13
    v_min3_u32 v12, v12, v14, v15
    s_nop 0
    v_readfirstlane_b32 s64, v12
    s_nop 0
    s_cmp_lt_u32 s64, 11
    s_nop 1
    s_cbranch_scc1 Lw_21
    ds_read_b64_tr_b16 v[60:61], v53 offset:0
    ds_read_b64_tr_b16 v[62:63], v53 offset:4608
    ds_read_b64_tr_b16 v[64:65], v53 offset:9216
    ds_read_b64_tr_b16 v[66:67], v53 offset:13824
    ds_read_b64_tr_b16 v[68:69], v53 offset:18432
    ds_read_b64_tr_b16 v[70:71], v53 offset:23040
    ds_read_b64_tr_b16 v[72:73], v53 offset:27648
    ds_read_b64_tr_b16 v[74:75], v53 offset:32256
    ds_read_b64_tr_b16 v[76:77], v53 offset:36864
    ds_read_b64_tr_b16 v[78:79], v53 offset:41472
    ds_read_b64_tr_b16 v[80:81], v55 offset:0
    ds_read_b64_tr_b16 v[82:83], v55 offset:4608
    s_waitcnt lgkmcnt(10)
    v_mfma_f32_16x16x32_bf16 v[140:143], v[60:63], v[136:139], 0
    s_waitcnt lgkmcnt(8)
    v_mfma_f32_16x16x32_bf16 v[140:143], v[64:67], v[136:139], v[140:143]
    s_waitcnt lgkmcnt(6)
    v_mfma_f32_16x16x32_bf16 v[140:143], v[68:71], v[136:139], v[140:143]
    s_waitcnt lgkmcnt(4)
    v_mfma_f32_16x16x32_bf16 v[140:143], v[72:75], v[136:139], v[140:143]
    s_waitcnt lgkmcnt(2)
    v_mfma_f32_16x16x32_bf16 v[140:143], v[76:79], v[136:139], v[140:143]
    s_waitcnt lgkmcnt(0)
    v_mfma_f32_16x16x32_bf16 v[140:143], v[80:83], v[136:139], v[140:143]
    ds_read_b64_tr_b16 v[60:61], v53 offset:128
    ds_read_b64_tr_b16 v[62:63], v53 offset:4736
    ds_read_b64_tr_b16 v[64:65], v53 offset:9344
    ds_read_b64_tr_b16 v[66:67], v53 offset:13952
    ds_read_b64_tr_b16 v[68:69], v53 offset:18560
    ds_read_b64_tr_b16 v[70:71], v53 offset:23168
    ds_read_b64_tr_b16 v[72:73], v53 offset:27776
    ds_read_b64_tr_b16 v[74:75], v53 offset:32384
    ds_read_b64_tr_b16 v[76:77], v53 offset:36992
    ds_read_b64_tr_b16 v[78:79], v53 offset:41600
    ds_read_b64_tr_b16 v[80:81], v55 offset:128
    ds_read_b64_tr_b16 v[82:83], v55 offset:4736
    s_waitcnt lgkmcnt(10)
    v_mfma_f32_16x16x32_bf16 v[144:147], v[60:63], v[136:139], 0
    s_waitcnt lgkmcnt(8)
    v_mfma_f32_16x16x32_bf16 v[144:147], v[64:67], v[136:139], v[144:147]
    s_waitcnt lgkmcnt(6)
    v_mfma_f32_16x16x32_bf16 v[144:147], v[68:71], v[136:139], v[144:147]
    s_waitcnt lgkmcnt(4)
    v_mfma_f32_16x16x32_bf16 v[144:147], v[72:75], v[136:139], v[144:147]
    s_waitcnt lgkmcnt(2)
    v_mfma_f32_16x16x32_bf16 v[144:147], v[76:79], v[136:139], v[144:147]
    s_waitcnt lgkmcnt(0)
    v_mfma_f32_16x16x32_bf16 v[144:147], v[80:83], v[136:139], v[144:147]
    ds_read_b64_tr_b16 v[60:61], v54 offset:256
    ds_read_b64_tr_b16 v[62:63], v54 offset:4864
    ds_read_b64_tr_b16 v[64:65], v54 offset:9472
    ds_read_b64_tr_b16 v[66:67], v54 offset:14080
    ds_read_b64_tr_b16 v[68:69], v54 offset:18688
    ds_read_b64_tr_b16 v[70:71], v54 offset:23296
    ds_read_b64_tr_b16 v[72:73], v54 offset:27904
    ds_read_b64_tr_b16 v[74:75], v54 offset:32512
    ds_read_b64_tr_b16 v[76:77], v54 offset:37120
    ds_read_b64_tr_b16 v[78:79], v54 offset:41728
    ds_read_b64_tr_b16 v[80:81], v56 offset:256
    ds_read_b64_tr_b16 v[82:83], v56 offset:4864
    s_waitcnt lgkmcnt(10)
    v_mfma_f32_16x16x32_bf16 v[148:151], v[60:63], v[136:139], 0
    s_waitcnt lgkmcnt(8)
    v_mfma_f32_16x16x32_bf16 v[148:151], v[64:67], v[136:139], v[148:151]
    s_waitcnt lgkmcnt(6)
    v_mfma_f32_16x16x32_bf16 v[148:151], v[68:71], v[136:139], v[148:151]
    s_waitcnt lgkmcnt(4)
    v_mfma_f32_16x16x32_bf16 v[148:151], v[72:75], v[136:139], v[148:151]
    s_waitcnt lgkmcnt(2)
    v_mfma_f32_16x16x32_bf16 v[148:151], v[76:79], v[136:139], v[148:151]
    s_waitcnt lgkmcnt(0)
    v_mfma_f32_16x16x32_bf16 v[148:151], v[80:83], v[136:139], v[148:151]
    v_bfi_b32 v140, s73, v16, v140
    v_bfi_b32 v141, s73, v16, v141
    v_bfi_b32 v142, s73, v16, v142
    v_bfi_b32 v143, s73, v16, v143
    v_bfi_b32 v144, s73, v16, v144
    v_bfi_b32 v145, s73, v16, v145
    v_bfi_b32 v146, s73, v16, v146
    v_bfi_b32 v147, s73, v16, v147
    v_bfi_b32 v148, s73, v16, v148
    v_bfi_b32 v149, s73, v16, v149
    v_bfi_b32 v150, s73, v16, v150
    v_bfi_b32 v151, s73, v16, v151
    s_mov_b32 exec_lo, 0x00010001
    s_mov_b32 exec_hi, 0x00010001
    buffer_store_dwordx4 v[140:143], v17, s[44:47], s71 offen sc1
    buffer_store_dwordx4 v[144:147], v17, s[44:47], s71 offen offset:256 sc1
    buffer_store_dwordx4 v[148:151], v17, s[44:47], s72 offen offset:512 sc1
    s_mov_b64 exec, -1
    s_nop 0
Lnj_20:
    s_mov_b32 s101, 0
    v_mov_b32 v0, 10
    ds_write_b32 v10, v0
    s_waitcnt lgkmcnt(0)
    s_nop 0
L_split:
    s_cmp_ge_u32 s81, 4
    s_cbranch_scc1 L_h_mlp
L_c_mlp:
    s_waitcnt lgkmcnt(0)
    v_add_u32 v16, 20736, v4
    v_add_u32 v17, 147456, v4
    v_min_u32 v18, 7, v1
    v_lshlrev_b32 v18, 7, v18
    s_mul_i32 s64, s57, 13312
    s_add_u32 s64, s64, 101376
    v_add_u32 v19, s64, v4
    s_lshl_b32 s64, s62, 3
    s_lshl_b32 s65, s57, 1
    s_add_u32 s64, s64, s65
    s_mul_i32 s64, s64, 20736
    s_add_u32 s68, s64, 2097152
    s_lshl_b32 s69, s63, 2
    s_and_b32 s64, s63, 2
    s_add_u32 s69, s69, s64
    s_lshl_b32 s69, s69, 10
    s_lshl_b32 s64, s62, 3
    s_lshl_b32 s65, s57, 1
    s_add_u32 s64, s64, s65
    s_lshl_b32 s64, s64, 3
    s_add_u32 s64, s64, s58
    s_mul_i32 s64, s64, 18432
    s_add_u32 s70, s64, 4194304
    s_xor_b32 s64, s63, 0
    s_lshl_b32 s64, s64, 12
    s_add_u32 s71, s64, s70
    s_xor_b32 s64, s63, 1
    s_lshl_b32 s64, s64, 12
    s_add_u32 s72, s64, s70
    s_xor_b32 s64, s63, 2
    s_lshl_b32 s64, s64, 12
    s_add_u32 s73, s64, s70
    s_xor_b32 s64, s63, 3
    s_lshl_b32 s64, s64, 12
    s_add_u32 s74, s64, s70
    s_lshr_b32 s64, s63, 1
    s_xor_b32 s64, s64, 0
    s_add_u32 s64, s64, 16
    s_lshl_b32 s64, s64, 10
    s_add_u32 s75, s64, s70
    s_lshr_b32 s64, s63, 1
    s_xor_b32 s64, s64, 1
    s_add_u32 s64, s64, 16
    s_lshl_b32 s64, s64, 10
    s_add_u32 s76, s64, s70
    s_lshl_b32 s64, s62, 3
    s_add_u32 s64, s64, s58
    s_lshl_b32 s64, s64, 2
    s_add_u32 s64, s64, s57
    s_lshl_b32 s64, s64, 10
    s_add_u32 s77, s64, 655360
    s_lshl_b32 s64, s62, 2
    s_add_u32 s64, s64, s57
    s_mul_i32 s64, s64, 3072
    s_add_u32 s78, s64, 65536
    v_lshrrev_b32 v12, 2, v1
    v_mul_u32_u24 v5, 288, v12
    v_and_b32 v12, 3, v1
    v_lshl_add_u32 v5, v12, 3, v5
    v_add_u32 v6, 55296, v5
    s_lshl_b32 s64, s69, 0
    s_lshr_b32 s64, s64, 3
    v_add_u32 v8, s64, v8
    v_subrev_u32 v12, 2304, v8
    v_min_u32 v8, v8, v12
    s_lshr_b32 s66, s69, 11
    s_mul_i32 s64, s66, 2304
    s_add_u32 s92, s64, s68
    s_add_u32 s66, s66, 1
    s_sub_u32 s65, s66, 9
    s_min_u32 s66, s66, s65
    s_mul_i32 s64, s66, 2304
    s_add_u32 s93, s64, s68
    s_add_u32 s66, s66, 1
    s_sub_u32 s65, s66, 9
    s_min_u32 s66, s66, s65
    s_mul_i32 s64, s66, 2304
    s_add_u32 s94, s64, s68
    s_add_u32 s66, s66, 1
    s_sub_u32 s65, s66, 9
    s_min_u32 s66, s66, s65
    s_mul_i32 s64, s66, 2304
    s_add_u32 s95, s64, s68
    s_add_u32 s66, s66, 1
    s_sub_u32 s65, s66, 9
    s_min_u32 s66, s66, s65
    s_mul_i32 s64, s66, 2304
    s_add_u32 s96, s64, s68
    s_add_u32 s66, s66, 1
    s_sub_u32 s65, s66, 9
    s_min_u32 s66, s66, s65
    s_mul_i32 s64, s66, 2304
    s_add_u32 s97, s64, s68
    s_add_u32 s66, s66, 1
    s_sub_u32 s65, s66, 9
    s_min_u32 s66, s66, s65
    s_mul_i32 s64, s66, 2304
    s_add_u32 s98, s64, s68
    s_add_u32 s66, s66, 1
    s_sub_u32 s65, s66, 9
    s_min_u32 s66, s66, s65
    s_mul_i32 s64, s66, 2304
    s_add_u32 s99, s64, s68
    s_add_u32 s66, s66, 1
    s_sub_u32 s65, s66, 9
    s_min_u32 s66, s66, s65
    s_mul_i32 s64, s66, 2304
    s_add_u32 s100, s64, s68
    s_add_u32 s66, s66, 1
    s_sub_u32 s65, s66, 9
    s_min_u32 s66, s66, s65
    v_lshlrev_b32 v7, 2, v1
    v_add_u32 v19, 20736, v7
    s_mov_b32 s89, 0
    s_nop 0
    s_branch Lw_24
Lw_23:
    s_sleep 2
Lw_24:
    ds_read_b128 v[12:15], v11 offset:16
    s_add_u32 s89, s89, 1
    s_cmp_gt_u32 s89, 1000000
    s_cbranch_scc1 L_end
    s_waitcnt lgkmcnt(0)
    v_min_u32 v12, v12, v13
    v_min3_u32 v12, v12, v14, v15
    s_nop 0
    v_readfirstlane_b32 s64, v12
    s_nop 0
    s_cmp_lt_u32 s64, 12
    s_nop 1
    s_cbranch_scc1 Lw_23
    s_mov_b32 s89, 0
    s_branch Lpoll_26
Lpoll_25:
    s_sleep 1
Lpoll_26:
    buffer_load_ubyte v12, v8, s[44:47], s78 offen sc1
    s_add_u32 s89, s89, 1
    s_cmp_gt_u32 s89, 100000
    s_cbranch_scc1 L_end
    s_waitcnt vmcnt(0)
    v_cmp_ne_u32 vcc, s82, v12
    s_cmp_eq_u32 s101, 0
    s_nop 2
    s_cbranch_scc1 Lff_27
    v_mov_b32 v12, s80
    v_mov_b32 v13, s80
    v_mov_b32 v14, s80
    v_mov_b32 v15, s80
    s_add_u32 s65, s101, 25165824
    s_mov_b64 exec, 0xff
    buffer_store_dwordx4 v[12:15], v4, s[44:47], s65 offen sc1
    s_mov_b64 exec, -1
    s_mov_b32 s101, 0
Lff_27:
    s_and_b32 s66, vcc_lo, 0x3ffff
    s_and_b32 vcc_lo, vcc_lo, 15
    s_cbranch_scc1 Lpoll_25
    buffer_load_dword v184, v7, s[44:47], s92 offen offset:2048 sc1
    buffer_load_dword v185, v19, s[44:47], s92 offen offset:2048 sc1
    buffer_load_dwordx4 v[112:115], v4, s[44:47], s92 offen offset:0 sc1
    buffer_load_dwordx4 v[116:119], v16, s[44:47], s92 offen offset:0 sc1
    buffer_load_dwordx4 v[120:123], v4, s[44:47], s92 offen offset:1024 sc1
    buffer_load_dwordx4 v[124:127], v16, s[44:47], s92 offen offset:1024 sc1
    buffer_load_dword v200, v7, s[44:47], s93 offen offset:2048 sc1
    buffer_load_dword v201, v19, s[44:47], s93 offen offset:2048 sc1
    buffer_load_dwordx4 v[128:131], v4, s[44:47], s93 offen offset:0 sc1
    buffer_load_dwordx4 v[132:135], v16, s[44:47], s93 offen offset:0 sc1
    buffer_load_dwordx4 v[136:139], v4, s[44:47], s93 offen offset:1024 sc1
    buffer_load_dwordx4 v[140:143], v16, s[44:47], s93 offen offset:1024 sc1
    s_cmp_lg_u32 s81, 3
    s_cbranch_scc1 Lfs_28
    s_getreg_b32 s65, hwreg(HW_REG_XCC_ID)
    s_and_b32 s65, s65, 15
    s_add_u32 s65, s65, s56
    s_lshl_b32 s64, s58, 5
    s_add_u32 s64, s64, s59
    s_lshl_b32 s64, s64, 7
    s_add_u32 s64, s64, 4096
    v_mov_b32 v12, s56
    v_mov_b32 v13, s65
    v_mov_b32 v14, s56
    v_mov_b32 v15, s65
    s_mov_b64 exec, 0xff
    buffer_store_dwordx4 v[12:15], v4, s[44:47], s64 offen sc1
    s_mov_b64 exec, -1
    s_nop 0
Lfs_28:
    s_cmp_eq_u32 s66, 0
    s_cbranch_scc1 Lh2_29
    s_mov_b32 s89, 0
    s_branch Lpoll_31
Lpoll_30:
    s_sleep 1
Lpoll_31:
    buffer_load_ubyte v12, v8, s[44:47], s78 offen sc1
    s_add_u32 s89, s89, 1
    s_cmp_gt_u32 s89, 100000
    s_cbranch_scc1 L_end
    s_waitcnt vmcnt(0)
    v_cmp_ne_u32 vcc, s82, v12
    s_nop 0
    s_and_b32 s66, vcc_lo, 0x3ffff
    s_and_b32 vcc_lo, vcc_lo, 262143
    s_nop 0
    s_cbranch_scc1 Lpoll_30
Lh2_29:
    v_add_u32 v8, 110592, v5
    buffer_load_dword v216, v7, s[44:47], s94 offen offset:2048 sc1
    buffer_load_dword v217, v19, s[44:47], s94 offen offset:2048 sc1
    buffer_load_dwordx4 v[144:147], v4, s[44:47], s94 offen offset:0 sc1
    buffer_load_dwordx4 v[148:151], v16, s[44:47], s94 offen offset:0 sc1
    buffer_load_dwordx4 v[152:155], v4, s[44:47], s94 offen offset:1024 sc1
    buffer_load_dwordx4 v[156:159], v16, s[44:47], s94 offen offset:1024 sc1
    buffer_load_dword v232, v7, s[44:47], s95 offen offset:2048 sc1
    buffer_load_dword v233, v19, s[44:47], s95 offen offset:2048 sc1
    buffer_load_dwordx4 v[160:163], v4, s[44:47], s95 offen offset:0 sc1
    buffer_load_dwordx4 v[164:167], v16, s[44:47], s95 offen offset:0 sc1
    buffer_load_dwordx4 v[168:171], v4, s[44:47], s95 offen offset:1024 sc1
    buffer_load_dwordx4 v[172:175], v16, s[44:47], s95 offen offset:1024 sc1
    s_waitcnt vmcnt(18)
    v_bitop3_b32 v184, v184, v112, v113 bitop3:0x96
    v_bitop3_b32 v184, v184, v114, v115 bitop3:0x96
    v_bitop3_b32 v184, v184, v120, v121 bitop3:0x96
    v_bitop3_b32 v184, v184, v122, v123 bitop3:0x96
    v_bitop3_b32 v185, v185, v116, v117 bitop3:0x96
    v_bitop3_b32 v185, v185, v118, v119 bitop3:0x96
    v_bitop3_b32 v185, v185, v124, v125 bitop3:0x96
    v_bitop3_b32 v185, v185, v126, v127 bitop3:0x96
    v_bitop3_b32 v184, v184, v185, s56 bitop3:0x7e
    v_cmp_eq_u32 vcc, 0, v184
    s_nop 0
    s_cmp_eq_u64 vcc, -1
    s_cbranch_scc0 Ls_s32
Ls_r32:
    s_add_u32 m0, s50, 0
    v_mov_b32 v0, 44
    s_mov_b64 exec, 1
    global_load_lds_dword v0, s[48:49]
    s_mov_b64 exec, -1
    ds_read_b64_tr_b16 v[20:21], v5 offset:0
    ds_read_b64_tr_b16 v[22:23], v5 offset:4608
    ds_read_b64_tr_b16 v[24:25], v5 offset:32
    ds_read_b64_tr_b16 v[26:27], v5 offset:4640
    ds_read_b64_tr_b16 v[28:29], v5 offset:64
    ds_read_b64_tr_b16 v[30:31], v5 offset:4672
    ds_read_b64_tr_b16 v[32:33], v5 offset:96
    ds_read_b64_tr_b16 v[34:35], v5 offset:4704
    ds_read_b64_tr_b16 v[36:37], v5 offset:128
    ds_read_b64_tr_b16 v[38:39], v5 offset:4736
    s_waitcnt lgkmcnt(8)
    v_mfma_f32_16x16x32_bf16 v[40:43], v[20:23], v[112:115], 0
    buffer_load_dword v248, v7, s[44:47], s96 offen offset:2048 sc1
    v_mfma_f32_16x16x32_bf16 v[44:47], v[20:23], v[116:119], 0
    s_waitcnt lgkmcnt(6)
    v_mfma_f32_16x16x32_bf16 v[48:51], v[24:27], v[112:115], 0
    ds_read_b64_tr_b16 v[20:21], v5 offset:160
    buffer_load_dword v249, v19, s[44:47], s96 offen offset:2048 sc1
    v_mfma_f32_16x16x32_bf16 v[52:55], v[24:27], v[116:119], 0
    ds_read_b64_tr_b16 v[22:23], v5 offset:4768
    s_waitcnt lgkmcnt(6)
    v_mfma_f32_16x16x32_bf16 v[56:59], v[28:31], v[112:115], 0
    ds_read_b64_tr_b16 v[24:25], v5 offset:192
    buffer_load_dwordx4 v[176:179], v4, s[44:47], s96 offen offset:0 sc1
    v_mfma_f32_16x16x32_bf16 v[60:63], v[28:31], v[116:119], 0
    ds_read_b64_tr_b16 v[26:27], v5 offset:4800
    s_waitcnt lgkmcnt(6)
    v_mfma_f32_16x16x32_bf16 v[64:67], v[32:35], v[112:115], 0
    ds_read_b64_tr_b16 v[28:29], v5 offset:224
    buffer_load_dwordx4 v[180:183], v16, s[44:47], s96 offen offset:0 sc1
    v_mfma_f32_16x16x32_bf16 v[68:71], v[32:35], v[116:119], 0
    ds_read_b64_tr_b16 v[30:31], v5 offset:4832
    s_waitcnt lgkmcnt(6)
    v_mfma_f32_16x16x32_bf16 v[72:75], v[36:39], v[112:115], 0
    ds_read_b64_tr_b16 v[32:33], v5 offset:256
    buffer_load_dwordx4 v[184:187], v4, s[44:47], s96 offen offset:1024 sc1
    v_mfma_f32_16x16x32_bf16 v[76:79], v[36:39], v[116:119], 0
    ds_read_b64_tr_b16 v[34:35], v5 offset:4864
    s_waitcnt lgkmcnt(6)
    v_mfma_f32_16x16x32_bf16 v[80:83], v[20:23], v[112:115], 0
    ds_read_b64_tr_b16 v[36:37], v5 offset:9216
    buffer_load_dwordx4 v[188:191], v16, s[44:47], s96 offen offset:1024 sc1
    v_mfma_f32_16x16x32_bf16 v[84:87], v[20:23], v[116:119], 0
    ds_read_b64_tr_b16 v[38:39], v5 offset:13824
    s_waitcnt lgkmcnt(6)
    v_mfma_f32_16x16x32_bf16 v[88:91], v[24:27], v[112:115], 0
    ds_read_b64_tr_b16 v[20:21], v5 offset:9248
    v_mfma_f32_16x16x32_bf16 v[92:95], v[24:27], v[116:119], 0
    ds_read_b64_tr_b16 v[22:23], v5 offset:13856
    s_waitcnt vmcnt(19)
    s_waitcnt lgkmcnt(6)
    v_mfma_f32_16x16x32_bf16 v[96:99], v[28:31], v[112:115], 0
    ds_read_b64_tr_b16 v[24:25], v5 offset:9280
    v_bitop3_b32 v200, v200, v128, v129 bitop3:0x96
    v_mfma_f32_16x16x32_bf16 v[100:103], v[28:31], v[116:119], 0
    ds_read_b64_tr_b16 v[26:27], v5 offset:13888
    s_waitcnt lgkmcnt(6)
    v_mfma_f32_16x16x32_bf16 v[104:107], v[32:35], v[112:115], 0
    ds_read_b64_tr_b16 v[28:29], v5 offset:9312
    v_bitop3_b32 v200, v200, v130, v131 bitop3:0x96
    v_mfma_f32_16x16x32_bf16 v[108:111], v[32:35], v[116:119], 0
    ds_read_b64_tr_b16 v[30:31], v5 offset:13920
    s_waitcnt lgkmcnt(6)
    v_mfma_f32_16x16x32_bf16 v[40:43], v[36:39], v[120:123], v[40:43]
    ds_read_b64_tr_b16 v[32:33], v5 offset:9344
    v_bitop3_b32 v200, v200, v136, v137 bitop3:0x96
    v_mfma_f32_16x16x32_bf16 v[44:47], v[36:39], v[124:127], v[44:47]
    ds_read_b64_tr_b16 v[34:35], v5 offset:13952
    ds_read_b64_tr_b16 v[112:113], v5 offset:9376
    ds_read_b64_tr_b16 v[114:115], v5 offset:13984
    s_waitcnt lgkmcnt(8)
    v_mfma_f32_16x16x32_bf16 v[48:51], v[20:23], v[120:123], v[48:51]
    ds_read_b64_tr_b16 v[116:117], v5 offset:9408
    v_bitop3_b32 v200, v200, v138, v139 bitop3:0x96
    v_mfma_f32_16x16x32_bf16 v[52:55], v[20:23], v[124:127], v[52:55]
    ds_read_b64_tr_b16 v[118:119], v5 offset:14016
    s_waitcnt lgkmcnt(8)
    v_mfma_f32_16x16x32_bf16 v[56:59], v[24:27], v[120:123], v[56:59]
    ds_read_b64_tr_b16 v[36:37], v5 offset:9440
    v_bitop3_b32 v201, v201, v132, v133 bitop3:0x96
    v_mfma_f32_16x16x32_bf16 v[60:63], v[24:27], v[124:127], v[60:63]
    ds_read_b64_tr_b16 v[38:39], v5 offset:14048
    ds_read_b64_tr_b16 v[20:21], v5 offset:9472
    ds_read_b64_tr_b16 v[22:23], v5 offset:14080
    s_waitcnt lgkmcnt(10)
    v_mfma_f32_16x16x32_bf16 v[64:67], v[28:31], v[120:123], v[64:67]
    ds_read_b64_tr_b16 v[24:25], v5 offset:18432
    v_bitop3_b32 v201, v201, v134, v135 bitop3:0x96
    v_mfma_f32_16x16x32_bf16 v[68:71], v[28:31], v[124:127], v[68:71]
    ds_read_b64_tr_b16 v[26:27], v5 offset:23040
    s_waitcnt lgkmcnt(10)
    v_mfma_f32_16x16x32_bf16 v[72:75], v[32:35], v[120:123], v[72:75]
    ds_read_b64_tr_b16 v[28:29], v5 offset:18464
    v_bitop3_b32 v201, v201, v140, v141 bitop3:0x96
    v_mfma_f32_16x16x32_bf16 v[76:79], v[32:35], v[124:127], v[76:79]
    ds_read_b64_tr_b16 v[30:31], v5 offset:23072
    s_waitcnt lgkmcnt(10)
    v_mfma_f32_16x16x32_bf16 v[80:83], v[112:115], v[120:123], v[80:83]
    ds_read_b64_tr_b16 v[32:33], v5 offset:18496
    v_bitop3_b32 v201, v201, v142, v143 bitop3:0x96
    v_mfma_f32_16x16x32_bf16 v[84:87], v[112:115], v[124:127], v[84:87]
    ds_read_b64_tr_b16 v[34:35], v5 offset:23104
    s_waitcnt lgkmcnt(10)
    v_mfma_f32_16x16x32_bf16 v[88:91], v[116:119], v[120:123], v[88:91]
    ds_read_b64_tr_b16 v[112:113], v5 offset:18528
    v_bitop3_b32 v200, v200, v201, s56 bitop3:0x7e
    v_mfma_f32_16x16x32_bf16 v[92:95], v[116:119], v[124:127], v[92:95]
    ds_read_b64_tr_b16 v[114:115], v5 offset:23136
    s_waitcnt lgkmcnt(10)
    v_mfma_f32_16x16x32_bf16 v[96:99], v[36:39], v[120:123], v[96:99]
    ds_read_b64_tr_b16 v[116:117], v5 offset:18560
    v_cmp_eq_u32 vcc, 0, v200
    v_mfma_f32_16x16x32_bf16 v[100:103], v[36:39], v[124:127], v[100:103]
    ds_read_b64_tr_b16 v[118:119], v5 offset:23168
    s_waitcnt lgkmcnt(10)
    v_mfma_f32_16x16x32_bf16 v[104:107], v[20:23], v[120:123], v[104:107]
    ds_read_b64_tr_b16 v[36:37], v5 offset:18592
    s_cmp_eq_u64 vcc, -1
    s_cbranch_scc0 Ls_s33
Ls_r33:
    v_mfma_f32_16x16x32_bf16 v[108:111], v[20:23], v[124:127], v[108:111]
    ds_read_b64_tr_b16 v[38:39], v5 offset:23200
    s_waitcnt lgkmcnt(10)
    v_mfma_f32_16x16x32_bf16 v[40:43], v[24:27], v[128:131], v[40:43]
    ds_read_b64_tr_b16 v[20:21], v5 offset:18624
    buffer_load_dword v120, v7, s[44:47], s97 offen offset:2048 sc1
    v_mfma_f32_16x16x32_bf16 v[44:47], v[24:27], v[132:135], v[44:47]
    ds_read_b64_tr_b16 v[22:23], v5 offset:23232
    s_waitcnt lgkmcnt(10)
    v_mfma_f32_16x16x32_bf16 v[48:51], v[28:31], v[128:131], v[48:51]
    ds_read_b64_tr_b16 v[24:25], v5 offset:18656
    buffer_load_dword v121, v19, s[44:47], s97 offen offset:2048 sc1
    v_mfma_f32_16x16x32_bf16 v[52:55], v[28:31], v[132:135], v[52:55]
    ds_read_b64_tr_b16 v[26:27], v5 offset:23264
    s_waitcnt lgkmcnt(10)
    v_mfma_f32_16x16x32_bf16 v[56:59], v[32:35], v[128:131], v[56:59]
    ds_read_b64_tr_b16 v[28:29], v5 offset:18688
    buffer_load_dwordx4 v[192:195], v4, s[44:47], s97 offen offset:0 sc1
    v_mfma_f32_16x16x32_bf16 v[60:63], v[32:35], v[132:135], v[60:63]
    ds_read_b64_tr_b16 v[30:31], v5 offset:23296
    s_waitcnt lgkmcnt(10)
    v_mfma_f32_16x16x32_bf16 v[64:67], v[112:115], v[128:131], v[64:67]
    ds_read_b64_tr_b16 v[32:33], v5 offset:27648
    buffer_load_dwordx4 v[196:199], v16, s[44:47], s97 offen offset:0 sc1
    v_mfma_f32_16x16x32_bf16 v[68:71], v[112:115], v[132:135], v[68:71]
    ds_read_b64_tr_b16 v[34:35], v5 offset:32256
    s_waitcnt lgkmcnt(10)
    v_mfma_f32_16x16x32_bf16 v[72:75], v[116:119], v[128:131], v[72:75]
    ds_read_b64_tr_b16 v[112:113], v5 offset:27680
    buffer_load_dwordx4 v[200:203], v4, s[44:47], s97 offen offset:1024 sc1
    v_mfma_f32_16x16x32_bf16 v[76:79], v[116:119], v[132:135], v[76:79]
    ds_read_b64_tr_b16 v[114:115], v5 offset:32288
    s_waitcnt lgkmcnt(10)
    v_mfma_f32_16x16x32_bf16 v[80:83], v[36:39], v[128:131], v[80:83]
    ds_read_b64_tr_b16 v[116:117], v5 offset:27712
    buffer_load_dwordx4 v[204:207], v16, s[44:47], s97 offen offset:1024 sc1
    v_mfma_f32_16x16x32_bf16 v[84:87], v[36:39], v[132:135], v[84:87]
    ds_read_b64_tr_b16 v[118:119], v5 offset:32320
    s_waitcnt lgkmcnt(10)
    v_mfma_f32_16x16x32_bf16 v[88:91], v[20:23], v[128:131], v[88:91]
    ds_read_b64_tr_b16 v[36:37], v5 offset:27744
    v_mfma_f32_16x16x32_bf16 v[92:95], v[20:23], v[132:135], v[92:95]
    ds_read_b64_tr_b16 v[38:39], v5 offset:32352
    s_waitcnt vmcnt(19)
    s_waitcnt lgkmcnt(10)
    v_mfma_f32_16x16x32_bf16 v[96:99], v[24:27], v[128:131], v[96:99]
    ds_read_b64_tr_b16 v[20:21], v5 offset:27776
    v_bitop3_b32 v216, v216, v144, v145 bitop3:0x96
    v_mfma_f32_16x16x32_bf16 v[100:103], v[24:27], v[132:135], v[100:103]
    ds_read_b64_tr_b16 v[22:23], v5 offset:32384
    s_waitcnt lgkmcnt(10)
    v_mfma_f32_16x16x32_bf16 v[104:107], v[28:31], v[128:131], v[104:107]
    ds_read_b64_tr_b16 v[24:25], v5 offset:27808
    v_bitop3_b32 v216, v216, v146, v147 bitop3:0x96
    v_mfma_f32_16x16x32_bf16 v[108:111], v[28:31], v[132:135], v[108:111]
    ds_read_b64_tr_b16 v[26:27], v5 offset:32416
    s_waitcnt lgkmcnt(10)
    v_mfma_f32_16x16x32_bf16 v[40:43], v[32:35], v[136:139], v[40:43]
    ds_read_b64_tr_b16 v[28:29], v5 offset:27840
    v_bitop3_b32 v216, v216, v152, v153 bitop3:0x96
    v_mfma_f32_16x16x32_bf16 v[44:47], v[32:35], v[140:143], v[44:47]
    ds_read_b64_tr_b16 v[30:31], v5 offset:32448
    s_waitcnt lgkmcnt(10)
    v_mfma_f32_16x16x32_bf16 v[48:51], v[112:115], v[136:139], v[48:51]
    ds_read_b64_tr_b16 v[32:33], v5 offset:27872
    v_bitop3_b32 v216, v216, v154, v155 bitop3:0x96
    v_mfma_f32_16x16x32_bf16 v[52:55], v[112:115], v[140:143], v[52:55]
    ds_read_b64_tr_b16 v[34:35], v5 offset:32480
    s_waitcnt lgkmcnt(10)
    v_mfma_f32_16x16x32_bf16 v[56:59], v[116:119], v[136:139], v[56:59]
    ds_read_b64_tr_b16 v[112:113], v5 offset:27904
    v_bitop3_b32 v217, v217, v148, v149 bitop3:0x96
    v_mfma_f32_16x16x32_bf16 v[60:63], v[116:119], v[140:143], v[60:63]
    ds_read_b64_tr_b16 v[114:115], v5 offset:32512
    s_waitcnt lgkmcnt(10)
    v_mfma_f32_16x16x32_bf16 v[64:67], v[36:39], v[136:139], v[64:67]
    ds_read_b64_tr_b16 v[116:117], v5 offset:36864
    v_bitop3_b32 v217, v217, v150, v151 bitop3:0x96
    v_mfma_f32_16x16x32_bf16 v[68:71], v[36:39], v[140:143], v[68:71]
    ds_read_b64_tr_b16 v[118:119], v5 offset:41472
    s_waitcnt lgkmcnt(10)
    v_mfma_f32_16x16x32_bf16 v[72:75], v[20:23], v[136:139], v[72:75]
    ds_read_b64_tr_b16 v[36:37], v5 offset:36896
    v_bitop3_b32 v217, v217, v156, v157 bitop3:0x96
    v_mfma_f32_16x16x32_bf16 v[76:79], v[20:23], v[140:143], v[76:79]
    ds_read_b64_tr_b16 v[38:39], v5 offset:41504
    s_waitcnt lgkmcnt(10)
    v_mfma_f32_16x16x32_bf16 v[80:83], v[24:27], v[136:139], v[80:83]
    ds_read_b64_tr_b16 v[20:21], v5 offset:36928
    v_bitop3_b32 v217, v217, v158, v159 bitop3:0x96
    v_mfma_f32_16x16x32_bf16 v[84:87], v[24:27], v[140:143], v[84:87]
    ds_read_b64_tr_b16 v[22:23], v5 offset:41536
    s_waitcnt lgkmcnt(10)
    v_mfma_f32_16x16x32_bf16 v[88:91], v[28:31], v[136:139], v[88:91]
    ds_read_b64_tr_b16 v[24:25], v5 offset:36960
    v_bitop3_b32 v216, v216, v217, s56 bitop3:0x7e
    v_mfma_f32_16x16x32_bf16 v[92:95], v[28:31], v[140:143], v[92:95]
    ds_read_b64_tr_b16 v[26:27], v5 offset:41568
    s_waitcnt lgkmcnt(10)
    v_mfma_f32_16x16x32_bf16 v[96:99], v[32:35], v[136:139], v[96:99]
    ds_read_b64_tr_b16 v[28:29], v5 offset:36992
    v_cmp_eq_u32 vcc, 0, v216
    v_mfma_f32_16x16x32_bf16 v[100:103], v[32:35], v[140:143], v[100:103]
    ds_read_b64_tr_b16 v[30:31], v5 offset:41600
    s_waitcnt lgkmcnt(10)
    v_mfma_f32_16x16x32_bf16 v[104:107], v[112:115], v[136:139], v[104:107]
    ds_read_b64_tr_b16 v[32:33], v5 offset:37024
    s_cmp_eq_u64 vcc, -1
    s_cbranch_scc0 Ls_s34
Ls_r34:
    v_mfma_f32_16x16x32_bf16 v[108:111], v[112:115], v[140:143], v[108:111]
    ds_read_b64_tr_b16 v[34:35], v5 offset:41632
    s_waitcnt lgkmcnt(10)
    v_mfma_f32_16x16x32_bf16 v[40:43], v[116:119], v[144:147], v[40:43]
    ds_read_b64_tr_b16 v[112:113], v5 offset:37056
    buffer_load_dword v128, v7, s[44:47], s98 offen offset:2048 sc1
    v_mfma_f32_16x16x32_bf16 v[44:47], v[116:119], v[148:151], v[44:47]
    ds_read_b64_tr_b16 v[114:115], v5 offset:41664
    s_waitcnt lgkmcnt(10)
    v_mfma_f32_16x16x32_bf16 v[48:51], v[36:39], v[144:147], v[48:51]
    ds_read_b64_tr_b16 v[116:117], v5 offset:37088
    buffer_load_dword v129, v19, s[44:47], s98 offen offset:2048 sc1
    v_mfma_f32_16x16x32_bf16 v[52:55], v[36:39], v[148:151], v[52:55]
    ds_read_b64_tr_b16 v[118:119], v5 offset:41696
    s_waitcnt lgkmcnt(10)
    v_mfma_f32_16x16x32_bf16 v[56:59], v[20:23], v[144:147], v[56:59]
    ds_read_b64_tr_b16 v[36:37], v5 offset:37120
    buffer_load_dwordx4 v[208:211], v4, s[44:47], s98 offen offset:0 sc1
    v_mfma_f32_16x16x32_bf16 v[60:63], v[20:23], v[148:151], v[60:63]
    ds_read_b64_tr_b16 v[38:39], v5 offset:41728
    s_waitcnt lgkmcnt(10)
    v_mfma_f32_16x16x32_bf16 v[64:67], v[24:27], v[144:147], v[64:67]
    ds_read_b64_tr_b16 v[20:21], v5 offset:46080
    buffer_load_dwordx4 v[212:215], v16, s[44:47], s98 offen offset:0 sc1
    v_mfma_f32_16x16x32_bf16 v[68:71], v[24:27], v[148:151], v[68:71]
    ds_read_b64_tr_b16 v[22:23], v5 offset:50688
    s_waitcnt lgkmcnt(10)
    v_mfma_f32_16x16x32_bf16 v[72:75], v[28:31], v[144:147], v[72:75]
    ds_read_b64_tr_b16 v[24:25], v5 offset:46112
    buffer_load_dwordx4 v[216:219], v4, s[44:47], s98 offen offset:1024 sc1
    v_mfma_f32_16x16x32_bf16 v[76:79], v[28:31], v[148:151], v[76:79]
    ds_read_b64_tr_b16 v[26:27], v5 offset:50720
    s_waitcnt lgkmcnt(10)
    v_mfma_f32_16x16x32_bf16 v[80:83], v[32:35], v[144:147], v[80:83]
    ds_read_b64_tr_b16 v[28:29], v5 offset:46144
    buffer_load_dwordx4 v[220:223], v16, s[44:47], s98 offen offset:1024 sc1
    v_mfma_f32_16x16x32_bf16 v[84:87], v[32:35], v[148:151], v[84:87]
    ds_read_b64_tr_b16 v[30:31], v5 offset:50752
    s_waitcnt lgkmcnt(10)
    v_mfma_f32_16x16x32_bf16 v[88:91], v[112:115], v[144:147], v[88:91]
    ds_read_b64_tr_b16 v[32:33], v5 offset:46176
    v_mfma_f32_16x16x32_bf16 v[92:95], v[112:115], v[148:151], v[92:95]
    ds_read_b64_tr_b16 v[34:35], v5 offset:50784
    s_waitcnt vmcnt(19)
    s_waitcnt lgkmcnt(10)
    v_mfma_f32_16x16x32_bf16 v[96:99], v[116:119], v[144:147], v[96:99]
    ds_read_b64_tr_b16 v[112:113], v5 offset:46208
    v_bitop3_b32 v232, v232, v160, v161 bitop3:0x96
    v_mfma_f32_16x16x32_bf16 v[100:103], v[116:119], v[148:151], v[100:103]
    ds_read_b64_tr_b16 v[114:115], v5 offset:50816
    s_waitcnt lgkmcnt(10)
    v_mfma_f32_16x16x32_bf16 v[104:107], v[36:39], v[144:147], v[104:107]
    ds_read_b64_tr_b16 v[116:117], v5 offset:46240
    v_bitop3_b32 v232, v232, v162, v163 bitop3:0x96
    v_mfma_f32_16x16x32_bf16 v[108:111], v[36:39], v[148:151], v[108:111]
    ds_read_b64_tr_b16 v[118:119], v5 offset:50848
    s_add_u32 m0, s50, 0
    v_mov_b32 v0, 48
    s_mov_b64 exec, 1
    global_load_lds_dword v0, s[48:49]
    s_mov_b64 exec, -1
    s_waitcnt lgkmcnt(10)
    v_mfma_f32_16x16x32_bf16 v[40:43], v[20:23], v[152:155], v[40:43]
    ds_read_b64_tr_b16 v[36:37], v5 offset:46272
    v_bitop3_b32 v232, v232, v168, v169 bitop3:0x96
    v_mfma_f32_16x16x32_bf16 v[44:47], v[20:23], v[156:159], v[44:47]
    ds_read_b64_tr_b16 v[38:39], v5 offset:50880
    s_waitcnt lgkmcnt(10)
    v_mfma_f32_16x16x32_bf16 v[48:51], v[24:27], v[152:155], v[48:51]
    ds_read_b64_tr_b16 v[20:21], v5 offset:46304
    v_bitop3_b32 v232, v232, v170, v171 bitop3:0x96
    v_mfma_f32_16x16x32_bf16 v[52:55], v[24:27], v[156:159], v[52:55]
    ds_read_b64_tr_b16 v[22:23], v5 offset:50912
    s_waitcnt lgkmcnt(10)
    v_mfma_f32_16x16x32_bf16 v[56:59], v[28:31], v[152:155], v[56:59]
    ds_read_b64_tr_b16 v[24:25], v5 offset:46336
    v_bitop3_b32 v233, v233, v164, v165 bitop3:0x96
    v_mfma_f32_16x16x32_bf16 v[60:63], v[28:31], v[156:159], v[60:63]
    ds_read_b64_tr_b16 v[26:27], v5 offset:50944
    s_waitcnt lgkmcnt(10)
    v_mfma_f32_16x16x32_bf16 v[64:67], v[32:35], v[152:155], v[64:67]
    ds_read_b64_tr_b16 v[28:29], v6 offset:0
    v_bitop3_b32 v233, v233, v166, v167 bitop3:0x96
    v_mfma_f32_16x16x32_bf16 v[68:71], v[32:35], v[156:159], v[68:71]
    ds_read_b64_tr_b16 v[30:31], v6 offset:4608
    s_waitcnt lgkmcnt(10)
    v_mfma_f32_16x16x32_bf16 v[72:75], v[112:115], v[152:155], v[72:75]
    ds_read_b64_tr_b16 v[32:33], v6 offset:32
    v_bitop3_b32 v233, v233, v172, v173 bitop3:0x96
    v_mfma_f32_16x16x32_bf16 v[76:79], v[112:115], v[156:159], v[76:79]
    ds_read_b64_tr_b16 v[34:35], v6 offset:4640
    s_waitcnt lgkmcnt(10)
    v_mfma_f32_16x16x32_bf16 v[80:83], v[116:119], v[152:155], v[80:83]
    ds_read_b64_tr_b16 v[112:113], v6 offset:64
    v_bitop3_b32 v233, v233, v174, v175 bitop3:0x96
    v_mfma_f32_16x16x32_bf16 v[84:87], v[116:119], v[156:159], v[84:87]
    ds_read_b64_tr_b16 v[114:115], v6 offset:4672
    s_waitcnt lgkmcnt(10)
    v_mfma_f32_16x16x32_bf16 v[88:91], v[36:39], v[152:155], v[88:91]
    ds_read_b64_tr_b16 v[116:117], v6 offset:96
    v_bitop3_b32 v232, v232, v233, s56 bitop3:0x7e
    v_mfma_f32_16x16x32_bf16 v[92:95], v[36:39], v[156:159], v[92:95]
    ds_read_b64_tr_b16 v[118:119], v6 offset:4704
    s_waitcnt lgkmcnt(10)
    v_mfma_f32_16x16x32_bf16 v[96:99], v[20:23], v[152:155], v[96:99]
    ds_read_b64_tr_b16 v[36:37], v6 offset:128
    v_cmp_eq_u32 vcc, 0, v232
    v_mfma_f32_16x16x32_bf16 v[100:103], v[20:23], v[156:159], v[100:103]
    ds_read_b64_tr_b16 v[38:39], v6 offset:4736
    s_waitcnt lgkmcnt(10)
    v_mfma_f32_16x16x32_bf16 v[104:107], v[24:27], v[152:155], v[104:107]
    ds_read_b64_tr_b16 v[20:21], v6 offset:160
    s_cmp_eq_u64 vcc, -1
    s_cbranch_scc0 Ls_s35
Ls_r35:
    v_mfma_f32_16x16x32_bf16 v[108:111], v[24:27], v[156:159], v[108:111]
    ds_read_b64_tr_b16 v[22:23], v6 offset:4768
    s_waitcnt lgkmcnt(10)
    v_mfma_f32_16x16x32_bf16 v[40:43], v[28:31], v[160:163], v[40:43]
    ds_read_b64_tr_b16 v[24:25], v6 offset:192
    buffer_load_dword v136, v7, s[44:47], s99 offen offset:2048 sc1
    v_mfma_f32_16x16x32_bf16 v[44:47], v[28:31], v[164:167], v[44:47]
    ds_read_b64_tr_b16 v[26:27], v6 offset:4800
    s_waitcnt lgkmcnt(10)
    v_mfma_f32_16x16x32_bf16 v[48:51], v[32:35], v[160:163], v[48:51]
    ds_read_b64_tr_b16 v[28:29], v6 offset:224
    buffer_load_dword v137, v19, s[44:47], s99 offen offset:2048 sc1
    v_mfma_f32_16x16x32_bf16 v[52:55], v[32:35], v[164:167], v[52:55]
    ds_read_b64_tr_b16 v[30:31], v6 offset:4832
    s_waitcnt lgkmcnt(10)
    v_mfma_f32_16x16x32_bf16 v[56:59], v[112:115], v[160:163], v[56:59]
    ds_read_b64_tr_b16 v[32:33], v6 offset:256
    buffer_load_dwordx4 v[224:227], v4, s[44:47], s99 offen offset:0 sc1
    v_mfma_f32_16x16x32_bf16 v[60:63], v[112:115], v[164:167], v[60:63]
    ds_read_b64_tr_b16 v[34:35], v6 offset:4864
    s_waitcnt lgkmcnt(10)
    v_mfma_f32_16x16x32_bf16 v[64:67], v[116:119], v[160:163], v[64:67]
    ds_read_b64_tr_b16 v[112:113], v6 offset:9216
    buffer_load_dwordx4 v[228:231], v16, s[44:47], s99 offen offset:0 sc1
    v_mfma_f32_16x16x32_bf16 v[68:71], v[116:119], v[164:167], v[68:71]
    ds_read_b64_tr_b16 v[114:115], v6 offset:13824
    s_waitcnt lgkmcnt(10)
    v_mfma_f32_16x16x32_bf16 v[72:75], v[36:39], v[160:163], v[72:75]
    ds_read_b64_tr_b16 v[116:117], v6 offset:9248
    buffer_load_dwordx4 v[232:235], v4, s[44:47], s99 offen offset:1024 sc1
    v_mfma_f32_16x16x32_bf16 v[76:79], v[36:39], v[164:167], v[76:79]
    ds_read_b64_tr_b16 v[118:119], v6 offset:13856
    s_waitcnt lgkmcnt(10)
    v_mfma_f32_16x16x32_bf16 v[80:83], v[20:23], v[160:163], v[80:83]
    ds_read_b64_tr_b16 v[36:37], v6 offset:9280
    buffer_load_dwordx4 v[236:239], v16, s[44:47], s99 offen offset:1024 sc1
    v_mfma_f32_16x16x32_bf16 v[84:87], v[20:23], v[164:167], v[84:87]
    ds_read_b64_tr_b16 v[38:39], v6 offset:13888
    s_waitcnt lgkmcnt(10)
    v_mfma_f32_16x16x32_bf16 v[88:91], v[24:27], v[160:163], v[88:91]
    ds_read_b64_tr_b16 v[20:21], v6 offset:9312
    v_mfma_f32_16x16x32_bf16 v[92:95], v[24:27], v[164:167], v[92:95]
    ds_read_b64_tr_b16 v[22:23], v6 offset:13920
    s_waitcnt vmcnt(19)
    s_waitcnt lgkmcnt(10)
    v_mfma_f32_16x16x32_bf16 v[96:99], v[28:31], v[160:163], v[96:99]
    ds_read_b128 v[152:155], v11 offset:16
    ds_read_b64_tr_b16 v[24:25], v6 offset:9344
    v_bitop3_b32 v248, v248, v176, v177 bitop3:0x96
    v_mfma_f32_16x16x32_bf16 v[100:103], v[28:31], v[164:167], v[100:103]
    ds_read_b64_tr_b16 v[26:27], v6 offset:13952
    s_waitcnt lgkmcnt(11)
    v_mfma_f32_16x16x32_bf16 v[104:107], v[32:35], v[160:163], v[104:107]
    ds_read_b64_tr_b16 v[28:29], v6 offset:9376
    v_bitop3_b32 v248, v248, v178, v179 bitop3:0x96
    v_mfma_f32_16x16x32_bf16 v[108:111], v[32:35], v[164:167], v[108:111]
    ds_read_b64_tr_b16 v[30:31], v6 offset:13984
    s_waitcnt lgkmcnt(11)
    v_mfma_f32_16x16x32_bf16 v[40:43], v[112:115], v[168:171], v[40:43]
    ds_read_b64_tr_b16 v[32:33], v6 offset:9408
    v_bitop3_b32 v248, v248, v184, v185 bitop3:0x96
    v_mfma_f32_16x16x32_bf16 v[44:47], v[112:115], v[172:175], v[44:47]
    ds_read_b64_tr_b16 v[34:35], v6 offset:14016
    s_waitcnt lgkmcnt(11)
    v_mfma_f32_16x16x32_bf16 v[48:51], v[116:119], v[168:171], v[48:51]
    ds_read_b64_tr_b16 v[112:113], v6 offset:9440
    v_bitop3_b32 v248, v248, v186, v187 bitop3:0x96
    v_mfma_f32_16x16x32_bf16 v[52:55], v[116:119], v[172:175], v[52:55]
    ds_read_b64_tr_b16 v[114:115], v6 offset:14048
    s_waitcnt lgkmcnt(11)
    v_mfma_f32_16x16x32_bf16 v[56:59], v[36:39], v[168:171], v[56:59]
    ds_read_b64_tr_b16 v[116:117], v6 offset:9472
    v_bitop3_b32 v249, v249, v180, v181 bitop3:0x96
    v_mfma_f32_16x16x32_bf16 v[60:63], v[36:39], v[172:175], v[60:63]
    ds_read_b64_tr_b16 v[118:119], v6 offset:14080
    s_waitcnt lgkmcnt(11)
    v_mfma_f32_16x16x32_bf16 v[64:67], v[20:23], v[168:171], v[64:67]
    s_waitcnt lgkmcnt(10)
    v_min_u32 v152, v152, v153
    v_min3_u32 v152, v152, v154, v155
    s_nop 0
    v_readfirstlane_b32 s64, v152
    s_nop 0
    s_cmp_ge_u32 s64, 13
    s_cbranch_scc0 Ls_s36
Ls_r36:
    ds_read_b64_tr_b16 v[36:37], v6 offset:18432
    v_bitop3_b32 v249, v249, v182, v183 bitop3:0x96
    v_mfma_f32_16x16x32_bf16 v[68:71], v[20:23], v[172:175], v[68:71]
    ds_read_b64_tr_b16 v[38:39], v6 offset:23040
    s_waitcnt lgkmcnt(10)
    v_mfma_f32_16x16x32_bf16 v[72:75], v[24:27], v[168:171], v[72:75]
    ds_read_b64_tr_b16 v[20:21], v6 offset:18464
    v_bitop3_b32 v249, v249, v188, v189 bitop3:0x96
    v_mfma_f32_16x16x32_bf16 v[76:79], v[24:27], v[172:175], v[76:79]
    ds_read_b64_tr_b16 v[22:23], v6 offset:23072
    s_waitcnt lgkmcnt(10)
    v_mfma_f32_16x16x32_bf16 v[80:83], v[28:31], v[168:171], v[80:83]
    ds_read_b64_tr_b16 v[24:25], v6 offset:18496
    v_bitop3_b32 v249, v249, v190, v191 bitop3:0x96
    v_mfma_f32_16x16x32_bf16 v[84:87], v[28:31], v[172:175], v[84:87]
    ds_read_b64_tr_b16 v[26:27], v6 offset:23104
    s_waitcnt lgkmcnt(10)
    v_mfma_f32_16x16x32_bf16 v[88:91], v[32:35], v[168:171], v[88:91]
    ds_read_b64_tr_b16 v[28:29], v6 offset:18528
    v_bitop3_b32 v248, v248, v249, s56 bitop3:0x7e
    v_mfma_f32_16x16x32_bf16 v[92:95], v[32:35], v[172:175], v[92:95]
    ds_read_b64_tr_b16 v[30:31], v6 offset:23136
    s_waitcnt lgkmcnt(10)
    v_mfma_f32_16x16x32_bf16 v[96:99], v[112:115], v[168:171], v[96:99]
    ds_read_b64_tr_b16 v[32:33], v6 offset:18560
    v_cmp_eq_u32 vcc, 0, v248
    v_mfma_f32_16x16x32_bf16 v[100:103], v[112:115], v[172:175], v[100:103]
    ds_read_b64_tr_b16 v[34:35], v6 offset:23168
    s_waitcnt lgkmcnt(10)
    v_mfma_f32_16x16x32_bf16 v[104:107], v[116:119], v[168:171], v[104:107]
    ds_read_b64_tr_b16 v[112:113], v6 offset:18592
    s_cmp_eq_u64 vcc, -1
    s_cbranch_scc0 Ls_s37
Ls_r37:
    v_mfma_f32_16x16x32_bf16 v[108:111], v[116:119], v[172:175], v[108:111]
    ds_read_b64_tr_b16 v[114:115], v6 offset:23200
    s_waitcnt lgkmcnt(10)
    v_mfma_f32_16x16x32_bf16 v[40:43], v[36:39], v[176:179], v[40:43]
    ds_read_b64_tr_b16 v[116:117], v6 offset:18624
    buffer_load_dword v144, v7, s[44:47], s100 offen offset:2048 sc1
    v_mfma_f32_16x16x32_bf16 v[44:47], v[36:39], v[180:183], v[44:47]
    ds_read_b64_tr_b16 v[118:119], v6 offset:23232
    s_waitcnt lgkmcnt(10)
    v_mfma_f32_16x16x32_bf16 v[48:51], v[20:23], v[176:179], v[48:51]
    ds_read_b64_tr_b16 v[36:37], v6 offset:18656
    buffer_load_dword v145, v19, s[44:47], s100 offen offset:2048 sc1
    v_mfma_f32_16x16x32_bf16 v[52:55], v[20:23], v[180:183], v[52:55]
    ds_read_b64_tr_b16 v[38:39], v6 offset:23264
    s_waitcnt lgkmcnt(10)
    v_mfma_f32_16x16x32_bf16 v[56:59], v[24:27], v[176:179], v[56:59]
    ds_read_b64_tr_b16 v[20:21], v6 offset:18688
    buffer_load_dwordx4 v[240:243], v4, s[44:47], s100 offen offset:0 sc1
    v_mfma_f32_16x16x32_bf16 v[60:63], v[24:27], v[180:183], v[60:63]
    ds_read_b64_tr_b16 v[22:23], v6 offset:23296
    s_waitcnt lgkmcnt(10)
    v_mfma_f32_16x16x32_bf16 v[64:67], v[28:31], v[176:179], v[64:67]
    ds_read_b64_tr_b16 v[24:25], v6 offset:27648
    buffer_load_dwordx4 v[244:247], v16, s[44:47], s100 offen offset:0 sc1
    v_mfma_f32_16x16x32_bf16 v[68:71], v[28:31], v[180:183], v[68:71]
    ds_read_b64_tr_b16 v[26:27], v6 offset:32256
    s_waitcnt lgkmcnt(10)
    v_mfma_f32_16x16x32_bf16 v[72:75], v[32:35], v[176:179], v[72:75]
    ds_read_b64_tr_b16 v[28:29], v6 offset:27680
    buffer_load_dwordx4 v[248:251], v4, s[44:47], s100 offen offset:1024 sc1
    v_mfma_f32_16x16x32_bf16 v[76:79], v[32:35], v[180:183], v[76:79]
    ds_read_b64_tr_b16 v[30:31], v6 offset:32288
    s_waitcnt lgkmcnt(10)
    v_mfma_f32_16x16x32_bf16 v[80:83], v[112:115], v[176:179], v[80:83]
    ds_read_b64_tr_b16 v[32:33], v6 offset:27712
    buffer_load_dwordx4 v[252:255], v16, s[44:47], s100 offen offset:1024 sc1
    v_mfma_f32_16x16x32_bf16 v[84:87], v[112:115], v[180:183], v[84:87]
    ds_read_b64_tr_b16 v[34:35], v6 offset:32320
    s_waitcnt lgkmcnt(10)
    v_mfma_f32_16x16x32_bf16 v[88:91], v[116:119], v[176:179], v[88:91]
    ds_read_b64_tr_b16 v[112:113], v6 offset:27744
    v_mfma_f32_16x16x32_bf16 v[92:95], v[116:119], v[180:183], v[92:95]
    ds_read_b64_tr_b16 v[114:115], v6 offset:32352
    s_waitcnt vmcnt(19)
    s_waitcnt lgkmcnt(10)
    v_mfma_f32_16x16x32_bf16 v[96:99], v[36:39], v[176:179], v[96:99]
    ds_read_b64_tr_b16 v[116:117], v6 offset:27776
    v_bitop3_b32 v120, v120, v192, v193 bitop3:0x96
    v_mfma_f32_16x16x32_bf16 v[100:103], v[36:39], v[180:183], v[100:103]
    ds_read_b64_tr_b16 v[118:119], v6 offset:32384
    s_waitcnt lgkmcnt(10)
    v_mfma_f32_16x16x32_bf16 v[104:107], v[20:23], v[176:179], v[104:107]
    ds_read_b64_tr_b16 v[36:37], v6 offset:27808
    v_bitop3_b32 v120, v120, v194, v195 bitop3:0x96
    v_mfma_f32_16x16x32_bf16 v[108:111], v[20:23], v[180:183], v[108:111]
    ds_read_b64_tr_b16 v[38:39], v6 offset:32416
    s_waitcnt lgkmcnt(10)
    v_mfma_f32_16x16x32_bf16 v[40:43], v[24:27], v[184:187], v[40:43]
    ds_read_b64_tr_b16 v[20:21], v6 offset:27840
    v_bitop3_b32 v120, v120, v200, v201 bitop3:0x96
    v_mfma_f32_16x16x32_bf16 v[44:47], v[24:27], v[188:191], v[44:47]
    ds_read_b64_tr_b16 v[22:23], v6 offset:32448
    s_waitcnt lgkmcnt(10)
    v_mfma_f32_16x16x32_bf16 v[48:51], v[28:31], v[184:187], v[48:51]
    ds_read_b64_tr_b16 v[24:25], v6 offset:27872
    v_bitop3_b32 v120, v120, v202, v203 bitop3:0x96
    v_mfma_f32_16x16x32_bf16 v[52:55], v[28:31], v[188:191], v[52:55]
    ds_read_b64_tr_b16 v[26:27], v6 offset:32480
    s_waitcnt lgkmcnt(10)
    v_mfma_f32_16x16x32_bf16 v[56:59], v[32:35], v[184:187], v[56:59]
    ds_read_b64_tr_b16 v[28:29], v6 offset:27904
    v_bitop3_b32 v121, v121, v196, v197 bitop3:0x96
    v_mfma_f32_16x16x32_bf16 v[60:63], v[32:35], v[188:191], v[60:63]
    ds_read_b64_tr_b16 v[30:31], v6 offset:32512
    s_waitcnt lgkmcnt(10)
    v_mfma_f32_16x16x32_bf16 v[64:67], v[112:115], v[184:187], v[64:67]
    ds_read_b64_tr_b16 v[32:33], v6 offset:36864
    v_bitop3_b32 v121, v121, v198, v199 bitop3:0x96
    v_mfma_f32_16x16x32_bf16 v[68:71], v[112:115], v[188:191], v[68:71]
    ds_read_b64_tr_b16 v[34:35], v6 offset:41472
    s_waitcnt lgkmcnt(10)
    v_mfma_f32_16x16x32_bf16 v[72:75], v[116:119], v[184:187], v[72:75]
    ds_read_b64_tr_b16 v[112:113], v6 offset:36896
    v_bitop3_b32 v121, v121, v204, v205 bitop3:0x96
    v_mfma_f32_16x16x32_bf16 v[76:79], v[116:119], v[188:191], v[76:79]
    ds_read_b64_tr_b16 v[114:115], v6 offset:41504
    s_waitcnt lgkmcnt(10)
    v_mfma_f32_16x16x32_bf16 v[80:83], v[36:39], v[184:187], v[80:83]
    ds_read_b64_tr_b16 v[116:117], v6 offset:36928
    v_bitop3_b32 v121, v121, v206, v207 bitop3:0x96
    v_mfma_f32_16x16x32_bf16 v[84:87], v[36:39], v[188:191], v[84:87]
    ds_read_b64_tr_b16 v[118:119], v6 offset:41536
    s_waitcnt lgkmcnt(10)
    v_mfma_f32_16x16x32_bf16 v[88:91], v[20:23], v[184:187], v[88:91]
    ds_read_b64_tr_b16 v[36:37], v6 offset:36960
    v_bitop3_b32 v120, v120, v121, s56 bitop3:0x7e
    v_mfma_f32_16x16x32_bf16 v[92:95], v[20:23], v[188:191], v[92:95]
    ds_read_b64_tr_b16 v[38:39], v6 offset:41568
    s_waitcnt lgkmcnt(10)
    v_mfma_f32_16x16x32_bf16 v[96:99], v[24:27], v[184:187], v[96:99]
    ds_read_b64_tr_b16 v[20:21], v6 offset:36992
    v_cmp_eq_u32 vcc, 0, v120
    v_mfma_f32_16x16x32_bf16 v[100:103], v[24:27], v[188:191], v[100:103]
    ds_read_b64_tr_b16 v[22:23], v6 offset:41600
    s_waitcnt lgkmcnt(10)
    v_mfma_f32_16x16x32_bf16 v[104:107], v[28:31], v[184:187], v[104:107]
    ds_read_b64_tr_b16 v[24:25], v6 offset:37024
    s_cmp_eq_u64 vcc, -1
    s_cbranch_scc0 Ls_s38
Ls_r38:
    v_mfma_f32_16x16x32_bf16 v[108:111], v[28:31], v[188:191], v[108:111]
    ds_read_b64_tr_b16 v[26:27], v6 offset:41632
    s_waitcnt lgkmcnt(10)
    v_mfma_f32_16x16x32_bf16 v[40:43], v[32:35], v[192:195], v[40:43]
    ds_read_b64_tr_b16 v[28:29], v6 offset:37056
    v_mfma_f32_16x16x32_bf16 v[44:47], v[32:35], v[196:199], v[44:47]
    ds_read_b64_tr_b16 v[30:31], v6 offset:41664
    s_waitcnt lgkmcnt(10)
    v_mfma_f32_16x16x32_bf16 v[48:51], v[112:115], v[192:195], v[48:51]
    ds_read_b64_tr_b16 v[32:33], v6 offset:37088
    v_mfma_f32_16x16x32_bf16 v[52:55], v[112:115], v[196:199], v[52:55]
    ds_read_b64_tr_b16 v[34:35], v6 offset:41696
    s_waitcnt lgkmcnt(10)
    v_mfma_f32_16x16x32_bf16 v[56:59], v[116:119], v[192:195], v[56:59]
    ds_read_b64_tr_b16 v[112:113], v6 offset:37120
    v_mfma_f32_16x16x32_bf16 v[60:63], v[116:119], v[196:199], v[60:63]
    ds_read_b64_tr_b16 v[114:115], v6 offset:41728
    s_waitcnt lgkmcnt(10)
    v_mfma_f32_16x16x32_bf16 v[64:67], v[36:39], v[192:195], v[64:67]
    ds_read_b64_tr_b16 v[116:117], v6 offset:46080
    v_mfma_f32_16x16x32_bf16 v[68:71], v[36:39], v[196:199], v[68:71]
    ds_read_b64_tr_b16 v[118:119], v6 offset:50688
    s_waitcnt lgkmcnt(10)
    v_mfma_f32_16x16x32_bf16 v[72:75], v[20:23], v[192:195], v[72:75]
    ds_read_b64_tr_b16 v[36:37], v6 offset:46112
    v_mfma_f32_16x16x32_bf16 v[76:79], v[20:23], v[196:199], v[76:79]
    ds_read_b64_tr_b16 v[38:39], v6 offset:50720
    s_waitcnt lgkmcnt(10)
    v_mfma_f32_16x16x32_bf16 v[80:83], v[24:27], v[192:195], v[80:83]
    ds_read_b64_tr_b16 v[20:21], v6 offset:46144
    v_mfma_f32_16x16x32_bf16 v[84:87], v[24:27], v[196:199], v[84:87]
    ds_read_b64_tr_b16 v[22:23], v6 offset:50752
    s_waitcnt lgkmcnt(10)
    v_mfma_f32_16x16x32_bf16 v[88:91], v[28:31], v[192:195], v[88:91]
    ds_read_b64_tr_b16 v[24:25], v6 offset:46176
    v_mfma_f32_16x16x32_bf16 v[92:95], v[28:31], v[196:199], v[92:95]
    ds_read_b64_tr_b16 v[26:27], v6 offset:50784
    s_waitcnt vmcnt(13)
    s_waitcnt lgkmcnt(10)
    v_mfma_f32_16x16x32_bf16 v[96:99], v[32:35], v[192:195], v[96:99]
    ds_read_b128 v[152:155], v11 offset:16
    ds_read_b64_tr_b16 v[28:29], v6 offset:46208
    v_bitop3_b32 v128, v128, v208, v209 bitop3:0x96
    v_mfma_f32_16x16x32_bf16 v[100:103], v[32:35], v[196:199], v[100:103]
    ds_read_b64_tr_b16 v[30:31], v6 offset:50816
    s_waitcnt lgkmcnt(11)
    v_mfma_f32_16x16x32_bf16 v[104:107], v[112:115], v[192:195], v[104:107]
    ds_read_b64_tr_b16 v[32:33], v6 offset:46240
    v_bitop3_b32 v128, v128, v210, v211 bitop3:0x96
    v_mfma_f32_16x16x32_bf16 v[108:111], v[112:115], v[196:199], v[108:111]
    ds_read_b64_tr_b16 v[34:35], v6 offset:50848
    s_waitcnt lgkmcnt(11)
    v_mfma_f32_16x16x32_bf16 v[40:43], v[116:119], v[200:203], v[40:43]
    ds_read_b64_tr_b16 v[112:113], v6 offset:46272
    v_bitop3_b32 v128, v128, v216, v217 bitop3:0x96
    v_mfma_f32_16x16x32_bf16 v[44:47], v[116:119], v[204:207], v[44:47]
    ds_read_b64_tr_b16 v[114:115], v6 offset:50880
    s_waitcnt lgkmcnt(11)
    v_mfma_f32_16x16x32_bf16 v[48:51], v[36:39], v[200:203], v[48:51]
    ds_read_b64_tr_b16 v[116:117], v6 offset:46304
    v_bitop3_b32 v128, v128, v218, v219 bitop3:0x96
    v_mfma_f32_16x16x32_bf16 v[52:55], v[36:39], v[204:207], v[52:55]
    ds_read_b64_tr_b16 v[118:119], v6 offset:50912
    s_waitcnt lgkmcnt(11)
    v_mfma_f32_16x16x32_bf16 v[56:59], v[20:23], v[200:203], v[56:59]
    ds_read_b64_tr_b16 v[36:37], v6 offset:46336
    v_bitop3_b32 v129, v129, v212, v213 bitop3:0x96
    v_mfma_f32_16x16x32_bf16 v[60:63], v[20:23], v[204:207], v[60:63]
    ds_read_b64_tr_b16 v[38:39], v6 offset:50944
    s_waitcnt lgkmcnt(11)
    v_mfma_f32_16x16x32_bf16 v[64:67], v[24:27], v[200:203], v[64:67]
    s_waitcnt lgkmcnt(10)
    v_min_u32 v152, v152, v153
    v_min3_u32 v152, v152, v154, v155
    s_nop 0
    v_readfirstlane_b32 s64, v152
    s_nop 0
    s_cmp_ge_u32 s64, 14
    s_cbranch_scc0 Ls_s39
Ls_r39:
    ds_read_b64_tr_b16 v[20:21], v8 offset:0
    v_bitop3_b32 v129, v129, v214, v215 bitop3:0x96
    v_mfma_f32_16x16x32_bf16 v[68:71], v[24:27], v[204:207], v[68:71]
    ds_read_b64_tr_b16 v[22:23], v8 offset:4608
    s_waitcnt lgkmcnt(10)
    v_mfma_f32_16x16x32_bf16 v[72:75], v[28:31], v[200:203], v[72:75]
    ds_read_b64_tr_b16 v[24:25], v8 offset:32
    v_bitop3_b32 v129, v129, v220, v221 bitop3:0x96
    v_mfma_f32_16x16x32_bf16 v[76:79], v[28:31], v[204:207], v[76:79]
    ds_read_b64_tr_b16 v[26:27], v8 offset:4640
    s_waitcnt lgkmcnt(10)
    v_mfma_f32_16x16x32_bf16 v[80:83], v[32:35], v[200:203], v[80:83]
    ds_read_b64_tr_b16 v[28:29], v8 offset:64
    v_bitop3_b32 v129, v129, v222, v223 bitop3:0x96
    v_mfma_f32_16x16x32_bf16 v[84:87], v[32:35], v[204:207], v[84:87]
    ds_read_b64_tr_b16 v[30:31], v8 offset:4672
    s_waitcnt lgkmcnt(10)
    v_mfma_f32_16x16x32_bf16 v[88:91], v[112:115], v[200:203], v[88:91]
    ds_read_b64_tr_b16 v[32:33], v8 offset:96
    v_bitop3_b32 v128, v128, v129, s56 bitop3:0x7e
    v_mfma_f32_16x16x32_bf16 v[92:95], v[112:115], v[204:207], v[92:95]
    ds_read_b64_tr_b16 v[34:35], v8 offset:4704
    s_waitcnt lgkmcnt(10)
    v_mfma_f32_16x16x32_bf16 v[96:99], v[116:119], v[200:203], v[96:99]
    ds_read_b64_tr_b16 v[112:113], v8 offset:128
    v_cmp_eq_u32 vcc, 0, v128
    v_mfma_f32_16x16x32_bf16 v[100:103], v[116:119], v[204:207], v[100:103]
    ds_read_b64_tr_b16 v[114:115], v8 offset:4736
    s_waitcnt lgkmcnt(10)
    v_mfma_f32_16x16x32_bf16 v[104:107], v[36:39], v[200:203], v[104:107]
    ds_read_b64_tr_b16 v[116:117], v8 offset:160
    s_cmp_eq_u64 vcc, -1
    s_cbranch_scc0 Ls_s40
Ls_r40:
    v_mfma_f32_16x16x32_bf16 v[108:111], v[36:39], v[204:207], v[108:111]
    ds_read_b64_tr_b16 v[118:119], v8 offset:4768
    s_waitcnt lgkmcnt(10)
    v_mfma_f32_16x16x32_bf16 v[40:43], v[20:23], v[208:211], v[40:43]
    ds_read_b64_tr_b16 v[36:37], v8 offset:192
    v_mfma_f32_16x16x32_bf16 v[44:47], v[20:23], v[212:215], v[44:47]
    ds_read_b64_tr_b16 v[38:39], v8 offset:4800
    s_waitcnt lgkmcnt(10)
    v_mfma_f32_16x16x32_bf16 v[48:51], v[24:27], v[208:211], v[48:51]
    ds_read_b64_tr_b16 v[20:21], v8 offset:224
    v_mfma_f32_16x16x32_bf16 v[52:55], v[24:27], v[212:215], v[52:55]
    ds_read_b64_tr_b16 v[22:23], v8 offset:4832
    s_waitcnt lgkmcnt(10)
    v_mfma_f32_16x16x32_bf16 v[56:59], v[28:31], v[208:211], v[56:59]
    ds_read_b64_tr_b16 v[24:25], v8 offset:256
    v_mfma_f32_16x16x32_bf16 v[60:63], v[28:31], v[212:215], v[60:63]
    ds_read_b64_tr_b16 v[26:27], v8 offset:4864
    s_waitcnt lgkmcnt(10)
    v_mfma_f32_16x16x32_bf16 v[64:67], v[32:35], v[208:211], v[64:67]
    ds_read_b64_tr_b16 v[28:29], v8 offset:9216
    v_mfma_f32_16x16x32_bf16 v[68:71], v[32:35], v[212:215], v[68:71]
    ds_read_b64_tr_b16 v[30:31], v8 offset:13824
    s_waitcnt lgkmcnt(10)
    v_mfma_f32_16x16x32_bf16 v[72:75], v[112:115], v[208:211], v[72:75]
    ds_read_b64_tr_b16 v[32:33], v8 offset:9248
    v_mfma_f32_16x16x32_bf16 v[76:79], v[112:115], v[212:215], v[76:79]
    ds_read_b64_tr_b16 v[34:35], v8 offset:13856
    s_waitcnt lgkmcnt(10)
    v_mfma_f32_16x16x32_bf16 v[80:83], v[116:119], v[208:211], v[80:83]
    ds_read_b64_tr_b16 v[112:113], v8 offset:9280
    v_mfma_f32_16x16x32_bf16 v[84:87], v[116:119], v[212:215], v[84:87]
    ds_read_b64_tr_b16 v[114:115], v8 offset:13888
    s_waitcnt lgkmcnt(10)
    v_mfma_f32_16x16x32_bf16 v[88:91], v[36:39], v[208:211], v[88:91]
    ds_read_b64_tr_b16 v[116:117], v8 offset:9312
    v_mfma_f32_16x16x32_bf16 v[92:95], v[36:39], v[212:215], v[92:95]
    ds_read_b64_tr_b16 v[118:119], v8 offset:13920
    s_waitcnt vmcnt(6)
    s_waitcnt lgkmcnt(10)
    v_mfma_f32_16x16x32_bf16 v[96:99], v[20:23], v[208:211], v[96:99]
    ds_read_b64_tr_b16 v[36:37], v8 offset:9344
    v_bitop3_b32 v136, v136, v224, v225 bitop3:0x96
    v_mfma_f32_16x16x32_bf16 v[100:103], v[20:23], v[212:215], v[100:103]
    ds_read_b64_tr_b16 v[38:39], v8 offset:13952
    s_waitcnt lgkmcnt(10)
    v_mfma_f32_16x16x32_bf16 v[104:107], v[24:27], v[208:211], v[104:107]
    ds_read_b64_tr_b16 v[20:21], v8 offset:9376
    v_bitop3_b32 v136, v136, v226, v227 bitop3:0x96
    v_mfma_f32_16x16x32_bf16 v[108:111], v[24:27], v[212:215], v[108:111]
    ds_read_b64_tr_b16 v[22:23], v8 offset:13984
    s_add_u32 m0, s50, 0
    v_mov_b32 v0, 56
    s_mov_b64 exec, 1
    global_load_lds_dword v0, s[48:49]
    s_mov_b64 exec, -1
    s_waitcnt lgkmcnt(10)
    v_mfma_f32_16x16x32_bf16 v[40:43], v[28:31], v[216:219], v[40:43]
    ds_read_b64_tr_b16 v[24:25], v8 offset:9408
    v_bitop3_b32 v136, v136, v232, v233 bitop3:0x96
    v_mfma_f32_16x16x32_bf16 v[44:47], v[28:31], v[220:223], v[44:47]
    ds_read_b64_tr_b16 v[26:27], v8 offset:14016
    s_waitcnt lgkmcnt(10)
    v_mfma_f32_16x16x32_bf16 v[48:51], v[32:35], v[216:219], v[48:51]
    ds_read_b64_tr_b16 v[28:29], v8 offset:9440
    v_bitop3_b32 v136, v136, v234, v235 bitop3:0x96
    v_mfma_f32_16x16x32_bf16 v[52:55], v[32:35], v[220:223], v[52:55]
    ds_read_b64_tr_b16 v[30:31], v8 offset:14048
    s_waitcnt lgkmcnt(10)
    v_mfma_f32_16x16x32_bf16 v[56:59], v[112:115], v[216:219], v[56:59]
    ds_read_b64_tr_b16 v[32:33], v8 offset:9472
    v_bitop3_b32 v137, v137, v228, v229 bitop3:0x96
    v_mfma_f32_16x16x32_bf16 v[60:63], v[112:115], v[220:223], v[60:63]
    ds_read_b64_tr_b16 v[34:35], v8 offset:14080
    s_waitcnt lgkmcnt(10)
    v_mfma_f32_16x16x32_bf16 v[64:67], v[116:119], v[216:219], v[64:67]
    ds_read_b64_tr_b16 v[112:113], v8 offset:18432
    v_bitop3_b32 v137, v137, v230, v231 bitop3:0x96
    v_mfma_f32_16x16x32_bf16 v[68:71], v[116:119], v[220:223], v[68:71]
    ds_read_b64_tr_b16 v[114:115], v8 offset:23040
    s_waitcnt lgkmcnt(10)
    v_mfma_f32_16x16x32_bf16 v[72:75], v[36:39], v[216:219], v[72:75]
    ds_read_b64_tr_b16 v[116:117], v8 offset:18464
    v_bitop3_b32 v137, v137, v236, v237 bitop3:0x96
    v_mfma_f32_16x16x32_bf16 v[76:79], v[36:39], v[220:223], v[76:79]
    ds_read_b64_tr_b16 v[118:119], v8 offset:23072
    s_waitcnt lgkmcnt(10)
    v_mfma_f32_16x16x32_bf16 v[80:83], v[20:23], v[216:219], v[80:83]
    ds_read_b64_tr_b16 v[36:37], v8 offset:18496
    v_bitop3_b32 v137, v137, v238, v239 bitop3:0x96
    v_mfma_f32_16x16x32_bf16 v[84:87], v[20:23], v[220:223], v[84:87]
    ds_read_b64_tr_b16 v[38:39], v8 offset:23104
    s_waitcnt lgkmcnt(10)
    v_mfma_f32_16x16x32_bf16 v[88:91], v[24:27], v[216:219], v[88:91]
    ds_read_b64_tr_b16 v[20:21], v8 offset:18528
    v_bitop3_b32 v136, v136, v137, s56 bitop3:0x7e
    v_mfma_f32_16x16x32_bf16 v[92:95], v[24:27], v[220:223], v[92:95]
    ds_read_b64_tr_b16 v[22:23], v8 offset:23136
    s_waitcnt lgkmcnt(10)
    v_mfma_f32_16x16x32_bf16 v[96:99], v[28:31], v[216:219], v[96:99]
    ds_read_b64_tr_b16 v[24:25], v8 offset:18560
    v_cmp_eq_u32 vcc, 0, v136
    v_mfma_f32_16x16x32_bf16 v[100:103], v[28:31], v[220:223], v[100:103]
    ds_read_b64_tr_b16 v[26:27], v8 offset:23168
    s_waitcnt lgkmcnt(10)
    v_mfma_f32_16x16x32_bf16 v[104:107], v[32:35], v[216:219], v[104:107]
    ds_read_b64_tr_b16 v[28:29], v8 offset:18592
    s_cmp_eq_u64 vcc, -1
    s_cbranch_scc0 Ls_s41
Ls_r41:
    v_mfma_f32_16x16x32_bf16 v[108:111], v[32:35], v[220:223], v[108:111]
    ds_read_b64_tr_b16 v[30:31], v8 offset:23200
    s_waitcnt lgkmcnt(10)
    v_mfma_f32_16x16x32_bf16 v[40:43], v[112:115], v[224:227], v[40:43]
    ds_read_b64_tr_b16 v[32:33], v8 offset:18624
    v_mfma_f32_16x16x32_bf16 v[44:47], v[112:115], v[228:231], v[44:47]
    ds_read_b64_tr_b16 v[34:35], v8 offset:23232
    s_waitcnt lgkmcnt(10)
    v_mfma_f32_16x16x32_bf16 v[48:51], v[116:119], v[224:227], v[48:51]
    ds_read_b64_tr_b16 v[112:113], v8 offset:18656
    v_mfma_f32_16x16x32_bf16 v[52:55], v[116:119], v[228:231], v[52:55]
    ds_read_b64_tr_b16 v[114:115], v8 offset:23264
    s_waitcnt lgkmcnt(10)
    v_mfma_f32_16x16x32_bf16 v[56:59], v[36:39], v[224:227], v[56:59]
    ds_read_b64_tr_b16 v[116:117], v8 offset:18688
    v_mfma_f32_16x16x32_bf16 v[60:63], v[36:39], v[228:231], v[60:63]
    ds_read_b64_tr_b16 v[118:119], v8 offset:23296
    s_waitcnt lgkmcnt(10)
    v_mfma_f32_16x16x32_bf16 v[64:67], v[20:23], v[224:227], v[64:67]
    ds_read_b64_tr_b16 v[36:37], v8 offset:27648
    v_mfma_f32_16x16x32_bf16 v[68:71], v[20:23], v[228:231], v[68:71]
    ds_read_b64_tr_b16 v[38:39], v8 offset:32256
    s_waitcnt lgkmcnt(10)
    v_mfma_f32_16x16x32_bf16 v[72:75], v[24:27], v[224:227], v[72:75]
    ds_read_b64_tr_b16 v[20:21], v8 offset:27680
    v_mfma_f32_16x16x32_bf16 v[76:79], v[24:27], v[228:231], v[76:79]
    ds_read_b64_tr_b16 v[22:23], v8 offset:32288
    s_waitcnt lgkmcnt(10)
    v_mfma_f32_16x16x32_bf16 v[80:83], v[28:31], v[224:227], v[80:83]
    ds_read_b64_tr_b16 v[24:25], v8 offset:27712
    v_mfma_f32_16x16x32_bf16 v[84:87], v[28:31], v[228:231], v[84:87]
    ds_read_b64_tr_b16 v[26:27], v8 offset:32320
    s_waitcnt lgkmcnt(10)
    v_mfma_f32_16x16x32_bf16 v[88:91], v[32:35], v[224:227], v[88:91]
    ds_read_b64_tr_b16 v[28:29], v8 offset:27744
    v_mfma_f32_16x16x32_bf16 v[92:95], v[32:35], v[228:231], v[92:95]
    ds_read_b64_tr_b16 v[30:31], v8 offset:32352
    s_waitcnt vmcnt(1)
    s_waitcnt lgkmcnt(10)
    v_mfma_f32_16x16x32_bf16 v[96:99], v[112:115], v[224:227], v[96:99]
    ds_read_b128 v[152:155], v11 offset:16
    ds_read_b64_tr_b16 v[32:33], v8 offset:27776
    v_bitop3_b32 v144, v144, v240, v241 bitop3:0x96
    v_mfma_f32_16x16x32_bf16 v[100:103], v[112:115], v[228:231], v[100:103]
    ds_read_b64_tr_b16 v[34:35], v8 offset:32384
    s_waitcnt lgkmcnt(11)
    v_mfma_f32_16x16x32_bf16 v[104:107], v[116:119], v[224:227], v[104:107]
    ds_read_b64_tr_b16 v[112:113], v8 offset:27808
    v_bitop3_b32 v144, v144, v242, v243 bitop3:0x96
    v_mfma_f32_16x16x32_bf16 v[108:111], v[116:119], v[228:231], v[108:111]
    ds_read_b64_tr_b16 v[114:115], v8 offset:32416
    s_waitcnt lgkmcnt(11)
    v_mfma_f32_16x16x32_bf16 v[40:43], v[36:39], v[232:235], v[40:43]
    ds_read_b64_tr_b16 v[116:117], v8 offset:27840
    v_bitop3_b32 v144, v144, v248, v249 bitop3:0x96
    v_mfma_f32_16x16x32_bf16 v[44:47], v[36:39], v[236:239], v[44:47]
    ds_read_b64_tr_b16 v[118:119], v8 offset:32448
    s_waitcnt lgkmcnt(11)
    v_mfma_f32_16x16x32_bf16 v[48:51], v[20:23], v[232:235], v[48:51]
    ds_read_b64_tr_b16 v[36:37], v8 offset:27872
    v_bitop3_b32 v144, v144, v250, v251 bitop3:0x96
    v_mfma_f32_16x16x32_bf16 v[52:55], v[20:23], v[236:239], v[52:55]
    ds_read_b64_tr_b16 v[38:39], v8 offset:32480
    s_waitcnt lgkmcnt(11)
    v_mfma_f32_16x16x32_bf16 v[56:59], v[24:27], v[232:235], v[56:59]
    ds_read_b64_tr_b16 v[20:21], v8 offset:27904
    v_bitop3_b32 v145, v145, v244, v245 bitop3:0x96
    v_mfma_f32_16x16x32_bf16 v[60:63], v[24:27], v[236:239], v[60:63]
    ds_read_b64_tr_b16 v[22:23], v8 offset:32512
    s_waitcnt lgkmcnt(11)
    v_mfma_f32_16x16x32_bf16 v[64:67], v[28:31], v[232:235], v[64:67]
    s_waitcnt lgkmcnt(10)
    v_min_u32 v152, v152, v153
    v_min3_u32 v152, v152, v154, v155
    s_nop 0
    v_readfirstlane_b32 s64, v152
    s_nop 0
    s_cmp_ge_u32 s64, 15
    s_cbranch_scc0 Ls_s42
Ls_r42:
    ds_read_b64_tr_b16 v[24:25], v8 offset:36864
    v_bitop3_b32 v145, v145, v246, v247 bitop3:0x96
    v_mfma_f32_16x16x32_bf16 v[68:71], v[28:31], v[236:239], v[68:71]
    ds_read_b64_tr_b16 v[26:27], v8 offset:41472
    s_waitcnt lgkmcnt(10)
    v_mfma_f32_16x16x32_bf16 v[72:75], v[32:35], v[232:235], v[72:75]
    ds_read_b64_tr_b16 v[28:29], v8 offset:36896
    v_bitop3_b32 v145, v145, v252, v253 bitop3:0x96
    v_mfma_f32_16x16x32_bf16 v[76:79], v[32:35], v[236:239], v[76:79]
    ds_read_b64_tr_b16 v[30:31], v8 offset:41504
    s_waitcnt lgkmcnt(10)
    v_mfma_f32_16x16x32_bf16 v[80:83], v[112:115], v[232:235], v[80:83]
    ds_read_b64_tr_b16 v[32:33], v8 offset:36928
    v_bitop3_b32 v145, v145, v254, v255 bitop3:0x96
    v_mfma_f32_16x16x32_bf16 v[84:87], v[112:115], v[236:239], v[84:87]
    ds_read_b64_tr_b16 v[34:35], v8 offset:41536
    s_waitcnt lgkmcnt(10)
    v_mfma_f32_16x16x32_bf16 v[88:91], v[116:119], v[232:235], v[88:91]
    ds_read_b64_tr_b16 v[112:113], v8 offset:36960
    v_bitop3_b32 v144, v144, v145, s56 bitop3:0x7e
    v_mfma_f32_16x16x32_bf16 v[92:95], v[116:119], v[236:239], v[92:95]
    ds_read_b64_tr_b16 v[114:115], v8 offset:41568
    s_waitcnt lgkmcnt(10)
    v_mfma_f32_16x16x32_bf16 v[96:99], v[36:39], v[232:235], v[96:99]
    ds_read_b64_tr_b16 v[116:117], v8 offset:36992
    v_cmp_eq_u32 vcc, 0, v144
    v_mfma_f32_16x16x32_bf16 v[100:103], v[36:39], v[236:239], v[100:103]
    ds_read_b64_tr_b16 v[118:119], v8 offset:41600
    s_waitcnt lgkmcnt(10)
    v_mfma_f32_16x16x32_bf16 v[104:107], v[20:23], v[232:235], v[104:107]
    ds_read_b64_tr_b16 v[36:37], v8 offset:37024
    s_cmp_eq_u64 vcc, -1
    s_cbranch_scc0 Ls_s43
Ls_r43:
    v_mfma_f32_16x16x32_bf16 v[108:111], v[20:23], v[236:239], v[108:111]
    ds_read_b64_tr_b16 v[38:39], v8 offset:41632
    s_waitcnt lgkmcnt(10)
    v_mfma_f32_16x16x32_bf16 v[40:43], v[24:27], v[240:243], v[40:43]
    ds_read_b64_tr_b16 v[20:21], v8 offset:37056
    v_mfma_f32_16x16x32_bf16 v[44:47], v[24:27], v[244:247], v[44:47]
    ds_read_b64_tr_b16 v[22:23], v8 offset:41664
    s_waitcnt lgkmcnt(10)
    v_mfma_f32_16x16x32_bf16 v[48:51], v[28:31], v[240:243], v[48:51]
    ds_read_b64_tr_b16 v[24:25], v8 offset:37088
    v_mfma_f32_16x16x32_bf16 v[52:55], v[28:31], v[244:247], v[52:55]
    ds_read_b64_tr_b16 v[26:27], v8 offset:41696
    s_waitcnt lgkmcnt(10)
    v_mfma_f32_16x16x32_bf16 v[56:59], v[32:35], v[240:243], v[56:59]
    ds_read_b64_tr_b16 v[28:29], v8 offset:37120
    v_mfma_f32_16x16x32_bf16 v[60:63], v[32:35], v[244:247], v[60:63]
    ds_read_b64_tr_b16 v[30:31], v8 offset:41728
    s_lshl_b32 s64, s57, 9
    s_add_u32 s64, s64, 156672
    v_lshl_add_u32 v0, v3, 4, s64
    ds_read_b128 v[152:155], v0 offset:0
    ds_read_b128 v[156:159], v0 offset:256
    s_waitcnt lgkmcnt(12)
    v_mfma_f32_16x16x32_bf16 v[64:67], v[112:115], v[240:243], v[64:67]
    ds_read_b64_tr_b16 v[32:33], v5 offset:0
    v_mfma_f32_16x16x32_bf16 v[68:71], v[112:115], v[244:247], v[68:71]
    ds_read_b64_tr_b16 v[34:35], v5 offset:4608
    s_waitcnt lgkmcnt(12)
    v_mfma_f32_16x16x32_bf16 v[72:75], v[116:119], v[240:243], v[72:75]
    ds_read_b64_tr_b16 v[112:113], v5 offset:32
    v_mfma_f32_16x16x32_bf16 v[76:79], v[116:119], v[244:247], v[76:79]
    ds_read_b64_tr_b16 v[114:115], v5 offset:4640
    v_lshl_add_u32 v14, v2, 4, v11
    s_waitcnt lgkmcnt(12)
    ds_read_b128 v[160:163], v14 offset:256
    v_mfma_f32_16x16x32_bf16 v[80:83], v[36:39], v[240:243], v[80:83]
    ds_read_b64_tr_b16 v[116:117], v5 offset:64
    v_mfma_f32_16x16x32_bf16 v[84:87], v[36:39], v[244:247], v[84:87]
    s_waitcnt lgkmcnt(12)
    ds_read_b64_tr_b16 v[118:119], v5 offset:4672
    ds_read_b128 v[164:167], v14 offset:320
    v_mfma_f32_16x16x32_bf16 v[88:91], v[20:23], v[240:243], v[88:91]
    s_waitcnt lgkmcnt(12)
    ds_read_b64_tr_b16 v[36:37], v5 offset:96
    v_mfma_f32_16x16x32_bf16 v[92:95], v[20:23], v[244:247], v[92:95]
    ds_read_b64_tr_b16 v[38:39], v5 offset:4704
    s_waitcnt lgkmcnt(12)
    ds_read_b128 v[168:171], v14 offset:384
    v_mfma_f32_16x16x32_bf16 v[96:99], v[24:27], v[240:243], v[96:99]
    ds_read_b64_tr_b16 v[20:21], v5 offset:128
    v_mfma_f32_16x16x32_bf16 v[100:103], v[24:27], v[244:247], v[100:103]
    s_waitcnt lgkmcnt(12)
    ds_read_b64_tr_b16 v[22:23], v5 offset:4736
    ds_read_b128 v[172:175], v14 offset:448
    v_mfma_f32_16x16x32_bf16 v[104:107], v[28:31], v[240:243], v[104:107]
    s_waitcnt lgkmcnt(12)
    ds_read_b64_tr_b16 v[24:25], v5 offset:160
    v_mfma_f32_16x16x32_bf16 v[108:111], v[28:31], v[244:247], v[108:111]
    ds_read_b64_tr_b16 v[26:27], v5 offset:4768
    s_waitcnt lgkmcnt(12)
    ds_read_b128 v[176:179], v14 offset:512
    v_mfma_f32_16x16x32_bf16 v[40:43], v[32:35], v[248:251], v[40:43]
    ds_read_b64_tr_b16 v[28:29], v5 offset:192
    v_mfma_f32_16x16x32_bf16 v[44:47], v[32:35], v[252:255], v[44:47]
    s_waitcnt lgkmcnt(12)
    ds_read_b64_tr_b16 v[30:31], v5 offset:4800
    ds_read_b128 v[180:183], v14 offset:576
    v_mfma_f32_16x16x32_bf16 v[48:51], v[112:115], v[248:251], v[48:51]
    s_waitcnt lgkmcnt(12)
    ds_read_b64_tr_b16 v[32:33], v5 offset:224
    v_mfma_f32_16x16x32_bf16 v[52:55], v[112:115], v[252:255], v[52:55]
    ds_read_b64_tr_b16 v[34:35], v5 offset:4832
    s_waitcnt lgkmcnt(12)
    ds_read_b128 v[184:187], v14 offset:640
    v_mfma_f32_16x16x32_bf16 v[56:59], v[116:119], v[248:251], v[56:59]
    ds_read_b64_tr_b16 v[112:113], v5 offset:256
    v_mfma_f32_16x16x32_bf16 v[60:63], v[116:119], v[252:255], v[60:63]
    s_waitcnt lgkmcnt(12)
    ds_read_b64_tr_b16 v[114:115], v5 offset:4864
    ds_read_b128 v[188:191], v14 offset:704
    v_mfma_f32_16x16x32_bf16 v[64:67], v[36:39], v[248:251], v[64:67]
    v_mfma_f32_16x16x32_bf16 v[68:71], v[36:39], v[252:255], v[68:71]
    s_waitcnt lgkmcnt(12)
    ds_read_b128 v[192:195], v14 offset:768
    v_mfma_f32_16x16x32_bf16 v[72:75], v[20:23], v[248:251], v[72:75]
    v_mfma_f32_16x16x32_bf16 v[76:79], v[20:23], v[252:255], v[76:79]
    s_waitcnt lgkmcnt(11)
    v_mfma_f32_16x16x32_bf16 v[80:83], v[24:27], v[248:251], v[80:83]
    v_mfma_f32_16x16x32_bf16 v[84:87], v[24:27], v[252:255], v[84:87]
    s_waitcnt lgkmcnt(8)
    v_mfma_f32_16x16x32_bf16 v[88:91], v[28:31], v[248:251], v[88:91]
    v_mfma_f32_16x16x32_bf16 v[92:95], v[28:31], v[252:255], v[92:95]
    s_waitcnt lgkmcnt(5)
    v_mfma_f32_16x16x32_bf16 v[96:99], v[32:35], v[248:251], v[96:99]
    v_mfma_f32_16x16x32_bf16 v[100:103], v[32:35], v[252:255], v[100:103]
    s_waitcnt lgkmcnt(2)
    v_mfma_f32_16x16x32_bf16 v[104:107], v[112:115], v[248:251], v[104:107]
    v_mfma_f32_16x16x32_bf16 v[108:111], v[112:115], v[252:255], v[108:111]
    s_add_u32 m0, s50, 0
    v_mov_b32 v0, 60
    s_mov_b64 exec, 1
    global_load_lds_dword v0, s[48:49]
    s_mov_b64 exec, -1
    s_and_b32 s64, s63, 1
    s_lshl_b32 s64, s64, 9
    s_add_u32 s67, s64, s75
    v_lshlrev_b32 v16, 3, v1
    v_add_u32 v7, 147456, v16
    s_lshl_b32 s64, s63, 8
    s_add_u32 s79, s64, s77
    s_waitcnt lgkmcnt(0)
    v_pk_fma_f32 v[40:41], v[160:161], v[152:153], v[40:41] op_sel_hi:[1,0,1]
    v_pk_fma_f32 v[42:43], v[162:163], v[152:153], v[42:43] op_sel_hi:[1,0,1]
    v_pk_fma_f32 v[44:45], v[160:161], v[156:157], v[44:45] op_sel_hi:[1,0,1]
    v_pk_fma_f32 v[46:47], v[162:163], v[156:157], v[46:47] op_sel_hi:[1,0,1]
    v_pk_mul_f32 v[200:201], v[40:41], v[40:41]
    v_pk_mul_f32 v[202:203], v[42:43], v[42:43]
    v_pk_mul_f32 v[204:205], v[44:45], v[44:45]
    v_pk_mul_f32 v[206:207], v[46:47], v[46:47]
    v_pk_fma_f32 v[200:201], v[200:201], v[154:155], v[154:155] op_sel:[0,1,0] op_sel_hi:[1,1,0]
    v_pk_fma_f32 v[202:203], v[202:203], v[154:155], v[154:155] op_sel:[0,1,0] op_sel_hi:[1,1,0]
    v_pk_fma_f32 v[204:205], v[204:205], v[158:159], v[158:159] op_sel:[0,1,0] op_sel_hi:[1,1,0]
    v_pk_fma_f32 v[206:207], v[206:207], v[158:159], v[158:159] op_sel:[0,1,0] op_sel_hi:[1,1,0]
    v_pk_mul_f32 v[200:201], v[200:201], v[40:41]
    v_pk_mul_f32 v[202:203], v[202:203], v[42:43]
    v_pk_mul_f32 v[204:205], v[204:205], v[44:45]
    v_pk_mul_f32 v[206:207], v[206:207], v[46:47]
    v_exp_f32 v200, v200
    v_exp_f32 v201, v201
    v_exp_f32 v202, v202
    v_exp_f32 v203, v203
    v_exp_f32 v204, v204
    v_exp_f32 v205, v205
    v_exp_f32 v206, v206
    v_exp_f32 v207, v207
    v_pk_fma_f32 v[200:201], v[200:201], v[152:153], v[152:153] op_sel:[0,1,1] op_sel_hi:[1,1,1]
    v_pk_fma_f32 v[202:203], v[202:203], v[152:153], v[152:153] op_sel:[0,1,1] op_sel_hi:[1,1,1]
    v_pk_fma_f32 v[204:205], v[204:205], v[156:157], v[156:157] op_sel:[0,1,1] op_sel_hi:[1,1,1]
    v_pk_fma_f32 v[206:207], v[206:207], v[156:157], v[156:157] op_sel:[0,1,1] op_sel_hi:[1,1,1]
    v_rcp_f32 v200, v200
    v_rcp_f32 v201, v201
    v_rcp_f32 v202, v202
    v_rcp_f32 v203, v203
    v_rcp_f32 v204, v204
    v_rcp_f32 v205, v205
    v_rcp_f32 v206, v206
    v_rcp_f32 v207, v207
    v_pk_mul_f32 v[40:41], v[40:41], v[200:201]
    v_pk_mul_f32 v[42:43], v[42:43], v[202:203]
    v_pk_mul_f32 v[44:45], v[44:45], v[204:205]
    v_pk_mul_f32 v[46:47], v[46:47], v[206:207]
    v_cvt_pk_bf16_f32 v112, v40, v41
    v_cvt_pk_bf16_f32 v113, v42, v43
    v_cvt_pk_bf16_f32 v116, v44, v45
    v_cvt_pk_bf16_f32 v117, v46, v47
    v_pk_fma_f32 v[48:49], v[164:165], v[152:153], v[48:49] op_sel_hi:[1,0,1]
    v_pk_fma_f32 v[50:51], v[166:167], v[152:153], v[50:51] op_sel_hi:[1,0,1]
    v_pk_fma_f32 v[52:53], v[164:165], v[156:157], v[52:53] op_sel_hi:[1,0,1]
    v_pk_fma_f32 v[54:55], v[166:167], v[156:157], v[54:55] op_sel_hi:[1,0,1]
    v_pk_mul_f32 v[200:201], v[48:49], v[48:49]
    v_pk_mul_f32 v[202:203], v[50:51], v[50:51]
    v_pk_mul_f32 v[204:205], v[52:53], v[52:53]
    v_pk_mul_f32 v[206:207], v[54:55], v[54:55]
    v_pk_fma_f32 v[200:201], v[200:201], v[154:155], v[154:155] op_sel:[0,1,0] op_sel_hi:[1,1,0]
    v_pk_fma_f32 v[202:203], v[202:203], v[154:155], v[154:155] op_sel:[0,1,0] op_sel_hi:[1,1,0]
    v_pk_fma_f32 v[204:205], v[204:205], v[158:159], v[158:159] op_sel:[0,1,0] op_sel_hi:[1,1,0]
    v_pk_fma_f32 v[206:207], v[206:207], v[158:159], v[158:159] op_sel:[0,1,0] op_sel_hi:[1,1,0]
    v_pk_mul_f32 v[200:201], v[200:201], v[48:49]
    v_pk_mul_f32 v[202:203], v[202:203], v[50:51]
    v_pk_mul_f32 v[204:205], v[204:205], v[52:53]
    v_pk_mul_f32 v[206:207], v[206:207], v[54:55]
    v_exp_f32 v200, v200
    v_exp_f32 v201, v201
    v_exp_f32 v202, v202
    v_exp_f32 v203, v203
    v_exp_f32 v204, v204
    v_exp_f32 v205, v205
    v_exp_f32 v206, v206
    v_exp_f32 v207, v207
    v_pk_fma_f32 v[200:201], v[200:201], v[152:153], v[152:153] op_sel:[0,1,1] op_sel_hi:[1,1,1]
    v_pk_fma_f32 v[202:203], v[202:203], v[152:153], v[152:153] op_sel:[0,1,1] op_sel_hi:[1,1,1]
    v_pk_fma_f32 v[204:205], v[204:205], v[156:157], v[156:157] op_sel:[0,1,1] op_sel_hi:[1,1,1]
    v_pk_fma_f32 v[206:207], v[206:207], v[156:157], v[156:157] op_sel:[0,1,1] op_sel_hi:[1,1,1]
    v_rcp_f32 v200, v200
    v_rcp_f32 v201, v201
    v_rcp_f32 v202, v202
    v_rcp_f32 v203, v203
    v_rcp_f32 v204, v204
    v_rcp_f32 v205, v205
    v_rcp_f32 v206, v206
    v_rcp_f32 v207, v207
    v_pk_mul_f32 v[48:49], v[48:49], v[200:201]
    v_pk_mul_f32 v[50:51], v[50:51], v[202:203]
    v_pk_mul_f32 v[52:53], v[52:53], v[204:205]
    v_pk_mul_f32 v[54:55], v[54:55], v[206:207]
    v_cvt_pk_bf16_f32 v114, v48, v49
    v_cvt_pk_bf16_f32 v115, v50, v51
    v_cvt_pk_bf16_f32 v118, v52, v53
    v_cvt_pk_bf16_f32 v119, v54, v55
    buffer_store_dwordx4 v[112:115], v4, s[44:47], s71 offen offset:0 sc1
    buffer_store_dwordx4 v[116:119], v17, s[44:47], s71 offen offset:0 sc1
    v_pk_fma_f32 v[56:57], v[168:169], v[152:153], v[56:57] op_sel_hi:[1,0,1]
    v_pk_fma_f32 v[58:59], v[170:171], v[152:153], v[58:59] op_sel_hi:[1,0,1]
    v_pk_fma_f32 v[60:61], v[168:169], v[156:157], v[60:61] op_sel_hi:[1,0,1]
    v_pk_fma_f32 v[62:63], v[170:171], v[156:157], v[62:63] op_sel_hi:[1,0,1]
    v_pk_mul_f32 v[200:201], v[56:57], v[56:57]
    v_pk_mul_f32 v[202:203], v[58:59], v[58:59]
    v_pk_mul_f32 v[204:205], v[60:61], v[60:61]
    v_pk_mul_f32 v[206:207], v[62:63], v[62:63]
    v_pk_fma_f32 v[200:201], v[200:201], v[154:155], v[154:155] op_sel:[0,1,0] op_sel_hi:[1,1,0]
    v_pk_fma_f32 v[202:203], v[202:203], v[154:155], v[154:155] op_sel:[0,1,0] op_sel_hi:[1,1,0]
    v_pk_fma_f32 v[204:205], v[204:205], v[158:159], v[158:159] op_sel:[0,1,0] op_sel_hi:[1,1,0]
    v_pk_fma_f32 v[206:207], v[206:207], v[158:159], v[158:159] op_sel:[0,1,0] op_sel_hi:[1,1,0]
    v_pk_mul_f32 v[200:201], v[200:201], v[56:57]
    v_pk_mul_f32 v[202:203], v[202:203], v[58:59]
    v_pk_mul_f32 v[204:205], v[204:205], v[60:61]
    v_pk_mul_f32 v[206:207], v[206:207], v[62:63]
    v_exp_f32 v200, v200
    v_exp_f32 v201, v201
    v_exp_f32 v202, v202
    v_exp_f32 v203, v203
    v_exp_f32 v204, v204
    v_exp_f32 v205, v205
    v_exp_f32 v206, v206
    v_exp_f32 v207, v207
    v_pk_fma_f32 v[200:201], v[200:201], v[152:153], v[152:153] op_sel:[0,1,1] op_sel_hi:[1,1,1]
    v_pk_fma_f32 v[202:203], v[202:203], v[152:153], v[152:153] op_sel:[0,1,1] op_sel_hi:[1,1,1]
    v_pk_fma_f32 v[204:205], v[204:205], v[156:157], v[156:157] op_sel:[0,1,1] op_sel_hi:[1,1,1]
    v_pk_fma_f32 v[206:207], v[206:207], v[156:157], v[156:157] op_sel:[0,1,1] op_sel_hi:[1,1,1]
    v_rcp_f32 v200, v200
    v_rcp_f32 v201, v201
    v_rcp_f32 v202, v202
    v_rcp_f32 v203, v203
    v_rcp_f32 v204, v204
    v_rcp_f32 v205, v205
    v_rcp_f32 v206, v206
    v_rcp_f32 v207, v207
    v_pk_mul_f32 v[56:57], v[56:57], v[200:201]
    v_pk_mul_f32 v[58:59], v[58:59], v[202:203]
    v_pk_mul_f32 v[60:61], v[60:61], v[204:205]
    v_pk_mul_f32 v[62:63], v[62:63], v[206:207]
    v_cvt_pk_bf16_f32 v120, v56, v57
    v_cvt_pk_bf16_f32 v121, v58, v59
    v_cvt_pk_bf16_f32 v124, v60, v61
    v_cvt_pk_bf16_f32 v125, v62, v63
    v_pk_fma_f32 v[64:65], v[172:173], v[152:153], v[64:65] op_sel_hi:[1,0,1]
    v_pk_fma_f32 v[66:67], v[174:175], v[152:153], v[66:67] op_sel_hi:[1,0,1]
    v_pk_fma_f32 v[68:69], v[172:173], v[156:157], v[68:69] op_sel_hi:[1,0,1]
    v_pk_fma_f32 v[70:71], v[174:175], v[156:157], v[70:71] op_sel_hi:[1,0,1]
    v_pk_mul_f32 v[200:201], v[64:65], v[64:65]
    v_pk_mul_f32 v[202:203], v[66:67], v[66:67]
    v_pk_mul_f32 v[204:205], v[68:69], v[68:69]
    v_pk_mul_f32 v[206:207], v[70:71], v[70:71]
    v_pk_fma_f32 v[200:201], v[200:201], v[154:155], v[154:155] op_sel:[0,1,0] op_sel_hi:[1,1,0]
    v_pk_fma_f32 v[202:203], v[202:203], v[154:155], v[154:155] op_sel:[0,1,0] op_sel_hi:[1,1,0]
    v_pk_fma_f32 v[204:205], v[204:205], v[158:159], v[158:159] op_sel:[0,1,0] op_sel_hi:[1,1,0]
    v_pk_fma_f32 v[206:207], v[206:207], v[158:159], v[158:159] op_sel:[0,1,0] op_sel_hi:[1,1,0]
    v_pk_mul_f32 v[200:201], v[200:201], v[64:65]
    v_pk_mul_f32 v[202:203], v[202:203], v[66:67]
    v_pk_mul_f32 v[204:205], v[204:205], v[68:69]
    v_pk_mul_f32 v[206:207], v[206:207], v[70:71]
    v_exp_f32 v200, v200
    v_exp_f32 v201, v201
    v_exp_f32 v202, v202
    v_exp_f32 v203, v203
    v_exp_f32 v204, v204
    v_exp_f32 v205, v205
    v_exp_f32 v206, v206
    v_exp_f32 v207, v207
    v_pk_fma_f32 v[200:201], v[200:201], v[152:153], v[152:153] op_sel:[0,1,1] op_sel_hi:[1,1,1]
    v_pk_fma_f32 v[202:203], v[202:203], v[152:153], v[152:153] op_sel:[0,1,1] op_sel_hi:[1,1,1]
    v_pk_fma_f32 v[204:205], v[204:205], v[156:157], v[156:157] op_sel:[0,1,1] op_sel_hi:[1,1,1]
    v_pk_fma_f32 v[206:207], v[206:207], v[156:157], v[156:157] op_sel:[0,1,1] op_sel_hi:[1,1,1]
    v_rcp_f32 v200, v200
    v_rcp_f32 v201, v201
    v_rcp_f32 v202, v202
    v_rcp_f32 v203, v203
    v_rcp_f32 v204, v204
    v_rcp_f32 v205, v205
    v_rcp_f32 v206, v206
    v_rcp_f32 v207, v207
    v_pk_mul_f32 v[64:65], v[64:65], v[200:201]
    v_pk_mul_f32 v[66:67], v[66:67], v[202:203]
    v_pk_mul_f32 v[68:69], v[68:69], v[204:205]
    v_pk_mul_f32 v[70:71], v[70:71], v[206:207]
    v_cvt_pk_bf16_f32 v122, v64, v65
    v_cvt_pk_bf16_f32 v123, v66, v67
    v_cvt_pk_bf16_f32 v126, v68, v69
    v_cvt_pk_bf16_f32 v127, v70, v71
    buffer_store_dwordx4 v[120:123], v4, s[44:47], s71 offen offset:1024 sc1
    buffer_store_dwordx4 v[124:127], v17, s[44:47], s71 offen offset:1024 sc1
    v_pk_fma_f32 v[72:73], v[176:177], v[152:153], v[72:73] op_sel_hi:[1,0,1]
    v_pk_fma_f32 v[74:75], v[178:179], v[152:153], v[74:75] op_sel_hi:[1,0,1]
    v_pk_fma_f32 v[76:77], v[176:177], v[156:157], v[76:77] op_sel_hi:[1,0,1]
    v_pk_fma_f32 v[78:79], v[178:179], v[156:157], v[78:79] op_sel_hi:[1,0,1]
    v_pk_mul_f32 v[200:201], v[72:73], v[72:73]
    v_pk_mul_f32 v[202:203], v[74:75], v[74:75]
    v_pk_mul_f32 v[204:205], v[76:77], v[76:77]
    v_pk_mul_f32 v[206:207], v[78:79], v[78:79]
    v_pk_fma_f32 v[200:201], v[200:201], v[154:155], v[154:155] op_sel:[0,1,0] op_sel_hi:[1,1,0]
    v_pk_fma_f32 v[202:203], v[202:203], v[154:155], v[154:155] op_sel:[0,1,0] op_sel_hi:[1,1,0]
    v_pk_fma_f32 v[204:205], v[204:205], v[158:159], v[158:159] op_sel:[0,1,0] op_sel_hi:[1,1,0]
    v_pk_fma_f32 v[206:207], v[206:207], v[158:159], v[158:159] op_sel:[0,1,0] op_sel_hi:[1,1,0]
    v_pk_mul_f32 v[200:201], v[200:201], v[72:73]
    v_pk_mul_f32 v[202:203], v[202:203], v[74:75]
    v_pk_mul_f32 v[204:205], v[204:205], v[76:77]
    v_pk_mul_f32 v[206:207], v[206:207], v[78:79]
    v_exp_f32 v200, v200
    v_exp_f32 v201, v201
    v_exp_f32 v202, v202
    v_exp_f32 v203, v203
    v_exp_f32 v204, v204
    v_exp_f32 v205, v205
    v_exp_f32 v206, v206
    v_exp_f32 v207, v207
    v_pk_fma_f32 v[200:201], v[200:201], v[152:153], v[152:153] op_sel:[0,1,1] op_sel_hi:[1,1,1]
    v_pk_fma_f32 v[202:203], v[202:203], v[152:153], v[152:153] op_sel:[0,1,1] op_sel_hi:[1,1,1]
    v_pk_fma_f32 v[204:205], v[204:205], v[156:157], v[156:157] op_sel:[0,1,1] op_sel_hi:[1,1,1]
    v_pk_fma_f32 v[206:207], v[206:207], v[156:157], v[156:157] op_sel:[0,1,1] op_sel_hi:[1,1,1]
    v_rcp_f32 v200, v200
    v_rcp_f32 v201, v201
    v_rcp_f32 v202, v202
    v_rcp_f32 v203, v203
    v_rcp_f32 v204, v204
    v_rcp_f32 v205, v205
    v_rcp_f32 v206, v206
    v_rcp_f32 v207, v207
    v_pk_mul_f32 v[72:73], v[72:73], v[200:201]
    v_pk_mul_f32 v[74:75], v[74:75], v[202:203]
    v_pk_mul_f32 v[76:77], v[76:77], v[204:205]
    v_pk_mul_f32 v[78:79], v[78:79], v[206:207]
    v_cvt_pk_bf16_f32 v128, v72, v73
    v_cvt_pk_bf16_f32 v129, v74, v75
    v_cvt_pk_bf16_f32 v132, v76, v77
    v_cvt_pk_bf16_f32 v133, v78, v79
    v_pk_fma_f32 v[80:81], v[180:181], v[152:153], v[80:81] op_sel_hi:[1,0,1]
    v_pk_fma_f32 v[82:83], v[182:183], v[152:153], v[82:83] op_sel_hi:[1,0,1]
    v_pk_fma_f32 v[84:85], v[180:181], v[156:157], v[84:85] op_sel_hi:[1,0,1]
    v_pk_fma_f32 v[86:87], v[182:183], v[156:157], v[86:87] op_sel_hi:[1,0,1]
    v_pk_mul_f32 v[200:201], v[80:81], v[80:81]
    v_pk_mul_f32 v[202:203], v[82:83], v[82:83]
    v_pk_mul_f32 v[204:205], v[84:85], v[84:85]
    v_pk_mul_f32 v[206:207], v[86:87], v[86:87]
    v_pk_fma_f32 v[200:201], v[200:201], v[154:155], v[154:155] op_sel:[0,1,0] op_sel_hi:[1,1,0]
    v_pk_fma_f32 v[202:203], v[202:203], v[154:155], v[154:155] op_sel:[0,1,0] op_sel_hi:[1,1,0]
    v_pk_fma_f32 v[204:205], v[204:205], v[158:159], v[158:159] op_sel:[0,1,0] op_sel_hi:[1,1,0]
    v_pk_fma_f32 v[206:207], v[206:207], v[158:159], v[158:159] op_sel:[0,1,0] op_sel_hi:[1,1,0]
    v_pk_mul_f32 v[200:201], v[200:201], v[80:81]
    v_pk_mul_f32 v[202:203], v[202:203], v[82:83]
    v_pk_mul_f32 v[204:205], v[204:205], v[84:85]
    v_pk_mul_f32 v[206:207], v[206:207], v[86:87]
    v_exp_f32 v200, v200
    v_exp_f32 v201, v201
    v_exp_f32 v202, v202
    v_exp_f32 v203, v203
    v_exp_f32 v204, v204
    v_exp_f32 v205, v205
    v_exp_f32 v206, v206
    v_exp_f32 v207, v207
    v_pk_fma_f32 v[200:201], v[200:201], v[152:153], v[152:153] op_sel:[0,1,1] op_sel_hi:[1,1,1]
    v_pk_fma_f32 v[202:203], v[202:203], v[152:153], v[152:153] op_sel:[0,1,1] op_sel_hi:[1,1,1]
    v_pk_fma_f32 v[204:205], v[204:205], v[156:157], v[156:157] op_sel:[0,1,1] op_sel_hi:[1,1,1]
    v_pk_fma_f32 v[206:207], v[206:207], v[156:157], v[156:157] op_sel:[0,1,1] op_sel_hi:[1,1,1]
    v_rcp_f32 v200, v200
    v_rcp_f32 v201, v201
    v_rcp_f32 v202, v202
    v_rcp_f32 v203, v203
    v_rcp_f32 v204, v204
    v_rcp_f32 v205, v205
    v_rcp_f32 v206, v206
    v_rcp_f32 v207, v207
    v_pk_mul_f32 v[80:81], v[80:81], v[200:201]
    v_pk_mul_f32 v[82:83], v[82:83], v[202:203]
    v_pk_mul_f32 v[84:85], v[84:85], v[204:205]
    v_pk_mul_f32 v[86:87], v[86:87], v[206:207]
    v_cvt_pk_bf16_f32 v130, v80, v81
    v_cvt_pk_bf16_f32 v131, v82, v83
    v_cvt_pk_bf16_f32 v134, v84, v85
    v_cvt_pk_bf16_f32 v135, v86, v87
    buffer_store_dwordx4 v[128:131], v4, s[44:47], s71 offen offset:2048 sc1
    buffer_store_dwordx4 v[132:135], v17, s[44:47], s71 offen offset:2048 sc1
    v_pk_fma_f32 v[88:89], v[184:185], v[152:153], v[88:89] op_sel_hi:[1,0,1]
    v_pk_fma_f32 v[90:91], v[186:187], v[152:153], v[90:91] op_sel_hi:[1,0,1]
    v_pk_fma_f32 v[92:93], v[184:185], v[156:157], v[92:93] op_sel_hi:[1,0,1]
    v_pk_fma_f32 v[94:95], v[186:187], v[156:157], v[94:95] op_sel_hi:[1,0,1]
    v_pk_mul_f32 v[200:201], v[88:89], v[88:89]
    v_pk_mul_f32 v[202:203], v[90:91], v[90:91]
    v_pk_mul_f32 v[204:205], v[92:93], v[92:93]
    v_pk_mul_f32 v[206:207], v[94:95], v[94:95]
    v_pk_fma_f32 v[200:201], v[200:201], v[154:155], v[154:155] op_sel:[0,1,0] op_sel_hi:[1,1,0]
    v_pk_fma_f32 v[202:203], v[202:203], v[154:155], v[154:155] op_sel:[0,1,0] op_sel_hi:[1,1,0]
    v_pk_fma_f32 v[204:205], v[204:205], v[158:159], v[158:159] op_sel:[0,1,0] op_sel_hi:[1,1,0]
    v_pk_fma_f32 v[206:207], v[206:207], v[158:159], v[158:159] op_sel:[0,1,0] op_sel_hi:[1,1,0]
    v_pk_mul_f32 v[200:201], v[200:201], v[88:89]
    v_pk_mul_f32 v[202:203], v[202:203], v[90:91]
    v_pk_mul_f32 v[204:205], v[204:205], v[92:93]
    v_pk_mul_f32 v[206:207], v[206:207], v[94:95]
    v_exp_f32 v200, v200
    v_exp_f32 v201, v201
    v_exp_f32 v202, v202
    v_exp_f32 v203, v203
    v_exp_f32 v204, v204
    v_exp_f32 v205, v205
    v_exp_f32 v206, v206
    v_exp_f32 v207, v207
    v_pk_fma_f32 v[200:201], v[200:201], v[152:153], v[152:153] op_sel:[0,1,1] op_sel_hi:[1,1,1]
    v_pk_fma_f32 v[202:203], v[202:203], v[152:153], v[152:153] op_sel:[0,1,1] op_sel_hi:[1,1,1]
    v_pk_fma_f32 v[204:205], v[204:205], v[156:157], v[156:157] op_sel:[0,1,1] op_sel_hi:[1,1,1]
    v_pk_fma_f32 v[206:207], v[206:207], v[156:157], v[156:157] op_sel:[0,1,1] op_sel_hi:[1,1,1]
    v_rcp_f32 v200, v200
    v_rcp_f32 v201, v201
    v_rcp_f32 v202, v202
    v_rcp_f32 v203, v203
    v_rcp_f32 v204, v204
    v_rcp_f32 v205, v205
    v_rcp_f32 v206, v206
    v_rcp_f32 v207, v207
    v_pk_mul_f32 v[88:89], v[88:89], v[200:201]
    v_pk_mul_f32 v[90:91], v[90:91], v[202:203]
    v_pk_mul_f32 v[92:93], v[92:93], v[204:205]
    v_pk_mul_f32 v[94:95], v[94:95], v[206:207]
    v_cvt_pk_bf16_f32 v136, v88, v89
    v_cvt_pk_bf16_f32 v137, v90, v91
    v_cvt_pk_bf16_f32 v140, v92, v93
    v_cvt_pk_bf16_f32 v141, v94, v95
    v_mov_b32 v12, s80
    v_mov_b32 v13, s80
    v_mov_b32 v14, s80
    v_mov_b32 v15, s80
    s_add_u32 s65, s79, 25165824
    s_waitcnt vmcnt(2)
    s_mov_b64 exec, 0xff
    buffer_store_dwordx4 v[12:15], v4, s[44:47], s79 offen
    buffer_store_dwordx4 v[12:15], v4, s[44:47], s65 offen sc1
    s_mov_b64 exec, -1
    v_pk_fma_f32 v[96:97], v[188:189], v[152:153], v[96:97] op_sel_hi:[1,0,1]
    v_pk_fma_f32 v[98:99], v[190:191], v[152:153], v[98:99] op_sel_hi:[1,0,1]
    v_pk_fma_f32 v[100:101], v[188:189], v[156:157], v[100:101] op_sel_hi:[1,0,1]
    v_pk_fma_f32 v[102:103], v[190:191], v[156:157], v[102:103] op_sel_hi:[1,0,1]
    v_pk_mul_f32 v[200:201], v[96:97], v[96:97]
    v_pk_mul_f32 v[202:203], v[98:99], v[98:99]
    v_pk_mul_f32 v[204:205], v[100:101], v[100:101]
    v_pk_mul_f32 v[206:207], v[102:103], v[102:103]
    v_pk_fma_f32 v[200:201], v[200:201], v[154:155], v[154:155] op_sel:[0,1,0] op_sel_hi:[1,1,0]
    v_pk_fma_f32 v[202:203], v[202:203], v[154:155], v[154:155] op_sel:[0,1,0] op_sel_hi:[1,1,0]
    v_pk_fma_f32 v[204:205], v[204:205], v[158:159], v[158:159] op_sel:[0,1,0] op_sel_hi:[1,1,0]
    v_pk_fma_f32 v[206:207], v[206:207], v[158:159], v[158:159] op_sel:[0,1,0] op_sel_hi:[1,1,0]
    v_pk_mul_f32 v[200:201], v[200:201], v[96:97]
    v_pk_mul_f32 v[202:203], v[202:203], v[98:99]
    v_pk_mul_f32 v[204:205], v[204:205], v[100:101]
    v_pk_mul_f32 v[206:207], v[206:207], v[102:103]
    v_exp_f32 v200, v200
    v_exp_f32 v201, v201
    v_exp_f32 v202, v202
    v_exp_f32 v203, v203
    v_exp_f32 v204, v204
    v_exp_f32 v205, v205
    v_exp_f32 v206, v206
    v_exp_f32 v207, v207
    v_pk_fma_f32 v[200:201], v[200:201], v[152:153], v[152:153] op_sel:[0,1,1] op_sel_hi:[1,1,1]
    v_pk_fma_f32 v[202:203], v[202:203], v[152:153], v[152:153] op_sel:[0,1,1] op_sel_hi:[1,1,1]
    v_pk_fma_f32 v[204:205], v[204:205], v[156:157], v[156:157] op_sel:[0,1,1] op_sel_hi:[1,1,1]
    v_pk_fma_f32 v[206:207], v[206:207], v[156:157], v[156:157] op_sel:[0,1,1] op_sel_hi:[1,1,1]
    v_rcp_f32 v200, v200
    v_rcp_f32 v201, v201
    v_rcp_f32 v202, v202
    v_rcp_f32 v203, v203
    v_rcp_f32 v204, v204
    v_rcp_f32 v205, v205
    v_rcp_f32 v206, v206
    v_rcp_f32 v207, v207
    v_pk_mul_f32 v[96:97], v[96:97], v[200:201]
    v_pk_mul_f32 v[98:99], v[98:99], v[202:203]
    v_pk_mul_f32 v[100:101], v[100:101], v[204:205]
    v_pk_mul_f32 v[102:103], v[102:103], v[206:207]
    v_cvt_pk_bf16_f32 v138, v96, v97
    v_cvt_pk_bf16_f32 v139, v98, v99
    v_cvt_pk_bf16_f32 v142, v100, v101
    v_cvt_pk_bf16_f32 v143, v102, v103
    buffer_store_dwordx4 v[136:139], v4, s[44:47], s71 offen offset:3072 sc1
    buffer_store_dwordx4 v[140:143], v17, s[44:47], s71 offen offset:3072 sc1
    ds_read_b128 v[216:219], v11 offset:16
    s_mov_b32 s92, 256
    s_add_u32 s64, s58, 1
    s_and_b32 s64, s64, 7
    s_lshl_b32 s93, s64, 5
    s_add_u32 s64, s58, 2
    s_and_b32 s64, s64, 7
    s_lshl_b32 s94, s64, 5
    s_add_u32 s64, s58, 3
    s_and_b32 s64, s64, 7
    s_lshl_b32 s95, s64, 5
    s_add_u32 s64, s58, 4
    s_and_b32 s64, s64, 7
    s_lshl_b32 s96, s64, 5
    s_add_u32 s64, s58, 5
    s_and_b32 s64, s64, 7
    s_lshl_b32 s97, s64, 5
    s_add_u32 s64, s58, 6
    s_and_b32 s64, s64, 7
    s_lshl_b32 s98, s64, 5
    s_add_u32 s64, s58, 7
    s_and_b32 s64, s64, 7
    s_lshl_b32 s99, s64, 5
    s_add_u32 s64, s58, 8
    s_and_b32 s64, s64, 7
    s_lshl_b32 s100, s64, 5
    v_pk_fma_f32 v[104:105], v[192:193], v[152:153], v[104:105] op_sel_hi:[1,0,1]
    v_pk_fma_f32 v[106:107], v[194:195], v[152:153], v[106:107] op_sel_hi:[1,0,1]
    v_pk_fma_f32 v[108:109], v[192:193], v[156:157], v[108:109] op_sel_hi:[1,0,1]
    v_pk_fma_f32 v[110:111], v[194:195], v[156:157], v[110:111] op_sel_hi:[1,0,1]
    v_pk_mul_f32 v[200:201], v[104:105], v[104:105]
    v_pk_mul_f32 v[202:203], v[106:107], v[106:107]
    v_pk_mul_f32 v[204:205], v[108:109], v[108:109]
    v_pk_mul_f32 v[206:207], v[110:111], v[110:111]
    v_pk_fma_f32 v[200:201], v[200:201], v[154:155], v[154:155] op_sel:[0,1,0] op_sel_hi:[1,1,0]
    v_pk_fma_f32 v[202:203], v[202:203], v[154:155], v[154:155] op_sel:[0,1,0] op_sel_hi:[1,1,0]
    v_pk_fma_f32 v[204:205], v[204:205], v[158:159], v[158:159] op_sel:[0,1,0] op_sel_hi:[1,1,0]
    v_pk_fma_f32 v[206:207], v[206:207], v[158:159], v[158:159] op_sel:[0,1,0] op_sel_hi:[1,1,0]
    v_pk_mul_f32 v[200:201], v[200:201], v[104:105]
    v_pk_mul_f32 v[202:203], v[202:203], v[106:107]
    v_pk_mul_f32 v[204:205], v[204:205], v[108:109]
    v_pk_mul_f32 v[206:207], v[206:207], v[110:111]
    v_exp_f32 v200, v200
    v_exp_f32 v201, v201
    v_exp_f32 v202, v202
    v_exp_f32 v203, v203
    v_exp_f32 v204, v204
    v_exp_f32 v205, v205
    v_exp_f32 v206, v206
    v_exp_f32 v207, v207
    v_pk_fma_f32 v[200:201], v[200:201], v[152:153], v[152:153] op_sel:[0,1,1] op_sel_hi:[1,1,1]
    v_pk_fma_f32 v[202:203], v[202:203], v[152:153], v[152:153] op_sel:[0,1,1] op_sel_hi:[1,1,1]
    v_pk_fma_f32 v[204:205], v[204:205], v[156:157], v[156:157] op_sel:[0,1,1] op_sel_hi:[1,1,1]
    v_pk_fma_f32 v[206:207], v[206:207], v[156:157], v[156:157] op_sel:[0,1,1] op_sel_hi:[1,1,1]
    v_rcp_f32 v200, v200
    v_rcp_f32 v201, v201
    v_rcp_f32 v202, v202
    v_rcp_f32 v203, v203
    v_rcp_f32 v204, v204
    v_rcp_f32 v205, v205
    v_rcp_f32 v206, v206
    v_rcp_f32 v207, v207
    v_pk_mul_f32 v[104:105], v[104:105], v[200:201]
    v_pk_mul_f32 v[106:107], v[106:107], v[202:203]
    v_pk_mul_f32 v[108:109], v[108:109], v[204:205]
    v_pk_mul_f32 v[110:111], v[110:111], v[206:207]
    v_cvt_pk_bf16_f32 v208, v104, v105
    v_cvt_pk_bf16_f32 v209, v106, v107
    v_cvt_pk_bf16_f32 v210, v108, v109
    v_cvt_pk_bf16_f32 v211, v110, v111
    buffer_store_dwordx2 v[208:209], v16, s[44:47], s67 offen sc1
    buffer_store_dwordx2 v[210:211], v7, s[44:47], s67 offen sc1
    s_waitcnt lgkmcnt(0)
    v_min_u32 v216, v216, v217
    v_min3_u32 v216, v216, v218, v219
    s_nop 0
    v_readfirstlane_b32 s64, v216
    s_nop 0
    s_cmp_ge_u32 s64, 17
    s_cbranch_scc0 Ls_s44
Ls_r44:
    v_add_u32 v252, s92, v5
    ds_read_b64_tr_b16 v[20:21], v252 offset:9216
    ds_read_b64_tr_b16 v[22:23], v252 offset:13824
    ds_read_b64_tr_b16 v[24:25], v252 offset:18432
    ds_read_b64_tr_b16 v[26:27], v252 offset:23040
    ds_read_b64_tr_b16 v[28:29], v252 offset:27648
    ds_read_b64_tr_b16 v[30:31], v252 offset:32256
    ds_read_b64_tr_b16 v[32:33], v252 offset:36864
    ds_read_b64_tr_b16 v[34:35], v252 offset:41472
    v_add_u32 v253, s93, v5
    ds_read_b64_tr_b16 v[36:37], v253 offset:9216
    ds_read_b64_tr_b16 v[38:39], v253 offset:13824
    s_waitcnt lgkmcnt(8)
    v_mfma_f32_16x16x32_bf16 v[40:43], v[20:23], v[112:115], 0
    v_mfma_f32_16x16x32_bf16 v[44:47], v[20:23], v[116:119], 0
    s_waitcnt lgkmcnt(6)
    v_mfma_f32_16x16x32_bf16 v[40:43], v[24:27], v[120:123], v[40:43]
    ds_read_b64_tr_b16 v[20:21], v253 offset:18432
    v_mfma_f32_16x16x32_bf16 v[44:47], v[24:27], v[124:127], v[44:47]
    ds_read_b64_tr_b16 v[22:23], v253 offset:23040
    s_waitcnt lgkmcnt(6)
    v_mfma_f32_16x16x32_bf16 v[40:43], v[28:31], v[128:131], v[40:43]
    ds_read_b64_tr_b16 v[24:25], v253 offset:27648
    v_mfma_f32_16x16x32_bf16 v[44:47], v[28:31], v[132:135], v[44:47]
    ds_read_b64_tr_b16 v[26:27], v253 offset:32256
    s_waitcnt lgkmcnt(6)
    v_mfma_f32_16x16x32_bf16 v[40:43], v[32:35], v[136:139], v[40:43]
    ds_read_b64_tr_b16 v[28:29], v253 offset:36864
    v_mfma_f32_16x16x32_bf16 v[44:47], v[32:35], v[140:143], v[44:47]
    ds_read_b64_tr_b16 v[30:31], v253 offset:41472
    s_waitcnt lgkmcnt(6)
    v_mfma_f32_16x16x32_bf16 v[48:51], v[36:39], v[112:115], 0
    v_add_u32 v252, s94, v5
    ds_read_b64_tr_b16 v[32:33], v252 offset:9216
    v_mfma_f32_16x16x32_bf16 v[52:55], v[36:39], v[116:119], 0
    ds_read_b64_tr_b16 v[34:35], v252 offset:13824
    s_waitcnt lgkmcnt(6)
    v_mfma_f32_16x16x32_bf16 v[48:51], v[20:23], v[120:123], v[48:51]
    ds_read_b64_tr_b16 v[36:37], v252 offset:18432
    v_mfma_f32_16x16x32_bf16 v[52:55], v[20:23], v[124:127], v[52:55]
    ds_read_b64_tr_b16 v[38:39], v252 offset:23040
    s_waitcnt lgkmcnt(6)
    v_mfma_f32_16x16x32_bf16 v[48:51], v[24:27], v[128:131], v[48:51]
    ds_read_b64_tr_b16 v[20:21], v252 offset:27648
    buffer_load_dword v19, v18, s[44:47], s77 offen sc1
    v_mfma_f32_16x16x32_bf16 v[52:55], v[24:27], v[132:135], v[52:55]
    ds_read_b64_tr_b16 v[22:23], v252 offset:32256
    s_waitcnt lgkmcnt(6)
    v_mfma_f32_16x16x32_bf16 v[48:51], v[28:31], v[136:139], v[48:51]
    ds_read_b64_tr_b16 v[24:25], v252 offset:36864
    v_mfma_f32_16x16x32_bf16 v[52:55], v[28:31], v[140:143], v[52:55]
    ds_read_b64_tr_b16 v[26:27], v252 offset:41472
    s_waitcnt lgkmcnt(6)
    v_mfma_f32_16x16x32_bf16 v[56:59], v[32:35], v[112:115], 0
    v_add_u32 v253, s95, v5
    ds_read_b64_tr_b16 v[28:29], v253 offset:9216
    v_mfma_f32_16x16x32_bf16 v[60:63], v[32:35], v[116:119], 0
    ds_read_b64_tr_b16 v[30:31], v253 offset:13824
    s_waitcnt lgkmcnt(6)
    v_mfma_f32_16x16x32_bf16 v[56:59], v[36:39], v[120:123], v[56:59]
    ds_read_b64_tr_b16 v[32:33], v253 offset:18432
    v_mfma_f32_16x16x32_bf16 v[60:63], v[36:39], v[124:127], v[60:63]
    ds_read_b64_tr_b16 v[34:35], v253 offset:23040
    s_waitcnt lgkmcnt(6)
    v_mfma_f32_16x16x32_bf16 v[56:59], v[20:23], v[128:131], v[56:59]
    ds_read_b64_tr_b16 v[36:37], v253 offset:27648
    v_mfma_f32_16x16x32_bf16 v[60:63], v[20:23], v[132:135], v[60:63]
    ds_read_b64_tr_b16 v[38:39], v253 offset:32256
    s_waitcnt lgkmcnt(6)
    v_mfma_f32_16x16x32_bf16 v[56:59], v[24:27], v[136:139], v[56:59]
    ds_read_b64_tr_b16 v[20:21], v253 offset:36864
    v_mfma_f32_16x16x32_bf16 v[60:63], v[24:27], v[140:143], v[60:63]
    ds_read_b64_tr_b16 v[22:23], v253 offset:41472
    s_waitcnt lgkmcnt(6)
    v_mfma_f32_16x16x32_bf16 v[64:67], v[28:31], v[112:115], 0
    v_add_u32 v252, s96, v5
    ds_read_b64_tr_b16 v[24:25], v252 offset:9216
    v_mfma_f32_16x16x32_bf16 v[68:71], v[28:31], v[116:119], 0
    ds_read_b64_tr_b16 v[26:27], v252 offset:13824
    s_waitcnt lgkmcnt(6)
    v_mfma_f32_16x16x32_bf16 v[64:67], v[32:35], v[120:123], v[64:67]
    ds_read_b64_tr_b16 v[28:29], v252 offset:18432
    v_mfma_f32_16x16x32_bf16 v[68:71], v[32:35], v[124:127], v[68:71]
    ds_read_b64_tr_b16 v[30:31], v252 offset:23040
    s_waitcnt lgkmcnt(6)
    v_mfma_f32_16x16x32_bf16 v[64:67], v[36:39], v[128:131], v[64:67]
    ds_read_b64_tr_b16 v[32:33], v252 offset:27648
    v_mfma_f32_16x16x32_bf16 v[68:71], v[36:39], v[132:135], v[68:71]
    ds_read_b64_tr_b16 v[34:35], v252 offset:32256
    s_waitcnt lgkmcnt(6)
    v_mfma_f32_16x16x32_bf16 v[64:67], v[20:23], v[136:139], v[64:67]
    ds_read_b64_tr_b16 v[36:37], v252 offset:36864
    v_mfma_f32_16x16x32_bf16 v[68:71], v[20:23], v[140:143], v[68:71]
    ds_read_b64_tr_b16 v[38:39], v252 offset:41472
    s_waitcnt vmcnt(0)
    v_subrev_u32 v19, s56, v19
    v_cmp_le_u32 vcc, 16, v19
    s_nop 0
    s_and_b32 s64, vcc_lo, 85
    s_cmp_eq_u32 s64, 0
    s_cbranch_scc0 Ls_s45
Ls_r45:
    s_waitcnt lgkmcnt(6)
    v_mfma_f32_16x16x32_bf16 v[72:75], v[24:27], v[112:115], 0
    v_add_u32 v253, s97, v5
    ds_read_b64_tr_b16 v[20:21], v253 offset:9216
    v_mfma_f32_16x16x32_bf16 v[76:79], v[24:27], v[116:119], 0
    ds_read_b64_tr_b16 v[22:23], v253 offset:13824
    s_add_u32 s64, s79, 128
    v_mov_b32 v248, s80
    v_mov_b32 v249, s80
    v_mov_b32 v250, s80
    v_mov_b32 v251, s80
    s_add_u32 s65, s64, 25165824
    s_mov_b64 exec, 0xff
    buffer_store_dwordx4 v[248:251], v4, s[44:47], s64 offen
    buffer_store_dwordx4 v[248:251], v4, s[44:47], s65 offen sc1
    s_mov_b64 exec, -1
    s_waitcnt lgkmcnt(6)
    v_mfma_f32_16x16x32_bf16 v[72:75], v[28:31], v[120:123], v[72:75]
    ds_read_b64_tr_b16 v[24:25], v253 offset:18432
    buffer_load_dwordx4 v[144:147], v4, s[44:47], s72 offen offset:0 sc1
    v_mfma_f32_16x16x32_bf16 v[76:79], v[28:31], v[124:127], v[76:79]
    ds_read_b64_tr_b16 v[26:27], v253 offset:23040
    s_waitcnt lgkmcnt(6)
    v_mfma_f32_16x16x32_bf16 v[72:75], v[32:35], v[128:131], v[72:75]
    ds_read_b64_tr_b16 v[28:29], v253 offset:27648
    buffer_load_dwordx4 v[148:151], v17, s[44:47], s72 offen offset:0 sc1
    v_mfma_f32_16x16x32_bf16 v[76:79], v[32:35], v[132:135], v[76:79]
    ds_read_b64_tr_b16 v[30:31], v253 offset:32256
    s_waitcnt lgkmcnt(6)
    v_mfma_f32_16x16x32_bf16 v[72:75], v[36:39], v[136:139], v[72:75]
    ds_read_b64_tr_b16 v[32:33], v253 offset:36864
    buffer_load_dwordx4 v[152:155], v4, s[44:47], s73 offen offset:0 sc1
    v_mfma_f32_16x16x32_bf16 v[76:79], v[36:39], v[140:143], v[76:79]
    ds_read_b64_tr_b16 v[34:35], v253 offset:41472
    s_waitcnt lgkmcnt(6)
    v_mfma_f32_16x16x32_bf16 v[80:83], v[20:23], v[112:115], 0
    v_add_u32 v252, s98, v5
    ds_read_b64_tr_b16 v[36:37], v252 offset:9216
    buffer_load_dwordx4 v[156:159], v17, s[44:47], s73 offen offset:0 sc1
    v_mfma_f32_16x16x32_bf16 v[84:87], v[20:23], v[116:119], 0
    ds_read_b64_tr_b16 v[38:39], v252 offset:13824
    s_waitcnt lgkmcnt(6)
    v_mfma_f32_16x16x32_bf16 v[80:83], v[24:27], v[120:123], v[80:83]
    ds_read_b64_tr_b16 v[20:21], v252 offset:18432
    buffer_load_dwordx4 v[160:163], v4, s[44:47], s74 offen offset:0 sc1
    v_mfma_f32_16x16x32_bf16 v[84:87], v[24:27], v[124:127], v[84:87]
    ds_read_b64_tr_b16 v[22:23], v252 offset:23040
    s_waitcnt lgkmcnt(6)
    v_mfma_f32_16x16x32_bf16 v[80:83], v[28:31], v[128:131], v[80:83]
    ds_read_b64_tr_b16 v[24:25], v252 offset:27648
    buffer_load_dwordx4 v[164:167], v17, s[44:47], s74 offen offset:0 sc1
    v_mfma_f32_16x16x32_bf16 v[84:87], v[28:31], v[132:135], v[84:87]
    ds_read_b64_tr_b16 v[26:27], v252 offset:32256
    s_waitcnt lgkmcnt(6)
    v_mfma_f32_16x16x32_bf16 v[80:83], v[32:35], v[136:139], v[80:83]
    ds_read_b64_tr_b16 v[28:29], v252 offset:36864
    buffer_load_dwordx4 v[168:171], v4, s[44:47], s72 offen offset:1024 sc1
    v_mfma_f32_16x16x32_bf16 v[84:87], v[32:35], v[140:143], v[84:87]
    ds_read_b64_tr_b16 v[30:31], v252 offset:41472
    s_waitcnt lgkmcnt(6)
    v_mfma_f32_16x16x32_bf16 v[88:91], v[36:39], v[112:115], 0
    v_add_u32 v253, s99, v5
    ds_read_b64_tr_b16 v[32:33], v253 offset:9216
    buffer_load_dwordx4 v[172:175], v17, s[44:47], s72 offen offset:1024 sc1
    v_mfma_f32_16x16x32_bf16 v[92:95], v[36:39], v[116:119], 0
    ds_read_b64_tr_b16 v[34:35], v253 offset:13824
    s_waitcnt lgkmcnt(6)
    v_mfma_f32_16x16x32_bf16 v[88:91], v[20:23], v[120:123], v[88:91]
    ds_read_b64_tr_b16 v[36:37], v253 offset:18432
    buffer_load_dwordx4 v[176:179], v4, s[44:47], s73 offen offset:1024 sc1
    v_mfma_f32_16x16x32_bf16 v[92:95], v[20:23], v[124:127], v[92:95]
    ds_read_b64_tr_b16 v[38:39], v253 offset:23040
    s_waitcnt lgkmcnt(6)
    v_mfma_f32_16x16x32_bf16 v[88:91], v[24:27], v[128:131], v[88:91]
    ds_read_b64_tr_b16 v[20:21], v253 offset:27648
    buffer_load_dwordx4 v[180:183], v17, s[44:47], s73 offen offset:1024 sc1
    v_mfma_f32_16x16x32_bf16 v[92:95], v[24:27], v[132:135], v[92:95]
    ds_read_b64_tr_b16 v[22:23], v253 offset:32256
    s_waitcnt lgkmcnt(6)
    v_mfma_f32_16x16x32_bf16 v[88:91], v[28:31], v[136:139], v[88:91]
    ds_read_b64_tr_b16 v[24:25], v253 offset:36864
    buffer_load_dwordx4 v[184:187], v4, s[44:47], s74 offen offset:1024 sc1
    v_mfma_f32_16x16x32_bf16 v[92:95], v[28:31], v[140:143], v[92:95]
    ds_read_b64_tr_b16 v[26:27], v253 offset:41472
    s_waitcnt lgkmcnt(6)
    v_mfma_f32_16x16x32_bf16 v[96:99], v[32:35], v[112:115], 0
    v_add_u32 v252, s100, v5
    ds_read_b64_tr_b16 v[28:29], v252 offset:9216
    buffer_load_dwordx4 v[188:191], v17, s[44:47], s74 offen offset:1024 sc1
    v_mfma_f32_16x16x32_bf16 v[100:103], v[32:35], v[116:119], 0
    ds_read_b64_tr_b16 v[30:31], v252 offset:13824
    s_waitcnt lgkmcnt(6)
    v_mfma_f32_16x16x32_bf16 v[96:99], v[36:39], v[120:123], v[96:99]
    ds_read_b64_tr_b16 v[32:33], v252 offset:18432
    v_mfma_f32_16x16x32_bf16 v[100:103], v[36:39], v[124:127], v[100:103]
    ds_read_b64_tr_b16 v[34:35], v252 offset:23040
    s_waitcnt lgkmcnt(6)
    v_mfma_f32_16x16x32_bf16 v[96:99], v[20:23], v[128:131], v[96:99]
    ds_read_b64_tr_b16 v[36:37], v252 offset:27648
    v_mfma_f32_16x16x32_bf16 v[100:103], v[20:23], v[132:135], v[100:103]
    ds_read_b64_tr_b16 v[38:39], v252 offset:32256
    s_waitcnt lgkmcnt(6)
    v_mfma_f32_16x16x32_bf16 v[96:99], v[24:27], v[136:139], v[96:99]
    ds_read_b64_tr_b16 v[20:21], v252 offset:36864
    v_mfma_f32_16x16x32_bf16 v[100:103], v[24:27], v[140:143], v[100:103]
    ds_read_b64_tr_b16 v[22:23], v252 offset:41472
    s_waitcnt lgkmcnt(6)
    v_mfma_f32_16x16x32_bf16 v[104:107], v[28:31], v[112:115], 0
    v_add_u32 v14, s92, v5
    v_add_u32 v14, 46080, v14
    ds_read_b64_tr_b16 v[24:25], v14 offset:0
    v_mfma_f32_16x16x32_bf16 v[108:111], v[28:31], v[116:119], 0
    ds_read_b64_tr_b16 v[26:27], v14 offset:4608
    s_waitcnt lgkmcnt(6)
    v_mfma_f32_16x16x32_bf16 v[104:107], v[32:35], v[120:123], v[104:107]
    ds_read_b64_tr_b16 v[28:29], v14 offset:9216
    v_mfma_f32_16x16x32_bf16 v[108:111], v[32:35], v[124:127], v[108:111]
    ds_read_b64_tr_b16 v[30:31], v14 offset:13824
    s_waitcnt lgkmcnt(6)
    v_mfma_f32_16x16x32_bf16 v[104:107], v[36:39], v[128:131], v[104:107]
    ds_read_b64_tr_b16 v[32:33], v14 offset:18432
    v_mfma_f32_16x16x32_bf16 v[108:111], v[36:39], v[132:135], v[108:111]
    ds_read_b64_tr_b16 v[34:35], v14 offset:23040
    s_waitcnt lgkmcnt(6)
    v_mfma_f32_16x16x32_bf16 v[104:107], v[20:23], v[136:139], v[104:107]
    v_add_u32 v15, s93, v5
    v_add_u32 v15, 46080, v15
    ds_read_b64_tr_b16 v[36:37], v15 offset:0
    v_mfma_f32_16x16x32_bf16 v[108:111], v[20:23], v[140:143], v[108:111]
    ds_read_b64_tr_b16 v[38:39], v15 offset:4608
    v_mov_b32 v0, 17
    ds_write_b32 v10, v0
    ds_read_b64_tr_b16 v[20:21], v15 offset:9216
    ds_read_b64_tr_b16 v[22:23], v15 offset:13824
    s_waitcnt vmcnt(10)
    s_waitcnt lgkmcnt(9)
    v_mfma_f32_16x16x32_bf16 v[40:43], v[24:27], v[144:147], v[40:43]
    ds_read_b64_tr_b16 v[112:113], v15 offset:18432
    v_mfma_f32_16x16x32_bf16 v[44:47], v[24:27], v[148:151], v[44:47]
    ds_read_b64_tr_b16 v[114:115], v15 offset:23040
    s_waitcnt vmcnt(8)
    s_waitcnt lgkmcnt(9)
    v_mfma_f32_16x16x32_bf16 v[40:43], v[28:31], v[152:155], v[40:43]
    v_add_u32 v14, s94, v5
    v_add_u32 v14, 46080, v14
    ds_read_b64_tr_b16 v[116:117], v14 offset:0
    v_mfma_f32_16x16x32_bf16 v[44:47], v[28:31], v[156:159], v[44:47]
    ds_read_b64_tr_b16 v[118:119], v14 offset:4608
    ds_read_b64_tr_b16 v[24:25], v14 offset:9216
    ds_read_b64_tr_b16 v[26:27], v14 offset:13824
    s_waitcnt vmcnt(6)
    s_waitcnt lgkmcnt(11)
    v_mfma_f32_16x16x32_bf16 v[40:43], v[32:35], v[160:163], v[40:43]
    ds_read_b64_tr_b16 v[28:29], v14 offset:18432
    v_mfma_f32_16x16x32_bf16 v[44:47], v[32:35], v[164:167], v[44:47]
    ds_read_b64_tr_b16 v[30:31], v14 offset:23040
    s_waitcnt lgkmcnt(11)
    v_mfma_f32_16x16x32_bf16 v[48:51], v[36:39], v[144:147], v[48:51]
    v_add_u32 v15, s95, v5
    v_add_u32 v15, 46080, v15
    ds_read_b64_tr_b16 v[32:33], v15 offset:0
    v_mfma_f32_16x16x32_bf16 v[52:55], v[36:39], v[148:151], v[52:55]
    ds_read_b64_tr_b16 v[34:35], v15 offset:4608
    s_waitcnt lgkmcnt(10)
    v_mfma_f32_16x16x32_bf16 v[48:51], v[20:23], v[152:155], v[48:51]
    ds_read_b64_tr_b16 v[36:37], v15 offset:9216
    v_mfma_f32_16x16x32_bf16 v[52:55], v[20:23], v[156:159], v[52:55]
    ds_read_b64_tr_b16 v[38:39], v15 offset:13824
    s_waitcnt lgkmcnt(10)
    v_mfma_f32_16x16x32_bf16 v[48:51], v[112:115], v[160:163], v[48:51]
    ds_read_b64_tr_b16 v[20:21], v15 offset:18432
    v_mfma_f32_16x16x32_bf16 v[52:55], v[112:115], v[164:167], v[52:55]
    ds_read_b64_tr_b16 v[22:23], v15 offset:23040
    s_waitcnt lgkmcnt(10)
    v_mfma_f32_16x16x32_bf16 v[56:59], v[116:119], v[144:147], v[56:59]
    v_add_u32 v14, s96, v5
    v_add_u32 v14, 46080, v14
    ds_read_b64_tr_b16 v[112:113], v14 offset:0
    v_mfma_f32_16x16x32_bf16 v[60:63], v[116:119], v[148:151], v[60:63]
    ds_read_b64_tr_b16 v[114:115], v14 offset:4608
    s_waitcnt lgkmcnt(10)
    v_mfma_f32_16x16x32_bf16 v[56:59], v[24:27], v[152:155], v[56:59]
    ds_read_b64_tr_b16 v[116:117], v14 offset:9216
    v_mfma_f32_16x16x32_bf16 v[60:63], v[24:27], v[156:159], v[60:63]
    ds_read_b64_tr_b16 v[118:119], v14 offset:13824
    s_waitcnt lgkmcnt(10)
    v_mfma_f32_16x16x32_bf16 v[56:59], v[28:31], v[160:163], v[56:59]
    ds_read_b64_tr_b16 v[24:25], v14 offset:18432
    buffer_load_dword v19, v18, s[44:47], s77 offen sc1
    v_mfma_f32_16x16x32_bf16 v[60:63], v[28:31], v[164:167], v[60:63]
    ds_read_b64_tr_b16 v[26:27], v14 offset:23040
    s_waitcnt lgkmcnt(10)
    v_mfma_f32_16x16x32_bf16 v[64:67], v[32:35], v[144:147], v[64:67]
    v_add_u32 v15, s97, v5
    v_add_u32 v15, 46080, v15
    ds_read_b64_tr_b16 v[28:29], v15 offset:0
    v_mfma_f32_16x16x32_bf16 v[68:71], v[32:35], v[148:151], v[68:71]
    ds_read_b64_tr_b16 v[30:31], v15 offset:4608
    s_waitcnt lgkmcnt(10)
    v_mfma_f32_16x16x32_bf16 v[64:67], v[36:39], v[152:155], v[64:67]
    ds_read_b64_tr_b16 v[32:33], v15 offset:9216
    v_mfma_f32_16x16x32_bf16 v[68:71], v[36:39], v[156:159], v[68:71]
    ds_read_b64_tr_b16 v[34:35], v15 offset:13824
    s_waitcnt lgkmcnt(10)
    v_mfma_f32_16x16x32_bf16 v[64:67], v[20:23], v[160:163], v[64:67]
    ds_read_b64_tr_b16 v[36:37], v15 offset:18432
    v_mfma_f32_16x16x32_bf16 v[68:71], v[20:23], v[164:167], v[68:71]
    ds_read_b64_tr_b16 v[38:39], v15 offset:23040
    s_waitcnt lgkmcnt(10)
    v_mfma_f32_16x16x32_bf16 v[72:75], v[112:115], v[144:147], v[72:75]
    v_add_u32 v14, s98, v5
    v_add_u32 v14, 46080, v14
    ds_read_b64_tr_b16 v[20:21], v14 offset:0
    v_mfma_f32_16x16x32_bf16 v[76:79], v[112:115], v[148:151], v[76:79]
    ds_read_b64_tr_b16 v[22:23], v14 offset:4608
    s_waitcnt lgkmcnt(10)
    v_mfma_f32_16x16x32_bf16 v[72:75], v[116:119], v[152:155], v[72:75]
    ds_read_b64_tr_b16 v[112:113], v14 offset:9216
    v_mfma_f32_16x16x32_bf16 v[76:79], v[116:119], v[156:159], v[76:79]
    ds_read_b64_tr_b16 v[114:115], v14 offset:13824
    ds_read_b128 v[120:123], v11 offset:16
    s_waitcnt lgkmcnt(11)
    v_mfma_f32_16x16x32_bf16 v[72:75], v[24:27], v[160:163], v[72:75]
    ds_read_b64_tr_b16 v[116:117], v14 offset:18432
    v_mfma_f32_16x16x32_bf16 v[76:79], v[24:27], v[164:167], v[76:79]
    ds_read_b64_tr_b16 v[118:119], v14 offset:23040
    s_waitcnt lgkmcnt(11)
    v_mfma_f32_16x16x32_bf16 v[80:83], v[28:31], v[144:147], v[80:83]
    v_add_u32 v15, s99, v5
    v_add_u32 v15, 46080, v15
    ds_read_b64_tr_b16 v[24:25], v15 offset:0
    v_mfma_f32_16x16x32_bf16 v[84:87], v[28:31], v[148:151], v[84:87]
    ds_read_b64_tr_b16 v[26:27], v15 offset:4608
    s_waitcnt vmcnt(0)
    v_subrev_u32 v19, s56, v19
    v_cmp_le_u32 vcc, 16, v19
    s_nop 0
    s_and_b32 s64, vcc_lo, 255
    s_cmp_eq_u32 s64, 0
    s_cbranch_scc0 Ls_s46
Ls_r46:
    s_waitcnt lgkmcnt(11)
    v_mfma_f32_16x16x32_bf16 v[80:83], v[32:35], v[152:155], v[80:83]
    ds_read_b64_tr_b16 v[28:29], v15 offset:9216
    buffer_load_dwordx4 v[192:195], v4, s[44:47], s72 offen offset:2048 sc1
    v_mfma_f32_16x16x32_bf16 v[84:87], v[32:35], v[156:159], v[84:87]
    ds_read_b64_tr_b16 v[30:31], v15 offset:13824
    s_waitcnt lgkmcnt(11)
    v_mfma_f32_16x16x32_bf16 v[80:83], v[36:39], v[160:163], v[80:83]
    ds_read_b64_tr_b16 v[32:33], v15 offset:18432
    buffer_load_dwordx4 v[196:199], v17, s[44:47], s72 offen offset:2048 sc1
    v_mfma_f32_16x16x32_bf16 v[84:87], v[36:39], v[164:167], v[84:87]
    ds_read_b64_tr_b16 v[34:35], v15 offset:23040
    s_waitcnt lgkmcnt(11)
    v_mfma_f32_16x16x32_bf16 v[88:91], v[20:23], v[144:147], v[88:91]
    v_add_u32 v14, s100, v5
    v_add_u32 v14, 46080, v14
    ds_read_b64_tr_b16 v[36:37], v14 offset:0
    buffer_load_dwordx4 v[200:203], v4, s[44:47], s73 offen offset:2048 sc1
    v_mfma_f32_16x16x32_bf16 v[92:95], v[20:23], v[148:151], v[92:95]
    ds_read_b64_tr_b16 v[38:39], v14 offset:4608
    s_waitcnt lgkmcnt(11)
    v_mfma_f32_16x16x32_bf16 v[88:91], v[112:115], v[152:155], v[88:91]
    ds_read_b64_tr_b16 v[20:21], v14 offset:9216
    buffer_load_dwordx4 v[204:207], v17, s[44:47], s73 offen offset:2048 sc1
    v_mfma_f32_16x16x32_bf16 v[92:95], v[112:115], v[156:159], v[92:95]
    ds_read_b64_tr_b16 v[22:23], v14 offset:13824
    s_waitcnt lgkmcnt(12)
    v_min_u32 v120, v120, v121
    v_min3_u32 v120, v120, v122, v123
    s_nop 0
    v_readfirstlane_b32 s64, v120
    s_nop 0
    s_cmp_ge_u32 s64, 18
    s_cbranch_scc0 Ls_s47
Ls_r47:
    s_waitcnt lgkmcnt(10)
    v_mfma_f32_16x16x32_bf16 v[88:91], v[116:119], v[160:163], v[88:91]
    ds_read_b64_tr_b16 v[112:113], v14 offset:18432
    buffer_load_dwordx4 v[208:211], v4, s[44:47], s74 offen offset:2048 sc1
    v_mfma_f32_16x16x32_bf16 v[92:95], v[116:119], v[164:167], v[92:95]
    ds_read_b64_tr_b16 v[114:115], v14 offset:23040
    s_waitcnt lgkmcnt(10)
    v_mfma_f32_16x16x32_bf16 v[96:99], v[24:27], v[144:147], v[96:99]
    v_add_u32 v15, s92, v6
    ds_read_b64_tr_b16 v[116:117], v15 offset:18432
    buffer_load_dwordx4 v[212:215], v17, s[44:47], s74 offen offset:2048 sc1
    v_mfma_f32_16x16x32_bf16 v[100:103], v[24:27], v[148:151], v[100:103]
    ds_read_b64_tr_b16 v[118:119], v15 offset:23040
    s_waitcnt lgkmcnt(10)
    v_mfma_f32_16x16x32_bf16 v[96:99], v[28:31], v[152:155], v[96:99]
    ds_read_b64_tr_b16 v[24:25], v15 offset:27648
    buffer_load_dwordx4 v[216:219], v4, s[44:47], s72 offen offset:3072 sc1
    v_mfma_f32_16x16x32_bf16 v[100:103], v[28:31], v[156:159], v[100:103]
    ds_read_b64_tr_b16 v[26:27], v15 offset:32256
    s_waitcnt lgkmcnt(10)
    v_mfma_f32_16x16x32_bf16 v[96:99], v[32:35], v[160:163], v[96:99]
    ds_read_b64_tr_b16 v[28:29], v15 offset:36864
    buffer_load_dwordx4 v[220:223], v17, s[44:47], s72 offen offset:3072 sc1
    v_mfma_f32_16x16x32_bf16 v[100:103], v[32:35], v[164:167], v[100:103]
    ds_read_b64_tr_b16 v[30:31], v15 offset:41472
    s_waitcnt lgkmcnt(10)
    v_mfma_f32_16x16x32_bf16 v[104:107], v[36:39], v[144:147], v[104:107]
    v_add_u32 v14, s93, v6
    ds_read_b64_tr_b16 v[32:33], v14 offset:18432
    buffer_load_dwordx4 v[224:227], v4, s[44:47], s73 offen offset:3072 sc1
    v_mfma_f32_16x16x32_bf16 v[108:111], v[36:39], v[148:151], v[108:111]
    ds_read_b64_tr_b16 v[34:35], v14 offset:23040
    s_waitcnt lgkmcnt(10)
    v_mfma_f32_16x16x32_bf16 v[104:107], v[20:23], v[152:155], v[104:107]
    ds_read_b64_tr_b16 v[36:37], v14 offset:27648
    buffer_load_dwordx4 v[228:231], v17, s[44:47], s73 offen offset:3072 sc1
    v_mfma_f32_16x16x32_bf16 v[108:111], v[20:23], v[156:159], v[108:111]
    ds_read_b64_tr_b16 v[38:39], v14 offset:32256
    s_waitcnt lgkmcnt(10)
    v_mfma_f32_16x16x32_bf16 v[104:107], v[112:115], v[160:163], v[104:107]
    ds_read_b64_tr_b16 v[20:21], v14 offset:36864
    buffer_load_dwordx4 v[232:235], v4, s[44:47], s74 offen offset:3072 sc1
    v_mfma_f32_16x16x32_bf16 v[108:111], v[112:115], v[164:167], v[108:111]
    ds_read_b64_tr_b16 v[22:23], v14 offset:41472
    s_waitcnt lgkmcnt(10)
    v_mfma_f32_16x16x32_bf16 v[40:43], v[116:119], v[168:171], v[40:43]
    v_add_u32 v15, s94, v6
    ds_read_b64_tr_b16 v[112:113], v15 offset:18432
    buffer_load_dwordx4 v[236:239], v17, s[44:47], s74 offen offset:3072 sc1
    v_mfma_f32_16x16x32_bf16 v[44:47], v[116:119], v[172:175], v[44:47]
    ds_read_b64_tr_b16 v[114:115], v15 offset:23040
    s_waitcnt lgkmcnt(10)
    v_mfma_f32_16x16x32_bf16 v[40:43], v[24:27], v[176:179], v[40:43]
    ds_read_b64_tr_b16 v[116:117], v15 offset:27648
    buffer_load_dwordx2 v[240:241], v16, s[44:47], s75 offen offset:0 sc1
    v_mfma_f32_16x16x32_bf16 v[44:47], v[24:27], v[180:183], v[44:47]
    ds_read_b64_tr_b16 v[118:119], v15 offset:32256
    s_waitcnt lgkmcnt(10)
    v_mfma_f32_16x16x32_bf16 v[40:43], v[28:31], v[184:187], v[40:43]
    ds_read_b64_tr_b16 v[24:25], v15 offset:36864
    buffer_load_dwordx2 v[242:243], v16, s[44:47], s75 offen offset:512 sc1
    v_mfma_f32_16x16x32_bf16 v[44:47], v[28:31], v[188:191], v[44:47]
    ds_read_b64_tr_b16 v[26:27], v15 offset:41472
    s_waitcnt lgkmcnt(10)
    v_mfma_f32_16x16x32_bf16 v[48:51], v[32:35], v[168:171], v[48:51]
    v_add_u32 v14, s95, v6
    ds_read_b64_tr_b16 v[28:29], v14 offset:18432
    buffer_load_dwordx2 v[244:245], v7, s[44:47], s75 offen offset:0 sc1
    v_mfma_f32_16x16x32_bf16 v[52:55], v[32:35], v[172:175], v[52:55]
    ds_read_b64_tr_b16 v[30:31], v14 offset:23040
    s_waitcnt lgkmcnt(10)
    v_mfma_f32_16x16x32_bf16 v[48:51], v[36:39], v[176:179], v[48:51]
    ds_read_b64_tr_b16 v[32:33], v14 offset:27648
    buffer_load_dwordx2 v[246:247], v7, s[44:47], s75 offen offset:512 sc1
    v_mfma_f32_16x16x32_bf16 v[52:55], v[36:39], v[180:183], v[52:55]
    ds_read_b64_tr_b16 v[34:35], v14 offset:32256
    ds_read_b128 v[120:123], v11 offset:16
    s_waitcnt lgkmcnt(11)
    v_mfma_f32_16x16x32_bf16 v[48:51], v[20:23], v[184:187], v[48:51]
    ds_read_b64_tr_b16 v[36:37], v14 offset:36864
    buffer_load_dwordx2 v[248:249], v16, s[44:47], s76 offen offset:0 sc1
    v_mfma_f32_16x16x32_bf16 v[52:55], v[20:23], v[188:191], v[52:55]
    ds_read_b64_tr_b16 v[38:39], v14 offset:41472
    s_waitcnt lgkmcnt(11)
    v_mfma_f32_16x16x32_bf16 v[56:59], v[112:115], v[168:171], v[56:59]
    v_add_u32 v128, s92, v5
    v_add_u32 v129, s92, v6
    v_add_u32 v130, s92, v8
    ds_read_b64_tr_b16 v[20:21], v129 offset:46080
    buffer_load_dwordx2 v[250:251], v16, s[44:47], s76 offen offset:512 sc1
    v_mfma_f32_16x16x32_bf16 v[60:63], v[112:115], v[172:175], v[60:63]
    ds_read_b64_tr_b16 v[22:23], v129 offset:50688
    s_waitcnt lgkmcnt(11)
    v_mfma_f32_16x16x32_bf16 v[56:59], v[116:119], v[176:179], v[56:59]
    ds_read_b64_tr_b16 v[112:113], v130 offset:0
    buffer_load_dwordx2 v[252:253], v7, s[44:47], s76 offen offset:0 sc1
    v_mfma_f32_16x16x32_bf16 v[60:63], v[116:119], v[180:183], v[60:63]
    ds_read_b64_tr_b16 v[114:115], v130 offset:4608
    s_waitcnt lgkmcnt(11)
    v_mfma_f32_16x16x32_bf16 v[56:59], v[24:27], v[184:187], v[56:59]
    ds_read_b64_tr_b16 v[116:117], v130 offset:9216
    buffer_load_dwordx2 v[254:255], v7, s[44:47], s76 offen offset:512 sc1
    v_mfma_f32_16x16x32_bf16 v[60:63], v[24:27], v[188:191], v[60:63]
    ds_read_b64_tr_b16 v[118:119], v130 offset:13824
    s_waitcnt lgkmcnt(11)
    v_mfma_f32_16x16x32_bf16 v[64:67], v[28:31], v[168:171], v[64:67]
    ds_read_b64_tr_b16 v[24:25], v130 offset:18432
    v_mfma_f32_16x16x32_bf16 v[68:71], v[28:31], v[172:175], v[68:71]
    ds_read_b64_tr_b16 v[26:27], v130 offset:23040
    s_waitcnt lgkmcnt(11)
    v_mfma_f32_16x16x32_bf16 v[64:67], v[32:35], v[176:179], v[64:67]
    ds_read_b64_tr_b16 v[28:29], v130 offset:27648
    v_mfma_f32_16x16x32_bf16 v[68:71], v[32:35], v[180:183], v[68:71]
    ds_read_b64_tr_b16 v[30:31], v130 offset:32256
    s_waitcnt lgkmcnt(12)
    v_min_u32 v120, v120, v121
    v_min3_u32 v120, v120, v122, v123
    s_nop 0
    v_readfirstlane_b32 s64, v120
    s_nop 0
    s_cmp_ge_u32 s64, 19
    s_cbranch_scc0 Ls_s48
Ls_r48:
    s_waitcnt lgkmcnt(10)
    v_mfma_f32_16x16x32_bf16 v[64:67], v[36:39], v[184:187], v[64:67]
    ds_read_b64_tr_b16 v[32:33], v130 offset:36864
    v_mfma_f32_16x16x32_bf16 v[68:71], v[36:39], v[188:191], v[68:71]
    ds_read_b64_tr_b16 v[34:35], v130 offset:41472
    ds_read_b128 v[124:127], v11 offset:0
    s_waitcnt vmcnt(18)
    s_waitcnt lgkmcnt(11)
    v_mfma_f32_16x16x32_bf16 v[40:43], v[20:23], v[192:195], v[40:43]
    ds_read_b64_tr_b16 v[36:37], v128 offset:0
    v_mfma_f32_16x16x32_bf16 v[44:47], v[20:23], v[196:199], v[44:47]
    ds_read_b64_tr_b16 v[38:39], v128 offset:4608
    s_waitcnt vmcnt(16)
    s_waitcnt lgkmcnt(11)
    v_mfma_f32_16x16x32_bf16 v[40:43], v[112:115], v[200:203], v[40:43]
    ds_read_b64_tr_b16 v[20:21], v128 offset:9216
    v_mfma_f32_16x16x32_bf16 v[44:47], v[112:115], v[204:207], v[44:47]
    ds_read_b64_tr_b16 v[22:23], v128 offset:13824
    s_waitcnt vmcnt(14)
    s_waitcnt lgkmcnt(11)
    v_mfma_f32_16x16x32_bf16 v[40:43], v[116:119], v[208:211], v[40:43]
    v_add_u32 v132, s93, v5
    v_add_u32 v133, s93, v6
    v_add_u32 v134, s93, v8
    ds_read_b64_tr_b16 v[112:113], v133 offset:46080
    v_mfma_f32_16x16x32_bf16 v[44:47], v[116:119], v[212:215], v[44:47]
    ds_read_b64_tr_b16 v[114:115], v133 offset:50688
    s_waitcnt vmcnt(12)
    s_waitcnt lgkmcnt(11)
    v_mfma_f32_16x16x32_bf16 v[40:43], v[24:27], v[216:219], v[40:43]
    ds_read_b64_tr_b16 v[116:117], v134 offset:0
    v_mfma_f32_16x16x32_bf16 v[44:47], v[24:27], v[220:223], v[44:47]
    ds_read_b64_tr_b16 v[118:119], v134 offset:4608
    s_waitcnt vmcnt(10)
    s_waitcnt lgkmcnt(11)
    v_mfma_f32_16x16x32_bf16 v[40:43], v[28:31], v[224:227], v[40:43]
    ds_read_b64_tr_b16 v[24:25], v134 offset:9216
    v_mfma_f32_16x16x32_bf16 v[44:47], v[28:31], v[228:231], v[44:47]
    ds_read_b64_tr_b16 v[26:27], v134 offset:13824
    s_waitcnt vmcnt(8)
    s_waitcnt lgkmcnt(11)
    v_mfma_f32_16x16x32_bf16 v[40:43], v[32:35], v[232:235], v[40:43]
    ds_read_b64_tr_b16 v[28:29], v134 offset:18432
    v_mfma_f32_16x16x32_bf16 v[44:47], v[32:35], v[236:239], v[44:47]
    ds_read_b64_tr_b16 v[30:31], v134 offset:23040
    s_waitcnt lgkmcnt(12)
    v_min_u32 v124, v124, v125
    v_min3_u32 v124, v124, v126, v127
    s_nop 0
    v_readfirstlane_b32 s64, v124
    s_nop 0
    s_cmp_ge_u32 s64, 17
    s_cbranch_scc0 Ls_s49
Ls_r49:
    s_lshl_b32 s64, s57, 11
    v_add_u32 v19, s64, v4
    v_xor_b32 v137, 16, v10
    s_waitcnt vmcnt(4)
    s_waitcnt lgkmcnt(10)
    v_mfma_f32_16x16x32_bf16 v[40:43], v[36:39], v[240:243], v[40:43]
    ds_read_b64_tr_b16 v[32:33], v134 offset:27648
    v_mfma_f32_16x16x32_bf16 v[44:47], v[36:39], v[244:247], v[44:47]
    ds_read_b64_tr_b16 v[34:35], v134 offset:32256
    s_waitcnt vmcnt(0)
    s_waitcnt lgkmcnt(10)
    v_mfma_f32_16x16x32_bf16 v[40:43], v[20:23], v[248:251], v[40:43]
    ds_read_b64_tr_b16 v[36:37], v134 offset:36864
    v_mfma_f32_16x16x32_bf16 v[44:47], v[20:23], v[252:255], v[44:47]
    ds_read_b64_tr_b16 v[38:39], v134 offset:41472
    s_waitcnt lgkmcnt(10)
    v_mfma_f32_16x16x32_bf16 v[48:51], v[112:115], v[192:195], v[48:51]
    ds_read_b64_tr_b16 v[20:21], v132 offset:0
    v_mfma_f32_16x16x32_bf16 v[52:55], v[112:115], v[196:199], v[52:55]
    ds_read_b64_tr_b16 v[22:23], v132 offset:4608
    s_waitcnt lgkmcnt(10)
    v_mfma_f32_16x16x32_bf16 v[48:51], v[116:119], v[200:203], v[48:51]
    ds_read_b64_tr_b16 v[112:113], v132 offset:9216
    ds_write_b128 v19, v[40:43] offset:18432
    v_mfma_f32_16x16x32_bf16 v[52:55], v[116:119], v[204:207], v[52:55]
    ds_read_b64_tr_b16 v[114:115], v132 offset:13824
    s_waitcnt lgkmcnt(11)
    v_mfma_f32_16x16x32_bf16 v[48:51], v[24:27], v[208:211], v[48:51]
    v_add_u32 v128, s94, v5
    v_add_u32 v129, s94, v6
    v_add_u32 v130, s94, v8
    ds_read_b64_tr_b16 v[116:117], v129 offset:46080
    ds_write_b128 v19, v[44:47] offset:19456
    v_mfma_f32_16x16x32_bf16 v[52:55], v[24:27], v[212:215], v[52:55]
    ds_read_b64_tr_b16 v[118:119], v129 offset:50688
    s_waitcnt lgkmcnt(12)
    v_mfma_f32_16x16x32_bf16 v[48:51], v[28:31], v[216:219], v[48:51]
    ds_read_b64_tr_b16 v[24:25], v130 offset:0
    v_mov_b32 v0, 19
    v_mfma_f32_16x16x32_bf16 v[52:55], v[28:31], v[220:223], v[52:55]
    ds_read_b64_tr_b16 v[26:27], v130 offset:4608
    s_waitcnt lgkmcnt(12)
    v_mfma_f32_16x16x32_bf16 v[48:51], v[32:35], v[224:227], v[48:51]
    ds_read_b64_tr_b16 v[28:29], v130 offset:9216
    ds_write_b32 v10, v0
    v_mfma_f32_16x16x32_bf16 v[52:55], v[32:35], v[228:231], v[52:55]
    s_waitcnt lgkmcnt(12)
    ds_read_b64_tr_b16 v[30:31], v130 offset:13824
    v_mfma_f32_16x16x32_bf16 v[48:51], v[36:39], v[232:235], v[48:51]
    ds_read_b64_tr_b16 v[32:33], v130 offset:18432
    v_mfma_f32_16x16x32_bf16 v[52:55], v[36:39], v[236:239], v[52:55]
    s_waitcnt lgkmcnt(12)
    ds_read_b64_tr_b16 v[34:35], v130 offset:23040
    v_mfma_f32_16x16x32_bf16 v[48:51], v[20:23], v[240:243], v[48:51]
    ds_read_b64_tr_b16 v[36:37], v130 offset:27648
    v_mfma_f32_16x16x32_bf16 v[52:55], v[20:23], v[244:247], v[52:55]
    s_waitcnt lgkmcnt(12)
    ds_read_b64_tr_b16 v[38:39], v130 offset:32256
    s_waitcnt lgkmcnt(12)
    v_mfma_f32_16x16x32_bf16 v[48:51], v[112:115], v[248:251], v[48:51]
    ds_read_b64_tr_b16 v[20:21], v130 offset:36864
    v_mfma_f32_16x16x32_bf16 v[52:55], v[112:115], v[252:255], v[52:55]
    ds_read_b64_tr_b16 v[22:23], v130 offset:41472
    s_waitcnt lgkmcnt(11)
    v_mfma_f32_16x16x32_bf16 v[56:59], v[116:119], v[192:195], v[56:59]
    ds_read_b64_tr_b16 v[112:113], v128 offset:0
    v_mfma_f32_16x16x32_bf16 v[60:63], v[116:119], v[196:199], v[60:63]
    ds_read_b64_tr_b16 v[114:115], v128 offset:4608
    s_waitcnt lgkmcnt(11)
    v_mfma_f32_16x16x32_bf16 v[56:59], v[24:27], v[200:203], v[56:59]
    ds_read_b64_tr_b16 v[116:117], v128 offset:9216
    ds_write_b128 v19, v[48:51] offset:27648
    v_mfma_f32_16x16x32_bf16 v[60:63], v[24:27], v[204:207], v[60:63]
    ds_read_b64_tr_b16 v[118:119], v128 offset:13824
    s_waitcnt lgkmcnt(11)
    v_mfma_f32_16x16x32_bf16 v[56:59], v[28:31], v[208:211], v[56:59]
    v_add_u32 v132, s95, v5
    v_add_u32 v133, s95, v6
    v_add_u32 v134, s95, v8
    ds_read_b64_tr_b16 v[24:25], v133 offset:46080
    ds_write_b128 v19, v[52:55] offset:28672
    v_mfma_f32_16x16x32_bf16 v[60:63], v[28:31], v[212:215], v[60:63]
    ds_read_b64_tr_b16 v[26:27], v133 offset:50688
    s_waitcnt lgkmcnt(12)
    v_mfma_f32_16x16x32_bf16 v[56:59], v[32:35], v[216:219], v[56:59]
    ds_read_b64_tr_b16 v[28:29], v134 offset:0
    v_mov_b32 v0, 20
    v_mfma_f32_16x16x32_bf16 v[60:63], v[32:35], v[220:223], v[60:63]
    ds_read_b64_tr_b16 v[30:31], v134 offset:4608
    s_waitcnt lgkmcnt(12)
    v_mfma_f32_16x16x32_bf16 v[56:59], v[36:39], v[224:227], v[56:59]
    ds_read_b64_tr_b16 v[32:33], v134 offset:9216
    ds_write_b32 v10, v0
    v_mfma_f32_16x16x32_bf16 v[60:63], v[36:39], v[228:231], v[60:63]
    s_waitcnt lgkmcnt(12)
    ds_read_b64_tr_b16 v[34:35], v134 offset:13824
    v_mfma_f32_16x16x32_bf16 v[56:59], v[20:23], v[232:235], v[56:59]
    ds_read_b64_tr_b16 v[36:37], v134 offset:18432
    v_mfma_f32_16x16x32_bf16 v[60:63], v[20:23], v[236:239], v[60:63]
    s_waitcnt lgkmcnt(12)
    ds_read_b64_tr_b16 v[38:39], v134 offset:23040
    v_mfma_f32_16x16x32_bf16 v[56:59], v[112:115], v[240:243], v[56:59]
    ds_read_b64_tr_b16 v[20:21], v134 offset:27648
    v_mfma_f32_16x16x32_bf16 v[60:63], v[112:115], v[244:247], v[60:63]
    s_waitcnt lgkmcnt(12)
    ds_read_b64_tr_b16 v[22:23], v134 offset:32256
    s_waitcnt lgkmcnt(12)
    v_mfma_f32_16x16x32_bf16 v[56:59], v[116:119], v[248:251], v[56:59]
    ds_read_b64_tr_b16 v[112:113], v134 offset:36864
    v_mfma_f32_16x16x32_bf16 v[60:63], v[116:119], v[252:255], v[60:63]
    ds_read_b64_tr_b16 v[114:115], v134 offset:41472
    s_waitcnt lgkmcnt(11)
    v_mfma_f32_16x16x32_bf16 v[64:67], v[24:27], v[192:195], v[64:67]
    ds_read_b64_tr_b16 v[116:117], v132 offset:0
    v_mfma_f32_16x16x32_bf16 v[68:71], v[24:27], v[196:199], v[68:71]
    ds_read_b64_tr_b16 v[118:119], v132 offset:4608
    s_waitcnt lgkmcnt(11)
    v_mfma_f32_16x16x32_bf16 v[64:67], v[28:31], v[200:203], v[64:67]
    ds_read_b64_tr_b16 v[24:25], v132 offset:9216
    ds_write_b128 v19, v[56:59] offset:36864
    v_mfma_f32_16x16x32_bf16 v[68:71], v[28:31], v[204:207], v[68:71]
    ds_read_b64_tr_b16 v[26:27], v132 offset:13824
    s_waitcnt lgkmcnt(11)
    v_mfma_f32_16x16x32_bf16 v[64:67], v[32:35], v[208:211], v[64:67]
    v_add_u32 v128, s96, v5
    v_add_u32 v129, s96, v6
    v_add_u32 v130, s96, v8
    ds_read_b64_tr_b16 v[28:29], v129 offset:18432
    ds_write_b128 v19, v[60:63] offset:37888
    v_mfma_f32_16x16x32_bf16 v[68:71], v[32:35], v[212:215], v[68:71]
    ds_read_b64_tr_b16 v[30:31], v129 offset:23040
    s_waitcnt lgkmcnt(12)
    v_mfma_f32_16x16x32_bf16 v[64:67], v[36:39], v[216:219], v[64:67]
    ds_read_b64_tr_b16 v[32:33], v129 offset:27648
    v_mov_b32 v0, 21
    v_mfma_f32_16x16x32_bf16 v[68:71], v[36:39], v[220:223], v[68:71]
    ds_read_b64_tr_b16 v[34:35], v129 offset:32256
    s_waitcnt lgkmcnt(12)
    v_mfma_f32_16x16x32_bf16 v[64:67], v[20:23], v[224:227], v[64:67]
    ds_read_b64_tr_b16 v[36:37], v129 offset:36864
    ds_write_b32 v10, v0
    v_mfma_f32_16x16x32_bf16 v[68:71], v[20:23], v[228:231], v[68:71]
    s_waitcnt lgkmcnt(12)
    ds_read_b64_tr_b16 v[38:39], v129 offset:41472
    v_mfma_f32_16x16x32_bf16 v[64:67], v[112:115], v[232:235], v[64:67]
    ds_read_b64_tr_b16 v[20:21], v129 offset:46080
    s_waitcnt lgkmcnt(12)
    ds_read_b32 v136, v137
    v_mfma_f32_16x16x32_bf16 v[68:71], v[112:115], v[236:239], v[68:71]
    ds_read_b64_tr_b16 v[22:23], v129 offset:50688
    v_mfma_f32_16x16x32_bf16 v[64:67], v[116:119], v[240:243], v[64:67]
    s_waitcnt lgkmcnt(12)
    ds_read_b64_tr_b16 v[112:113], v130 offset:0
    v_mfma_f32_16x16x32_bf16 v[68:71], v[116:119], v[244:247], v[68:71]
    ds_read_b64_tr_b16 v[114:115], v130 offset:4608
    s_waitcnt lgkmcnt(13)
    v_mfma_f32_16x16x32_bf16 v[64:67], v[24:27], v[248:251], v[64:67]
    ds_read_b64_tr_b16 v[116:117], v130 offset:9216
    v_mfma_f32_16x16x32_bf16 v[68:71], v[24:27], v[252:255], v[68:71]
    s_waitcnt lgkmcnt(12)
    ds_read_b64_tr_b16 v[118:119], v130 offset:13824
    s_waitcnt lgkmcnt(12)
    v_mfma_f32_16x16x32_bf16 v[72:75], v[28:31], v[168:171], v[72:75]
    ds_read_b64_tr_b16 v[24:25], v130 offset:18432
    v_mfma_f32_16x16x32_bf16 v[76:79], v[28:31], v[172:175], v[76:79]
    ds_read_b64_tr_b16 v[26:27], v130 offset:23040
    s_waitcnt lgkmcnt(7)
    v_readfirstlane_b32 s64, v136
    s_nop 0
    s_cmp_ge_u32 s64, 20
    s_cbranch_scc0 Ls_s50
Ls_r50:
    v_mfma_f32_16x16x32_bf16 v[72:75], v[32:35], v[176:179], v[72:75]
    ds_read_b64_tr_b16 v[28:29], v130 offset:27648
    ds_write_b128 v19, v[64:67] offset:18432
    v_mfma_f32_16x16x32_bf16 v[76:79], v[32:35], v[180:183], v[76:79]
    ds_read_b64_tr_b16 v[30:31], v130 offset:32256
    v_mfma_f32_16x16x32_bf16 v[72:75], v[36:39], v[184:187], v[72:75]
    ds_read_b64_tr_b16 v[32:33], v130 offset:36864
    ds_write_b128 v19, v[68:71] offset:19456
    v_mfma_f32_16x16x32_bf16 v[76:79], v[36:39], v[188:191], v[76:79]
    ds_read_b64_tr_b16 v[34:35], v130 offset:41472
    s_waitcnt lgkmcnt(12)
    v_mfma_f32_16x16x32_bf16 v[72:75], v[20:23], v[192:195], v[72:75]
    ds_read_b64_tr_b16 v[36:37], v128 offset:0
    v_mov_b32 v0, 22
    v_mfma_f32_16x16x32_bf16 v[76:79], v[20:23], v[196:199], v[76:79]
    ds_read_b64_tr_b16 v[38:39], v128 offset:4608
    s_waitcnt lgkmcnt(12)
    v_mfma_f32_16x16x32_bf16 v[72:75], v[112:115], v[200:203], v[72:75]
    ds_read_b64_tr_b16 v[20:21], v128 offset:9216
    ds_write_b32 v10, v0
    v_mfma_f32_16x16x32_bf16 v[76:79], v[112:115], v[204:207], v[76:79]
    s_waitcnt lgkmcnt(12)
    ds_read_b64_tr_b16 v[22:23], v128 offset:13824
    v_mfma_f32_16x16x32_bf16 v[72:75], v[116:119], v[208:211], v[72:75]
    v_add_u32 v132, s97, v5
    v_add_u32 v133, s97, v6
    v_add_u32 v134, s97, v8
    ds_read_b64_tr_b16 v[112:113], v133 offset:18432
    v_mfma_f32_16x16x32_bf16 v[76:79], v[116:119], v[212:215], v[76:79]
    s_waitcnt lgkmcnt(12)
    ds_read_b64_tr_b16 v[114:115], v133 offset:23040
    v_mfma_f32_16x16x32_bf16 v[72:75], v[24:27], v[216:219], v[72:75]
    ds_read_b64_tr_b16 v[116:117], v133 offset:27648
    v_mfma_f32_16x16x32_bf16 v[76:79], v[24:27], v[220:223], v[76:79]
    s_waitcnt lgkmcnt(12)
    ds_read_b64_tr_b16 v[118:119], v133 offset:32256
    s_waitcnt lgkmcnt(12)
    v_mfma_f32_16x16x32_bf16 v[72:75], v[28:31], v[224:227], v[72:75]
    ds_read_b64_tr_b16 v[24:25], v133 offset:36864
    v_mfma_f32_16x16x32_bf16 v[76:79], v[28:31], v[228:231], v[76:79]
    ds_read_b64_tr_b16 v[26:27], v133 offset:41472
    s_waitcnt lgkmcnt(11)
    v_mfma_f32_16x16x32_bf16 v[72:75], v[32:35], v[232:235], v[72:75]
    ds_read_b64_tr_b16 v[28:29], v133 offset:46080
    ds_read_b32 v136, v137
    v_mfma_f32_16x16x32_bf16 v[76:79], v[32:35], v[236:239], v[76:79]
    ds_read_b64_tr_b16 v[30:31], v133 offset:50688
    s_waitcnt lgkmcnt(12)
    v_mfma_f32_16x16x32_bf16 v[72:75], v[36:39], v[240:243], v[72:75]
    ds_read_b64_tr_b16 v[32:33], v134 offset:0
    v_mfma_f32_16x16x32_bf16 v[76:79], v[36:39], v[244:247], v[76:79]
    ds_read_b64_tr_b16 v[34:35], v134 offset:4608
    s_waitcnt lgkmcnt(11)
    v_mfma_f32_16x16x32_bf16 v[72:75], v[20:23], v[248:251], v[72:75]
    ds_read_b64_tr_b16 v[36:37], v134 offset:9216
    v_mfma_f32_16x16x32_bf16 v[76:79], v[20:23], v[252:255], v[76:79]
    ds_read_b64_tr_b16 v[38:39], v134 offset:13824
    s_waitcnt lgkmcnt(11)
    v_mfma_f32_16x16x32_bf16 v[80:83], v[112:115], v[168:171], v[80:83]
    ds_read_b64_tr_b16 v[20:21], v134 offset:18432
    v_mfma_f32_16x16x32_bf16 v[84:87], v[112:115], v[172:175], v[84:87]
    ds_read_b64_tr_b16 v[22:23], v134 offset:23040
    s_waitcnt lgkmcnt(7)
    v_readfirstlane_b32 s64, v136
    s_nop 0
    s_cmp_ge_u32 s64, 21
    s_cbranch_scc0 Ls_s51
Ls_r51:
    v_mfma_f32_16x16x32_bf16 v[80:83], v[116:119], v[176:179], v[80:83]
    ds_read_b64_tr_b16 v[112:113], v134 offset:27648
    ds_write_b128 v19, v[72:75] offset:27648
    v_mfma_f32_16x16x32_bf16 v[84:87], v[116:119], v[180:183], v[84:87]
    ds_read_b64_tr_b16 v[114:115], v134 offset:32256
    v_mfma_f32_16x16x32_bf16 v[80:83], v[24:27], v[184:187], v[80:83]
    ds_read_b64_tr_b16 v[116:117], v134 offset:36864
    ds_write_b128 v19, v[76:79] offset:28672
    v_mfma_f32_16x16x32_bf16 v[84:87], v[24:27], v[188:191], v[84:87]
    ds_read_b64_tr_b16 v[118:119], v134 offset:41472
    s_waitcnt lgkmcnt(12)
    v_mfma_f32_16x16x32_bf16 v[80:83], v[28:31], v[192:195], v[80:83]
    ds_read_b64_tr_b16 v[24:25], v132 offset:0
    v_mov_b32 v0, 23
    v_mfma_f32_16x16x32_bf16 v[84:87], v[28:31], v[196:199], v[84:87]
    ds_read_b64_tr_b16 v[26:27], v132 offset:4608
    s_waitcnt lgkmcnt(12)
    v_mfma_f32_16x16x32_bf16 v[80:83], v[32:35], v[200:203], v[80:83]
    ds_read_b64_tr_b16 v[28:29], v132 offset:9216
    ds_write_b32 v10, v0
    v_mfma_f32_16x16x32_bf16 v[84:87], v[32:35], v[204:207], v[84:87]
    s_waitcnt lgkmcnt(12)
    ds_read_b64_tr_b16 v[30:31], v132 offset:13824
    v_mfma_f32_16x16x32_bf16 v[80:83], v[36:39], v[208:211], v[80:83]
    v_add_u32 v128, s98, v5
    v_add_u32 v129, s98, v6
    v_add_u32 v130, s98, v8
    ds_read_b64_tr_b16 v[32:33], v129 offset:18432
    v_mfma_f32_16x16x32_bf16 v[84:87], v[36:39], v[212:215], v[84:87]
    s_waitcnt lgkmcnt(12)
    ds_read_b64_tr_b16 v[34:35], v129 offset:23040
    v_mfma_f32_16x16x32_bf16 v[80:83], v[20:23], v[216:219], v[80:83]
    ds_read_b64_tr_b16 v[36:37], v129 offset:27648
    v_mfma_f32_16x16x32_bf16 v[84:87], v[20:23], v[220:223], v[84:87]
    s_waitcnt lgkmcnt(12)
    ds_read_b64_tr_b16 v[38:39], v129 offset:32256
    s_waitcnt lgkmcnt(12)
    v_mfma_f32_16x16x32_bf16 v[80:83], v[112:115], v[224:227], v[80:83]
    ds_read_b64_tr_b16 v[20:21], v129 offset:36864
    v_mfma_f32_16x16x32_bf16 v[84:87], v[112:115], v[228:231], v[84:87]
    ds_read_b64_tr_b16 v[22:23], v129 offset:41472
    s_waitcnt lgkmcnt(11)
    v_mfma_f32_16x16x32_bf16 v[80:83], v[116:119], v[232:235], v[80:83]
    ds_read_b64_tr_b16 v[112:113], v129 offset:46080
    ds_read_b32 v136, v137
    v_mfma_f32_16x16x32_bf16 v[84:87], v[116:119], v[236:239], v[84:87]
    ds_read_b64_tr_b16 v[114:115], v129 offset:50688
    s_waitcnt lgkmcnt(12)
    v_mfma_f32_16x16x32_bf16 v[80:83], v[24:27], v[240:243], v[80:83]
    ds_read_b64_tr_b16 v[116:117], v130 offset:0
    v_mfma_f32_16x16x32_bf16 v[84:87], v[24:27], v[244:247], v[84:87]
    ds_read_b64_tr_b16 v[118:119], v130 offset:4608
    s_waitcnt lgkmcnt(11)
    v_mfma_f32_16x16x32_bf16 v[80:83], v[28:31], v[248:251], v[80:83]
    ds_read_b64_tr_b16 v[24:25], v130 offset:9216
    v_mfma_f32_16x16x32_bf16 v[84:87], v[28:31], v[252:255], v[84:87]
    ds_read_b64_tr_b16 v[26:27], v130 offset:13824
    s_waitcnt lgkmcnt(11)
    v_mfma_f32_16x16x32_bf16 v[88:91], v[32:35], v[168:171], v[88:91]
    ds_read_b64_tr_b16 v[28:29], v130 offset:18432
    v_mfma_f32_16x16x32_bf16 v[92:95], v[32:35], v[172:175], v[92:95]
    ds_read_b64_tr_b16 v[30:31], v130 offset:23040
    s_waitcnt lgkmcnt(7)
    v_readfirstlane_b32 s64, v136
    s_nop 0
    s_cmp_ge_u32 s64, 22
    s_cbranch_scc0 Ls_s52
Ls_r52:
    v_mfma_f32_16x16x32_bf16 v[88:91], v[36:39], v[176:179], v[88:91]
    ds_read_b64_tr_b16 v[32:33], v130 offset:27648
    ds_write_b128 v19, v[80:83] offset:36864
    v_mfma_f32_16x16x32_bf16 v[92:95], v[36:39], v[180:183], v[92:95]
    ds_read_b64_tr_b16 v[34:35], v130 offset:32256
    v_mfma_f32_16x16x32_bf16 v[88:91], v[20:23], v[184:187], v[88:91]
    ds_read_b64_tr_b16 v[36:37], v130 offset:36864
    ds_write_b128 v19, v[84:87] offset:37888
    v_mfma_f32_16x16x32_bf16 v[92:95], v[20:23], v[188:191], v[92:95]
    ds_read_b64_tr_b16 v[38:39], v130 offset:41472
    s_waitcnt lgkmcnt(12)
    v_mfma_f32_16x16x32_bf16 v[88:91], v[112:115], v[192:195], v[88:91]
    ds_read_b64_tr_b16 v[20:21], v128 offset:0
    v_mov_b32 v0, 24
    v_mfma_f32_16x16x32_bf16 v[92:95], v[112:115], v[196:199], v[92:95]
    ds_read_b64_tr_b16 v[22:23], v128 offset:4608
    s_waitcnt lgkmcnt(12)
    v_mfma_f32_16x16x32_bf16 v[88:91], v[116:119], v[200:203], v[88:91]
    ds_read_b64_tr_b16 v[112:113], v128 offset:9216
    ds_write_b32 v10, v0
    v_mfma_f32_16x16x32_bf16 v[92:95], v[116:119], v[204:207], v[92:95]
    s_waitcnt lgkmcnt(12)
    ds_read_b64_tr_b16 v[114:115], v128 offset:13824
    v_mfma_f32_16x16x32_bf16 v[88:91], v[24:27], v[208:211], v[88:91]
    v_add_u32 v132, s99, v5
    v_add_u32 v133, s99, v6
    v_add_u32 v134, s99, v8
    ds_read_b64_tr_b16 v[116:117], v133 offset:18432
    v_mfma_f32_16x16x32_bf16 v[92:95], v[24:27], v[212:215], v[92:95]
    s_waitcnt lgkmcnt(12)
    ds_read_b64_tr_b16 v[118:119], v133 offset:23040
    v_mfma_f32_16x16x32_bf16 v[88:91], v[28:31], v[216:219], v[88:91]
    ds_read_b64_tr_b16 v[24:25], v133 offset:27648
    v_mfma_f32_16x16x32_bf16 v[92:95], v[28:31], v[220:223], v[92:95]
    s_waitcnt lgkmcnt(12)
    ds_read_b64_tr_b16 v[26:27], v133 offset:32256
    s_waitcnt lgkmcnt(12)
    v_mfma_f32_16x16x32_bf16 v[88:91], v[32:35], v[224:227], v[88:91]
    ds_read_b64_tr_b16 v[28:29], v133 offset:36864
    v_mfma_f32_16x16x32_bf16 v[92:95], v[32:35], v[228:231], v[92:95]
    ds_read_b64_tr_b16 v[30:31], v133 offset:41472
    s_waitcnt lgkmcnt(11)
    v_mfma_f32_16x16x32_bf16 v[88:91], v[36:39], v[232:235], v[88:91]
    ds_read_b64_tr_b16 v[32:33], v133 offset:46080
    ds_read_b32 v136, v137
    v_mfma_f32_16x16x32_bf16 v[92:95], v[36:39], v[236:239], v[92:95]
    ds_read_b64_tr_b16 v[34:35], v133 offset:50688
    s_waitcnt lgkmcnt(12)
    v_mfma_f32_16x16x32_bf16 v[88:91], v[20:23], v[240:243], v[88:91]
    ds_read_b64_tr_b16 v[36:37], v134 offset:0
    v_mfma_f32_16x16x32_bf16 v[92:95], v[20:23], v[244:247], v[92:95]
    ds_read_b64_tr_b16 v[38:39], v134 offset:4608
    s_waitcnt lgkmcnt(11)
    v_mfma_f32_16x16x32_bf16 v[88:91], v[112:115], v[248:251], v[88:91]
    ds_read_b64_tr_b16 v[20:21], v134 offset:9216
    v_mfma_f32_16x16x32_bf16 v[92:95], v[112:115], v[252:255], v[92:95]
    ds_read_b64_tr_b16 v[22:23], v134 offset:13824
    s_waitcnt lgkmcnt(11)
    v_mfma_f32_16x16x32_bf16 v[96:99], v[116:119], v[168:171], v[96:99]
    ds_read_b64_tr_b16 v[112:113], v134 offset:18432
    v_mfma_f32_16x16x32_bf16 v[100:103], v[116:119], v[172:175], v[100:103]
    ds_read_b64_tr_b16 v[114:115], v134 offset:23040
    s_waitcnt lgkmcnt(7)
    v_readfirstlane_b32 s64, v136
    s_nop 0
    s_cmp_ge_u32 s64, 23
    s_cbranch_scc0 Ls_s53
Ls_r53:
    v_mfma_f32_16x16x32_bf16 v[96:99], v[24:27], v[176:179], v[96:99]
    ds_read_b64_tr_b16 v[116:117], v134 offset:27648
    ds_write_b128 v19, v[88:91] offset:18432
    v_mfma_f32_16x16x32_bf16 v[100:103], v[24:27], v[180:183], v[100:103]
    ds_read_b64_tr_b16 v[118:119], v134 offset:32256
    v_mfma_f32_16x16x32_bf16 v[96:99], v[28:31], v[184:187], v[96:99]
    ds_read_b64_tr_b16 v[24:25], v134 offset:36864
    ds_write_b128 v19, v[92:95] offset:19456
    v_mfma_f32_16x16x32_bf16 v[100:103], v[28:31], v[188:191], v[100:103]
    ds_read_b64_tr_b16 v[26:27], v134 offset:41472
    s_waitcnt lgkmcnt(12)
    v_mfma_f32_16x16x32_bf16 v[96:99], v[32:35], v[192:195], v[96:99]
    ds_read_b64_tr_b16 v[28:29], v132 offset:0
    v_mov_b32 v0, 25
    v_mfma_f32_16x16x32_bf16 v[100:103], v[32:35], v[196:199], v[100:103]
    ds_read_b64_tr_b16 v[30:31], v132 offset:4608
    s_waitcnt lgkmcnt(12)
    v_mfma_f32_16x16x32_bf16 v[96:99], v[36:39], v[200:203], v[96:99]
    ds_read_b64_tr_b16 v[32:33], v132 offset:9216
    ds_write_b32 v10, v0
    v_mfma_f32_16x16x32_bf16 v[100:103], v[36:39], v[204:207], v[100:103]
    s_waitcnt lgkmcnt(12)
    ds_read_b64_tr_b16 v[34:35], v132 offset:13824
    v_mfma_f32_16x16x32_bf16 v[96:99], v[20:23], v[208:211], v[96:99]
    v_add_u32 v128, s100, v5
    v_add_u32 v129, s100, v6
    v_add_u32 v130, s100, v8
    ds_read_b64_tr_b16 v[36:37], v129 offset:18432
    v_mfma_f32_16x16x32_bf16 v[100:103], v[20:23], v[212:215], v[100:103]
    s_waitcnt lgkmcnt(12)
    ds_read_b64_tr_b16 v[38:39], v129 offset:23040
    v_mfma_f32_16x16x32_bf16 v[96:99], v[112:115], v[216:219], v[96:99]
    ds_read_b64_tr_b16 v[20:21], v129 offset:27648
    v_mfma_f32_16x16x32_bf16 v[100:103], v[112:115], v[220:223], v[100:103]
    s_waitcnt lgkmcnt(12)
    ds_read_b64_tr_b16 v[22:23], v129 offset:32256
    s_waitcnt lgkmcnt(12)
    v_mfma_f32_16x16x32_bf16 v[96:99], v[116:119], v[224:227], v[96:99]
    ds_read_b64_tr_b16 v[112:113], v129 offset:36864
    v_mfma_f32_16x16x32_bf16 v[100:103], v[116:119], v[228:231], v[100:103]
    ds_read_b64_tr_b16 v[114:115], v129 offset:41472
    s_waitcnt lgkmcnt(11)
    v_mfma_f32_16x16x32_bf16 v[96:99], v[24:27], v[232:235], v[96:99]
    ds_read_b64_tr_b16 v[116:117], v129 offset:46080
    ds_read_b32 v136, v137
    v_mfma_f32_16x16x32_bf16 v[100:103], v[24:27], v[236:239], v[100:103]
    ds_read_b64_tr_b16 v[118:119], v129 offset:50688
    s_lshr_b32 s64, s58, 1
    s_cmp_lg_u32 s64, s57
    s_cbranch_scc1 Ls_e8_54
    s_lshl_b32 s64, s62, 2
    s_add_u32 s64, s64, s63
    s_mul_i32 s64, s64, 294912
    s_add_u32 s69, s64, 14942208
    s_add_u32 s69, s69, s83
    s_sub_u32 s64, s58, 0
    s_and_b32 s64, s64, 7
    s_lshl_b32 s64, s64, 12
    s_add_u32 s64, s64, s69
    buffer_load_dwordx4 v[40:43], v4, s[44:47], s64 offen sc1
    s_sub_u32 s64, s58, 1
    s_and_b32 s64, s64, 7
    s_lshl_b32 s64, s64, 12
    s_add_u32 s64, s64, s69
    buffer_load_dwordx4 v[44:47], v4, s[44:47], s64 offen sc1
    s_sub_u32 s64, s58, 2
    s_and_b32 s64, s64, 7
    s_lshl_b32 s64, s64, 12
    s_add_u32 s64, s64, s69
    buffer_load_dwordx4 v[48:51], v4, s[44:47], s64 offen sc1
    s_sub_u32 s64, s58, 3
    s_and_b32 s64, s64, 7
    s_lshl_b32 s64, s64, 12
    s_add_u32 s64, s64, s69
    buffer_load_dwordx4 v[52:55], v4, s[44:47], s64 offen sc1
    s_sub_u32 s64, s58, 4
    s_and_b32 s64, s64, 7
    s_lshl_b32 s64, s64, 12
    s_add_u32 s64, s64, s69
    buffer_load_dwordx4 v[56:59], v4, s[44:47], s64 offen sc1
    s_sub_u32 s64, s58, 5
    s_and_b32 s64, s64, 7
    s_lshl_b32 s64, s64, 12
    s_add_u32 s64, s64, s69
    buffer_load_dwordx4 v[60:63], v4, s[44:47], s64 offen sc1
    s_sub_u32 s64, s58, 6
    s_and_b32 s64, s64, 7
    s_lshl_b32 s64, s64, 12
    s_add_u32 s64, s64, s69
    buffer_load_dwordx4 v[64:67], v4, s[44:47], s64 offen sc1
    s_sub_u32 s64, s58, 7
    s_and_b32 s64, s64, 7
    s_lshl_b32 s64, s64, 12
    s_add_u32 s64, s64, s69
    buffer_load_dwordx4 v[68:71], v4, s[44:47], s64 offen sc1
    s_mul_i32 s64, s63, 9
    s_add_u32 s78, s64, 8
    s_lshl_b32 s64, s62, 3
    s_add_u32 s79, s64, s58
    s_mul_i32 s64, s79, 9
    s_lshr_b32 s65, s78, 2
    s_add_u32 s64, s64, s65
    s_mul_i32 s64, s64, 2304
    s_and_b32 s65, s78, 2
    s_lshl_b32 s65, s65, 9
    s_add_u32 s64, s64, s65
    s_and_b32 s65, s78, 1
    s_lshl_b32 s65, s65, 3
    s_add_u32 s64, s64, s65
    s_add_u32 s64, s64, 2097152
    buffer_load_dwordx2 v[72:73], v4, s[44:47], s64 offen sc1
Ls_e8_54:
    s_waitcnt lgkmcnt(12)
    v_mfma_f32_16x16x32_bf16 v[96:99], v[28:31], v[240:243], v[96:99]
    ds_read_b64_tr_b16 v[24:25], v130 offset:0
    v_mfma_f32_16x16x32_bf16 v[100:103], v[28:31], v[244:247], v[100:103]
    ds_read_b64_tr_b16 v[26:27], v130 offset:4608
    s_waitcnt lgkmcnt(11)
    v_mfma_f32_16x16x32_bf16 v[96:99], v[32:35], v[248:251], v[96:99]
    ds_read_b64_tr_b16 v[28:29], v130 offset:9216
    v_mfma_f32_16x16x32_bf16 v[100:103], v[32:35], v[252:255], v[100:103]
    ds_read_b64_tr_b16 v[30:31], v130 offset:13824
    s_waitcnt lgkmcnt(11)
    v_mfma_f32_16x16x32_bf16 v[104:107], v[36:39], v[168:171], v[104:107]
    ds_read_b64_tr_b16 v[32:33], v130 offset:18432
    v_mfma_f32_16x16x32_bf16 v[108:111], v[36:39], v[172:175], v[108:111]
    ds_read_b64_tr_b16 v[34:35], v130 offset:23040
    s_waitcnt lgkmcnt(7)
    v_readfirstlane_b32 s64, v136
    s_nop 0
    s_cmp_ge_u32 s64, 24
    s_cbranch_scc0 Ls_s55
Ls_r55:
    v_mfma_f32_16x16x32_bf16 v[104:107], v[20:23], v[176:179], v[104:107]
    ds_read_b64_tr_b16 v[36:37], v130 offset:27648
    ds_write_b128 v19, v[96:99] offset:27648
    v_mfma_f32_16x16x32_bf16 v[108:111], v[20:23], v[180:183], v[108:111]
    ds_read_b64_tr_b16 v[38:39], v130 offset:32256
    v_mfma_f32_16x16x32_bf16 v[104:107], v[112:115], v[184:187], v[104:107]
    ds_read_b64_tr_b16 v[20:21], v130 offset:36864
    ds_write_b128 v19, v[100:103] offset:28672
    v_mfma_f32_16x16x32_bf16 v[108:111], v[112:115], v[188:191], v[108:111]
    ds_read_b64_tr_b16 v[22:23], v130 offset:41472
    s_waitcnt lgkmcnt(12)
    v_mfma_f32_16x16x32_bf16 v[104:107], v[116:119], v[192:195], v[104:107]
    ds_read_b64_tr_b16 v[112:113], v128 offset:0
    v_mov_b32 v0, 26
    v_mfma_f32_16x16x32_bf16 v[108:111], v[116:119], v[196:199], v[108:111]
    ds_read_b64_tr_b16 v[114:115], v128 offset:4608
    s_waitcnt lgkmcnt(12)
    v_mfma_f32_16x16x32_bf16 v[104:107], v[24:27], v[200:203], v[104:107]
    ds_read_b64_tr_b16 v[116:117], v128 offset:9216
    ds_write_b32 v10, v0
    v_mfma_f32_16x16x32_bf16 v[108:111], v[24:27], v[204:207], v[108:111]
    s_waitcnt lgkmcnt(12)
    ds_read_b64_tr_b16 v[118:119], v128 offset:13824
    v_mfma_f32_16x16x32_bf16 v[104:107], v[28:31], v[208:211], v[104:107]
    v_mfma_f32_16x16x32_bf16 v[108:111], v[28:31], v[212:215], v[108:111]
    s_waitcnt lgkmcnt(11)
    v_mfma_f32_16x16x32_bf16 v[104:107], v[32:35], v[216:219], v[104:107]
    ds_read_b32 v136, v137
    v_mfma_f32_16x16x32_bf16 v[108:111], v[32:35], v[220:223], v[108:111]
    s_waitcnt lgkmcnt(9)
    v_mfma_f32_16x16x32_bf16 v[104:107], v[36:39], v[224:227], v[104:107]
    v_mfma_f32_16x16x32_bf16 v[108:111], v[36:39], v[228:231], v[108:111]
    s_waitcnt lgkmcnt(6)
    v_mfma_f32_16x16x32_bf16 v[104:107], v[20:23], v[232:235], v[104:107]
    v_mfma_f32_16x16x32_bf16 v[108:111], v[20:23], v[236:239], v[108:111]
    s_waitcnt lgkmcnt(4)
    v_mfma_f32_16x16x32_bf16 v[104:107], v[112:115], v[240:243], v[104:107]
    v_mfma_f32_16x16x32_bf16 v[108:111], v[112:115], v[244:247], v[108:111]
    s_waitcnt lgkmcnt(0)
    v_readfirstlane_b32 s64, v136
    s_nop 0
    s_cmp_ge_u32 s64, 25
    s_cbranch_scc0 Ls_s56
Ls_r56:
    v_mfma_f32_16x16x32_bf16 v[104:107], v[116:119], v[248:251], v[104:107]
    v_mfma_f32_16x16x32_bf16 v[108:111], v[116:119], v[252:255], v[108:111]
    s_nop 6
    ds_write_b128 v19, v[104:107] offset:36864
    ds_write_b128 v19, v[108:111] offset:37888
    v_mov_b32 v0, 27
    ds_write_b32 v10, v0
    s_lshr_b32 s64, s58, 1
    s_cmp_lg_u32 s64, s57
    s_cbranch_scc1 Lu8_57
    s_and_b32 s64, s3, 0xf0000000
    v_mov_b32 v200, s64
    s_mov_b32 s95, 0x01800000
    s_mov_b32 s96, 0x07800000
    s_mov_b32 s97, 0x1f800000
    v_mul_u32_u24 v201, 1152, v3
    v_lshl_add_u32 v201, v2, 3, v201
    s_bitcmp1_b32 s58, 0
    s_cselect_b64 s[98:99], -1, 0
    v_mov_b32 v192, 0
    v_mov_b32 v193, 0
    v_mov_b32 v194, 0
    v_mov_b32 v195, 0
    s_waitcnt vmcnt(8)
    v_xor_b32 v12, v40, v200
    v_bitop3_b32 v12, v12, v41, v200 bitop3:0xf6
    v_bitop3_b32 v12, v12, v42, v200 bitop3:0xf6
    v_bitop3_b32 v12, v12, v43, v200 bitop3:0xf6
    v_cmp_gt_u32 vcc, 0x10000000, v12
    s_nop 0
    s_cmp_eq_u64 vcc, -1
    s_cbranch_scc0 Ls_s58
Ls_r58:
    v_lshrrev_b32 v12, 3, v40
    v_lshrrev_b32 v13, 1, v41
    v_bfi_b32 v12, s95, v12, v13
    v_lshlrev_b32 v13, 1, v42
    v_bfi_b32 v12, s96, v12, v13
    v_lshlrev_b32 v13, 3, v43
    v_bfi_b32 v12, s97, v12, v13
    v_and_b32 v12, 0x7f800000, v12
    v_add_u32 v12, 4202694656, v12
    v_cndmask_b32 v40, v40, v42, s[98:99]
    v_cndmask_b32 v41, v41, v43, s[98:99]
    v_bfe_i32 v208, v40, 0, 13
    v_bfe_i32 v209, v40, 13, 13
    v_bfe_i32 v210, v41, 0, 13
    v_bfe_i32 v211, v41, 13, 13
    v_cvt_f32_i32 v208, v208
    v_cvt_f32_i32 v209, v209
    v_cvt_f32_i32 v210, v210
    v_cvt_f32_i32 v211, v211
    v_fma_f32 v192, v208, v12, v192
    v_fma_f32 v193, v209, v12, v193
    v_fma_f32 v194, v210, v12, v194
    v_fma_f32 v195, v211, v12, v195
    s_waitcnt vmcnt(7)
    v_xor_b32 v12, v44, v200
    v_bitop3_b32 v12, v12, v45, v200 bitop3:0xf6
    v_bitop3_b32 v12, v12, v46, v200 bitop3:0xf6
    v_bitop3_b32 v12, v12, v47, v200 bitop3:0xf6
    v_cmp_gt_u32 vcc, 0x10000000, v12
    s_nop 0
    s_cmp_eq_u64 vcc, -1
    s_cbranch_scc0 Ls_s59
Ls_r59:
    v_lshrrev_b32 v12, 3, v44
    v_lshrrev_b32 v13, 1, v45
    v_bfi_b32 v12, s95, v12, v13
    v_lshlrev_b32 v13, 1, v46
    v_bfi_b32 v12, s96, v12, v13
    v_lshlrev_b32 v13, 3, v47
    v_bfi_b32 v12, s97, v12, v13
    v_and_b32 v12, 0x7f800000, v12
    v_add_u32 v12, 4202694656, v12
    v_cndmask_b32 v44, v44, v46, s[98:99]
    v_cndmask_b32 v45, v45, v47, s[98:99]
    v_bfe_i32 v208, v44, 0, 13
    v_bfe_i32 v209, v44, 13, 13
    v_bfe_i32 v210, v45, 0, 13
    v_bfe_i32 v211, v45, 13, 13
    v_cvt_f32_i32 v208, v208
    v_cvt_f32_i32 v209, v209
    v_cvt_f32_i32 v210, v210
    v_cvt_f32_i32 v211, v211
    v_fma_f32 v192, v208, v12, v192
    v_fma_f32 v193, v209, v12, v193
    v_fma_f32 v194, v210, v12, v194
    v_fma_f32 v195, v211, v12, v195
    s_waitcnt vmcnt(6)
    v_xor_b32 v12, v48, v200
    v_bitop3_b32 v12, v12, v49, v200 bitop3:0xf6
    v_bitop3_b32 v12, v12, v50, v200 bitop3:0xf6
    v_bitop3_b32 v12, v12, v51, v200 bitop3:0xf6
    v_cmp_gt_u32 vcc, 0x10000000, v12
    s_nop 0
    s_cmp_eq_u64 vcc, -1
    s_cbranch_scc0 Ls_s60
Ls_r60:
    v_lshrrev_b32 v12, 3, v48
    v_lshrrev_b32 v13, 1, v49
    v_bfi_b32 v12, s95, v12, v13
    v_lshlrev_b32 v13, 1, v50
    v_bfi_b32 v12, s96, v12, v13
    v_lshlrev_b32 v13, 3, v51
    v_bfi_b32 v12, s97, v12, v13
    v_and_b32 v12, 0x7f800000, v12
    v_add_u32 v12, 4202694656, v12
    v_cndmask_b32 v48, v48, v50, s[98:99]
    v_cndmask_b32 v49, v49, v51, s[98:99]
    v_bfe_i32 v208, v48, 0, 13
    v_bfe_i32 v209, v48, 13, 13
    v_bfe_i32 v210, v49, 0, 13
    v_bfe_i32 v211, v49, 13, 13
    v_cvt_f32_i32 v208, v208
    v_cvt_f32_i32 v209, v209
    v_cvt_f32_i32 v210, v210
    v_cvt_f32_i32 v211, v211
    v_fma_f32 v192, v208, v12, v192
    v_fma_f32 v193, v209, v12, v193
    v_fma_f32 v194, v210, v12, v194
    v_fma_f32 v195, v211, v12, v195
    s_waitcnt vmcnt(5)
    v_xor_b32 v12, v52, v200
    v_bitop3_b32 v12, v12, v53, v200 bitop3:0xf6
    v_bitop3_b32 v12, v12, v54, v200 bitop3:0xf6
    v_bitop3_b32 v12, v12, v55, v200 bitop3:0xf6
    v_cmp_gt_u32 vcc, 0x10000000, v12
    s_nop 0
    s_cmp_eq_u64 vcc, -1
    s_cbranch_scc0 Ls_s61
Ls_r61:
    v_lshrrev_b32 v12, 3, v52
    v_lshrrev_b32 v13, 1, v53
    v_bfi_b32 v12, s95, v12, v13
    v_lshlrev_b32 v13, 1, v54
    v_bfi_b32 v12, s96, v12, v13
    v_lshlrev_b32 v13, 3, v55
    v_bfi_b32 v12, s97, v12, v13
    v_and_b32 v12, 0x7f800000, v12
    v_add_u32 v12, 4202694656, v12
    v_cndmask_b32 v52, v52, v54, s[98:99]
    v_cndmask_b32 v53, v53, v55, s[98:99]
    v_bfe_i32 v208, v52, 0, 13
    v_bfe_i32 v209, v52, 13, 13
    v_bfe_i32 v210, v53, 0, 13
    v_bfe_i32 v211, v53, 13, 13
    v_cvt_f32_i32 v208, v208
    v_cvt_f32_i32 v209, v209
    v_cvt_f32_i32 v210, v210
    v_cvt_f32_i32 v211, v211
    v_fma_f32 v192, v208, v12, v192
    v_fma_f32 v193, v209, v12, v193
    v_fma_f32 v194, v210, v12, v194
    v_fma_f32 v195, v211, v12, v195
    s_waitcnt vmcnt(4)
    v_xor_b32 v12, v56, v200
    v_bitop3_b32 v12, v12, v57, v200 bitop3:0xf6
    v_bitop3_b32 v12, v12, v58, v200 bitop3:0xf6
    v_bitop3_b32 v12, v12, v59, v200 bitop3:0xf6
    v_cmp_gt_u32 vcc, 0x10000000, v12
    s_nop 0
    s_cmp_eq_u64 vcc, -1
    s_cbranch_scc0 Ls_s62
Ls_r62:
    v_lshrrev_b32 v12, 3, v56
    v_lshrrev_b32 v13, 1, v57
    v_bfi_b32 v12, s95, v12, v13
    v_lshlrev_b32 v13, 1, v58
    v_bfi_b32 v12, s96, v12, v13
    v_lshlrev_b32 v13, 3, v59
    v_bfi_b32 v12, s97, v12, v13
    v_and_b32 v12, 0x7f800000, v12
    v_add_u32 v12, 4202694656, v12
    v_cndmask_b32 v56, v56, v58, s[98:99]
    v_cndmask_b32 v57, v57, v59, s[98:99]
    v_bfe_i32 v208, v56, 0, 13
    v_bfe_i32 v209, v56, 13, 13
    v_bfe_i32 v210, v57, 0, 13
    v_bfe_i32 v211, v57, 13, 13
    v_cvt_f32_i32 v208, v208
    v_cvt_f32_i32 v209, v209
    v_cvt_f32_i32 v210, v210
    v_cvt_f32_i32 v211, v211
    v_fma_f32 v192, v208, v12, v192
    v_fma_f32 v193, v209, v12, v193
    v_fma_f32 v194, v210, v12, v194
    v_fma_f32 v195, v211, v12, v195
    s_waitcnt vmcnt(3)
    v_xor_b32 v12, v60, v200
    v_bitop3_b32 v12, v12, v61, v200 bitop3:0xf6
    v_bitop3_b32 v12, v12, v62, v200 bitop3:0xf6
    v_bitop3_b32 v12, v12, v63, v200 bitop3:0xf6
    v_cmp_gt_u32 vcc, 0x10000000, v12
    s_nop 0
    s_cmp_eq_u64 vcc, -1
    s_cbranch_scc0 Ls_s63
Ls_r63:
    v_lshrrev_b32 v12, 3, v60
    v_lshrrev_b32 v13, 1, v61
    v_bfi_b32 v12, s95, v12, v13
    v_lshlrev_b32 v13, 1, v62
    v_bfi_b32 v12, s96, v12, v13
    v_lshlrev_b32 v13, 3, v63
    v_bfi_b32 v12, s97, v12, v13
    v_and_b32 v12, 0x7f800000, v12
    v_add_u32 v12, 4202694656, v12
    v_cndmask_b32 v60, v60, v62, s[98:99]
    v_cndmask_b32 v61, v61, v63, s[98:99]
    v_bfe_i32 v208, v60, 0, 13
    v_bfe_i32 v209, v60, 13, 13
    v_bfe_i32 v210, v61, 0, 13
    v_bfe_i32 v211, v61, 13, 13
    v_cvt_f32_i32 v208, v208
    v_cvt_f32_i32 v209, v209
    v_cvt_f32_i32 v210, v210
    v_cvt_f32_i32 v211, v211
    v_fma_f32 v192, v208, v12, v192
    v_fma_f32 v193, v209, v12, v193
    v_fma_f32 v194, v210, v12, v194
    v_fma_f32 v195, v211, v12, v195
    s_waitcnt vmcnt(2)
    v_xor_b32 v12, v64, v200
    v_bitop3_b32 v12, v12, v65, v200 bitop3:0xf6
    v_bitop3_b32 v12, v12, v66, v200 bitop3:0xf6
    v_bitop3_b32 v12, v12, v67, v200 bitop3:0xf6
    v_cmp_gt_u32 vcc, 0x10000000, v12
    s_nop 0
    s_cmp_eq_u64 vcc, -1
    s_cbranch_scc0 Ls_s64
Ls_r64:
    v_lshrrev_b32 v12, 3, v64
    v_lshrrev_b32 v13, 1, v65
    v_bfi_b32 v12, s95, v12, v13
    v_lshlrev_b32 v13, 1, v66
    v_bfi_b32 v12, s96, v12, v13
    v_lshlrev_b32 v13, 3, v67
    v_bfi_b32 v12, s97, v12, v13
    v_and_b32 v12, 0x7f800000, v12
    v_add_u32 v12, 4202694656, v12
    v_cndmask_b32 v64, v64, v66, s[98:99]
    v_cndmask_b32 v65, v65, v67, s[98:99]
    v_bfe_i32 v208, v64, 0, 13
    v_bfe_i32 v209, v64, 13, 13
    v_bfe_i32 v210, v65, 0, 13
    v_bfe_i32 v211, v65, 13, 13
    v_cvt_f32_i32 v208, v208
    v_cvt_f32_i32 v209, v209
    v_cvt_f32_i32 v210, v210
    v_cvt_f32_i32 v211, v211
    v_fma_f32 v192, v208, v12, v192
    v_fma_f32 v193, v209, v12, v193
    v_fma_f32 v194, v210, v12, v194
    v_fma_f32 v195, v211, v12, v195
    s_waitcnt vmcnt(1)
    v_xor_b32 v12, v68, v200
    v_bitop3_b32 v12, v12, v69, v200 bitop3:0xf6
    v_bitop3_b32 v12, v12, v70, v200 bitop3:0xf6
    v_bitop3_b32 v12, v12, v71, v200 bitop3:0xf6
    v_cmp_gt_u32 vcc, 0x10000000, v12
    s_nop 0
    s_cmp_eq_u64 vcc, -1
    s_cbranch_scc0 Ls_s65
Ls_r65:
    v_lshrrev_b32 v12, 3, v68
    v_lshrrev_b32 v13, 1, v69
    v_bfi_b32 v12, s95, v12, v13
    v_lshlrev_b32 v13, 1, v70
    v_bfi_b32 v12, s96, v12, v13
    v_lshlrev_b32 v13, 3, v71
    v_bfi_b32 v12, s97, v12, v13
    v_and_b32 v12, 0x7f800000, v12
    v_add_u32 v12, 4202694656, v12
    v_cndmask_b32 v68, v68, v70, s[98:99]
    v_cndmask_b32 v69, v69, v71, s[98:99]
    v_bfe_i32 v208, v68, 0, 13
    v_bfe_i32 v209, v68, 13, 13
    v_bfe_i32 v210, v69, 0, 13
    v_bfe_i32 v211, v69, 13, 13
    v_cvt_f32_i32 v208, v208
    v_cvt_f32_i32 v209, v209
    v_cvt_f32_i32 v210, v210
    v_cvt_f32_i32 v211, v211
    v_fma_f32 v192, v208, v12, v192
    v_fma_f32 v193, v209, v12, v193
    v_fma_f32 v194, v210, v12, v194
    v_fma_f32 v195, v211, v12, v195
    s_waitcnt vmcnt(0)
    v_cvt_pk_bf16_f32 v12, v192, v193
    v_lshlrev_b32 v13, 16, v12
    v_and_b32 v12, 0xffff0000, v12
    v_lshlrev_b32 v14, 16, v72
    v_and_b32 v15, 0xffff0000, v72
    v_add_f32 v13, v13, v14
    v_add_f32 v12, v12, v15
    v_cvt_pk_bf16_f32 v192, v13, v12
    v_cvt_pk_bf16_f32 v12, v194, v195
    v_lshlrev_b32 v13, 16, v12
    v_and_b32 v12, 0xffff0000, v12
    v_lshlrev_b32 v14, 16, v73
    v_and_b32 v15, 0xffff0000, v73
    v_add_f32 v13, v13, v14
    v_add_f32 v12, v12, v15
    v_cvt_pk_bf16_f32 v193, v13, v12
    s_mul_i32 s64, s79, 18432
    s_lshl_b32 s65, s78, 5
    s_add_u32 s64, s64, s65
    buffer_store_dwordx2 v[192:193], v201, s[40:43], s64 offen
Lu8_57:
    s_branch L_fin
L_h_mlp:
    s_waitcnt lgkmcnt(0)
    v_add_u32 v17, 147456, v4
    v_lshlrev_b32 v20, 3, v1
    v_add_u32 v20, 147456, v20
    s_mul_i32 s64, s57, 13312
    s_add_u32 s64, s64, 101376
    v_add_u32 v18, s64, v4
    v_mov_b32 v19, s82
    s_lshl_b32 s64, s62, 3
    s_lshl_b32 s65, s57, 1
    s_add_u32 s64, s64, s65
    s_lshl_b32 s64, s64, 3
    s_add_u32 s64, s64, s58
    s_mul_i32 s64, s64, 18432
    s_add_u32 s71, s64, 4194304
    s_lshl_b32 s64, s62, 3
    s_add_u32 s64, s64, s58
    s_lshl_b32 s64, s64, 2
    s_add_u32 s64, s64, s57
    s_lshl_b32 s64, s64, 10
    s_add_u32 s72, s64, 655360
    s_lshr_b32 s64, s63, 1
    s_add_u32 s64, s64, 16
    s_lshl_b32 s64, s64, 10
    s_add_u32 s68, s64, s71
    s_and_b32 s64, s63, 1
    s_lshl_b32 s64, s64, 9
    s_add_u32 s68, s68, s64
    s_lshl_b32 s64, s63, 12
    s_add_u32 s71, s71, s64
    s_lshl_b32 s64, s63, 8
    s_add_u32 s72, s72, s64
    s_add_u32 s64, s57, 0
    s_sub_u32 s65, s64, 9
    s_min_u32 s64, s64, s65
    s_lshl_b32 s92, s64, 10
    s_lshl_b32 s64, s64, 6
    v_add_u32 v12, s64, v1
    v_mul_u32_u24 v13, 3641, v12
    v_lshrrev_b32 v13, 16, v13
    v_mul_u32_u24 v14, 18, v13
    v_sub_u32 v12, v12, v14
    v_lshlrev_b32 v12, 4, v12
    v_mul_u32_u24 v200, 9216, v13
    v_add_u32 v200, v200, v12
    v_mul_u32_u24 v205, 1152, v13
    v_add_u32 v205, v205, v12
    v_lshrrev_b32 v13, 4, v13
    v_mul_u32_u24 v13, 147456, v13
    v_add_u32 v210, v205, v13
    s_add_u32 s64, s57, 4
    s_sub_u32 s65, s64, 9
    s_min_u32 s64, s64, s65
    s_lshl_b32 s93, s64, 10
    s_lshl_b32 s64, s64, 6
    v_add_u32 v12, s64, v1
    v_mul_u32_u24 v13, 3641, v12
    v_lshrrev_b32 v13, 16, v13
    v_mul_u32_u24 v14, 18, v13
    v_sub_u32 v12, v12, v14
    v_lshlrev_b32 v12, 4, v12
    v_mul_u32_u24 v201, 9216, v13
    v_add_u32 v201, v201, v12
    v_mul_u32_u24 v206, 1152, v13
    v_add_u32 v206, v206, v12
    v_lshrrev_b32 v13, 4, v13
    v_mul_u32_u24 v13, 147456, v13
    v_add_u32 v211, v206, v13
    s_add_u32 s64, s57, 8
    s_sub_u32 s65, s64, 9
    s_min_u32 s64, s64, s65
    s_lshl_b32 s94, s64, 10
    s_lshl_b32 s64, s64, 6
    v_add_u32 v12, s64, v1
    v_mul_u32_u24 v13, 3641, v12
    v_lshrrev_b32 v13, 16, v13
    v_mul_u32_u24 v14, 18, v13
    v_sub_u32 v12, v12, v14
    v_lshlrev_b32 v12, 4, v12
    v_mul_u32_u24 v202, 9216, v13
    v_add_u32 v202, v202, v12
    v_mul_u32_u24 v207, 1152, v13
    v_add_u32 v207, v207, v12
    v_lshrrev_b32 v13, 4, v13
    v_mul_u32_u24 v13, 147456, v13
    v_add_u32 v212, v207, v13
    s_add_u32 s64, s57, 12
    s_sub_u32 s65, s64, 9
    s_min_u32 s64, s64, s65
    s_lshl_b32 s95, s64, 10
    s_lshl_b32 s64, s64, 6
    v_add_u32 v12, s64, v1
    v_mul_u32_u24 v13, 3641, v12
    v_lshrrev_b32 v13, 16, v13
    v_mul_u32_u24 v14, 18, v13
    v_sub_u32 v12, v12, v14
    v_lshlrev_b32 v12, 4, v12
    v_mul_u32_u24 v203, 9216, v13
    v_add_u32 v203, v203, v12
    v_mul_u32_u24 v208, 1152, v13
    v_add_u32 v208, v208, v12
    v_lshrrev_b32 v13, 4, v13
    v_mul_u32_u24 v13, 147456, v13
    v_add_u32 v213, v208, v13
    s_add_u32 s64, s57, 16
    s_sub_u32 s65, s64, 9
    s_min_u32 s64, s64, s65
    s_lshl_b32 s96, s64, 10
    s_lshl_b32 s64, s64, 6
    v_add_u32 v12, s64, v1
    v_mul_u32_u24 v13, 3641, v12
    v_lshrrev_b32 v13, 16, v13
    v_mul_u32_u24 v14, 18, v13
    v_sub_u32 v12, v12, v14
    v_lshlrev_b32 v12, 4, v12
    v_mul_u32_u24 v204, 9216, v13
    v_add_u32 v204, v204, v12
    v_mul_u32_u24 v209, 1152, v13
    v_add_u32 v209, v209, v12
    v_lshrrev_b32 v13, 4, v13
    v_mul_u32_u24 v13, 147456, v13
    v_add_u32 v214, v209, v13
    s_lshl_b32 s69, s63, 2
    s_and_b32 s64, s63, 2
    s_add_u32 s69, s69, s64
    s_lshl_b32 s64, s58, 2
    s_add_u32 s64, s64, s63
    s_mul_i32 s70, s64, 288
    s_mul_i32 s64, s58, 663552
    s_mul_i32 s65, s63, 288
    s_add_u32 s101, s64, s65
    s_xor_b32 s64, s63, 0
    s_mul_i32 s64, s64, 165888
    s_add_u32 s97, s64, s101
    s_xor_b32 s64, s63, 1
    s_mul_i32 s64, s64, 165888
    s_add_u32 s98, s64, s101
    s_xor_b32 s64, s63, 2
    s_mul_i32 s64, s64, 165888
    s_add_u32 s99, s64, s101
    s_xor_b32 s64, s63, 3
    s_mul_i32 s64, s64, 165888
    s_add_u32 s100, s64, s101
    v_and_b32 v12, 3, v1
    v_lshlrev_b32 v12, 7, v12
    s_cmp_lt_u32 s59, 18
    s_nop 0
    s_cbranch_scc1 Learly_66
    s_cmp_eq_u32 s62, 6
    s_cbranch_scc1 Lq_69
    s_cmp_eq_u32 s62, 7
    s_cbranch_scc1 Lq_70
    s_add_u32 s73, s69, 0
    s_sub_u32 s65, s73, 18
    s_min_u32 s73, s73, s65
    s_mul_i32 s73, s73, 294912
    s_add_u32 s73, s73, s70
    s_add_u32 s74, s73, 294912
    s_cmp_ge_u32 s57, 2
    s_cbranch_scc1 Lx_72
    s_add_u32 m0, s96, 9216
    s_nop 0
    buffer_load_dwordx4 v204, s[32:35], s74 offen nt lds
Lx_72:
    s_add_u32 m0, s92, 0
    s_nop 0
    buffer_load_dwordx4 v200, s[32:35], s73 offen nt lds
    s_add_u32 m0, s93, 0
    s_nop 0
    buffer_load_dwordx4 v201, s[32:35], s73 offen nt lds
    s_mov_b32 s64, 9216
    s_cmp_eq_u32 s57, 0
    s_cselect_b32 s64, 0, s64
    s_cselect_b32 s66, s73, s74
    s_add_u32 m0, s94, s64
    s_nop 0
    buffer_load_dwordx4 v202, s[32:35], s66 offen nt lds
    s_add_u32 m0, s95, 9216
    s_nop 0
    buffer_load_dwordx4 v203, s[32:35], s74 offen nt lds
    s_add_u32 s73, s69, 2
    s_sub_u32 s65, s73, 18
    s_min_u32 s73, s73, s65
    s_mul_i32 s73, s73, 294912
    s_add_u32 s73, s73, s70
    s_add_u32 s74, s73, 294912
    s_cmp_ge_u32 s57, 2
    s_cbranch_scc1 Lx_73
    s_add_u32 m0, s96, 27648
    s_nop 0
    buffer_load_dwordx4 v204, s[32:35], s74 offen nt lds
Lx_73:
    s_add_u32 m0, s92, 18432
    s_nop 0
    buffer_load_dwordx4 v200, s[32:35], s73 offen nt lds
    s_add_u32 m0, s93, 18432
    s_nop 0
    buffer_load_dwordx4 v201, s[32:35], s73 offen nt lds
    s_mov_b32 s64, 27648
    s_cmp_eq_u32 s57, 0
    s_cselect_b32 s64, 18432, s64
    s_cselect_b32 s66, s73, s74
    s_add_u32 m0, s94, s64
    s_nop 0
    buffer_load_dwordx4 v202, s[32:35], s66 offen nt lds
    s_add_u32 m0, s95, 27648
    s_nop 0
    buffer_load_dwordx4 v203, s[32:35], s74 offen nt lds
    s_add_u32 s73, s69, 4
    s_sub_u32 s65, s73, 18
    s_min_u32 s73, s73, s65
    s_mul_i32 s73, s73, 294912
    s_add_u32 s73, s73, s70
    s_add_u32 s74, s73, 294912
    s_cmp_ge_u32 s57, 2
    s_cbranch_scc1 Lx_74
    s_add_u32 m0, s96, 46080
    s_nop 0
    buffer_load_dwordx4 v204, s[32:35], s74 offen nt lds
Lx_74:
    s_add_u32 m0, s92, 36864
    s_nop 0
    buffer_load_dwordx4 v200, s[32:35], s73 offen nt lds
    s_add_u32 m0, s93, 36864
    s_nop 0
    buffer_load_dwordx4 v201, s[32:35], s73 offen nt lds
    s_mov_b32 s64, 46080
    s_cmp_eq_u32 s57, 0
    s_cselect_b32 s64, 36864, s64
    s_cselect_b32 s66, s73, s74
    s_add_u32 m0, s94, s64
    s_nop 0
    buffer_load_dwordx4 v202, s[32:35], s66 offen nt lds
    s_add_u32 m0, s95, 46080
    s_nop 0
    buffer_load_dwordx4 v203, s[32:35], s74 offen nt lds
    s_add_u32 m0, s50, 0
    v_mov_b32 v0, 44
    s_mov_b64 exec, 1
    global_load_lds_dword v0, s[48:49]
    s_mov_b64 exec, -1
    s_add_u32 s73, s69, 6
    s_sub_u32 s65, s73, 18
    s_min_u32 s73, s73, s65
    s_mul_i32 s73, s73, 294912
    s_add_u32 s73, s73, s70
    s_add_u32 s74, s73, 294912
    s_cmp_ge_u32 s57, 2
    s_cbranch_scc1 Lx_75
    s_add_u32 m0, s96, 64512
    s_nop 0
    buffer_load_dwordx4 v204, s[32:35], s74 offen  lds
Lx_75:
    s_add_u32 m0, s92, 55296
    s_nop 0
    buffer_load_dwordx4 v200, s[32:35], s73 offen  lds
    s_add_u32 m0, s93, 55296
    s_nop 0
    buffer_load_dwordx4 v201, s[32:35], s73 offen  lds
    s_mov_b32 s64, 64512
    s_cmp_eq_u32 s57, 0
    s_cselect_b32 s64, 55296, s64
    s_cselect_b32 s66, s73, s74
    s_add_u32 m0, s94, s64
    s_nop 0
    buffer_load_dwordx4 v202, s[32:35], s66 offen  lds
    s_add_u32 m0, s95, 64512
    s_nop 0
    buffer_load_dwordx4 v203, s[32:35], s74 offen  lds
    s_add_u32 s73, s69, 8
    s_sub_u32 s65, s73, 18
    s_min_u32 s73, s73, s65
    s_mul_i32 s73, s73, 294912
    s_add_u32 s73, s73, s70
    s_add_u32 s74, s73, 294912
    s_cmp_ge_u32 s57, 2
    s_cbranch_scc1 Lx_76
    s_add_u32 m0, s96, 82944
    s_nop 0
    buffer_load_dwordx4 v204, s[32:35], s74 offen  lds
Lx_76:
    s_add_u32 m0, s92, 73728
    s_nop 0
    buffer_load_dwordx4 v200, s[32:35], s73 offen  lds
    s_add_u32 m0, s93, 73728
    s_nop 0
    buffer_load_dwordx4 v201, s[32:35], s73 offen  lds
    s_mov_b32 s64, 82944
    s_cmp_eq_u32 s57, 0
    s_cselect_b32 s64, 73728, s64
    s_cselect_b32 s66, s73, s74
    s_add_u32 m0, s94, s64
    s_nop 0
    buffer_load_dwordx4 v202, s[32:35], s66 offen  lds
    s_add_u32 m0, s95, 82944
    s_nop 0
    buffer_load_dwordx4 v203, s[32:35], s74 offen  lds
    s_add_u32 s73, s69, 10
    s_sub_u32 s65, s73, 18
    s_min_u32 s73, s73, s65
    s_mul_i32 s73, s73, 294912
    s_add_u32 s73, s73, s70
    s_add_u32 s74, s73, 294912
    s_cmp_ge_u32 s57, 2
    s_cbranch_scc1 Lx_77
    s_add_u32 m0, s96, 101376
    s_nop 0
    buffer_load_dwordx4 v204, s[32:35], s74 offen  lds
Lx_77:
    s_add_u32 m0, s92, 92160
    s_nop 0
    buffer_load_dwordx4 v200, s[32:35], s73 offen  lds
    s_add_u32 m0, s93, 92160
    s_nop 0
    buffer_load_dwordx4 v201, s[32:35], s73 offen  lds
    s_mov_b32 s64, 101376
    s_cmp_eq_u32 s57, 0
    s_cselect_b32 s64, 92160, s64
    s_cselect_b32 s66, s73, s74
    s_add_u32 m0, s94, s64
    s_nop 0
    buffer_load_dwordx4 v202, s[32:35], s66 offen  lds
    s_add_u32 m0, s95, 101376
    s_nop 0
    buffer_load_dwordx4 v203, s[32:35], s74 offen  lds
    s_add_u32 s73, s69, 12
    s_sub_u32 s65, s73, 18
    s_min_u32 s73, s73, s65
    s_mul_i32 s73, s73, 294912
    s_add_u32 s73, s73, s70
    s_add_u32 s74, s73, 294912
    s_cmp_ge_u32 s57, 2
    s_cbranch_scc1 Lx_78
    s_add_u32 m0, s96, 119808
    s_nop 0
    buffer_load_dwordx4 v204, s[32:35], s74 offen  lds
Lx_78:
    s_add_u32 m0, s92, 110592
    s_nop 0
    buffer_load_dwordx4 v200, s[32:35], s73 offen  lds
    s_add_u32 m0, s93, 110592
    s_nop 0
    buffer_load_dwordx4 v201, s[32:35], s73 offen  lds
    s_mov_b32 s64, 119808
    s_cmp_eq_u32 s57, 0
    s_cselect_b32 s64, 110592, s64
    s_cselect_b32 s66, s73, s74
    s_add_u32 m0, s94, s64
    s_nop 0
    buffer_load_dwordx4 v202, s[32:35], s66 offen  lds
    s_add_u32 m0, s95, 119808
    s_nop 0
    buffer_load_dwordx4 v203, s[32:35], s74 offen  lds
    s_add_u32 s73, s69, 14
    s_sub_u32 s65, s73, 18
    s_min_u32 s73, s73, s65
    s_mul_i32 s73, s73, 294912
    s_add_u32 s73, s73, s70
    s_add_u32 s74, s73, 294912
    s_cmp_ge_u32 s57, 2
    s_cbranch_scc1 Lx_79
    s_add_u32 m0, s96, 138240
    s_nop 0
    buffer_load_dwordx4 v204, s[32:35], s74 offen  lds
Lx_79:
    s_add_u32 m0, s92, 129024
    s_nop 0
    buffer_load_dwordx4 v200, s[32:35], s73 offen  lds
    s_add_u32 m0, s93, 129024
    s_nop 0
    buffer_load_dwordx4 v201, s[32:35], s73 offen  lds
    s_mov_b32 s64, 138240
    s_cmp_eq_u32 s57, 0
    s_cselect_b32 s64, 129024, s64
    s_cselect_b32 s66, s73, s74
    s_add_u32 m0, s94, s64
    s_nop 0
    buffer_load_dwordx4 v202, s[32:35], s66 offen  lds
    s_add_u32 m0, s95, 138240
    s_nop 0
    buffer_load_dwordx4 v203, s[32:35], s74 offen  lds
    s_branch Lq_71
Lq_69:
    s_add_u32 s73, s69, 6
    s_sub_u32 s65, s73, 18
    s_min_u32 s73, s73, s65
    s_mul_i32 s73, s73, 294912
    s_add_u32 s73, s73, s70
    s_add_u32 s74, s73, 294912
    s_cmp_ge_u32 s57, 2
    s_cbranch_scc1 Lx_80
    s_add_u32 m0, s96, 64512
    s_nop 0
    buffer_load_dwordx4 v204, s[32:35], s74 offen nt lds
Lx_80:
    s_add_u32 m0, s92, 55296
    s_nop 0
    buffer_load_dwordx4 v200, s[32:35], s73 offen nt lds
    s_add_u32 m0, s93, 55296
    s_nop 0
    buffer_load_dwordx4 v201, s[32:35], s73 offen nt lds
    s_mov_b32 s64, 64512
    s_cmp_eq_u32 s57, 0
    s_cselect_b32 s64, 55296, s64
    s_cselect_b32 s66, s73, s74
    s_add_u32 m0, s94, s64
    s_nop 0
    buffer_load_dwordx4 v202, s[32:35], s66 offen nt lds
    s_add_u32 m0, s95, 64512
    s_nop 0
    buffer_load_dwordx4 v203, s[32:35], s74 offen nt lds
    s_add_u32 s73, s69, 8
    s_sub_u32 s65, s73, 18
    s_min_u32 s73, s73, s65
    s_mul_i32 s73, s73, 294912
    s_add_u32 s73, s73, s70
    s_add_u32 s74, s73, 294912
    s_cmp_ge_u32 s57, 2
    s_cbranch_scc1 Lx_81
    s_add_u32 m0, s96, 82944
    s_nop 0
    buffer_load_dwordx4 v204, s[32:35], s74 offen nt lds
Lx_81:
    s_add_u32 m0, s92, 73728
    s_nop 0
    buffer_load_dwordx4 v200, s[32:35], s73 offen nt lds
    s_add_u32 m0, s93, 73728
    s_nop 0
    buffer_load_dwordx4 v201, s[32:35], s73 offen nt lds
    s_mov_b32 s64, 82944
    s_cmp_eq_u32 s57, 0
    s_cselect_b32 s64, 73728, s64
    s_cselect_b32 s66, s73, s74
    s_add_u32 m0, s94, s64
    s_nop 0
    buffer_load_dwordx4 v202, s[32:35], s66 offen nt lds
    s_add_u32 m0, s95, 82944
    s_nop 0
    buffer_load_dwordx4 v203, s[32:35], s74 offen nt lds
    s_add_u32 s73, s69, 10
    s_sub_u32 s65, s73, 18
    s_min_u32 s73, s73, s65
    s_mul_i32 s73, s73, 294912
    s_add_u32 s73, s73, s70
    s_add_u32 s74, s73, 294912
    s_cmp_ge_u32 s57, 2
    s_cbranch_scc1 Lx_82
    s_add_u32 m0, s96, 101376
    s_nop 0
    buffer_load_dwordx4 v204, s[32:35], s74 offen nt lds
Lx_82:
    s_add_u32 m0, s92, 92160
    s_nop 0
    buffer_load_dwordx4 v200, s[32:35], s73 offen nt lds
    s_add_u32 m0, s93, 92160
    s_nop 0
    buffer_load_dwordx4 v201, s[32:35], s73 offen nt lds
    s_mov_b32 s64, 101376
    s_cmp_eq_u32 s57, 0
    s_cselect_b32 s64, 92160, s64
    s_cselect_b32 s66, s73, s74
    s_add_u32 m0, s94, s64
    s_nop 0
    buffer_load_dwordx4 v202, s[32:35], s66 offen nt lds
    s_add_u32 m0, s95, 101376
    s_nop 0
    buffer_load_dwordx4 v203, s[32:35], s74 offen nt lds
    s_add_u32 m0, s50, 0
    v_mov_b32 v0, 44
    s_mov_b64 exec, 1
    global_load_lds_dword v0, s[48:49]
    s_mov_b64 exec, -1
    s_add_u32 s73, s69, 0
    s_sub_u32 s65, s73, 18
    s_min_u32 s73, s73, s65
    s_mul_i32 s73, s73, 294912
    s_add_u32 s73, s73, s70
    s_add_u32 s74, s73, 294912
    s_cmp_ge_u32 s57, 2
    s_cbranch_scc1 Lx_83
    s_add_u32 m0, s96, 9216
    s_nop 0
    buffer_load_dwordx4 v204, s[32:35], s74 offen  lds
Lx_83:
    s_add_u32 m0, s92, 0
    s_nop 0
    buffer_load_dwordx4 v200, s[32:35], s73 offen  lds
    s_add_u32 m0, s93, 0
    s_nop 0
    buffer_load_dwordx4 v201, s[32:35], s73 offen  lds
    s_mov_b32 s64, 9216
    s_cmp_eq_u32 s57, 0
    s_cselect_b32 s64, 0, s64
    s_cselect_b32 s66, s73, s74
    s_add_u32 m0, s94, s64
    s_nop 0
    buffer_load_dwordx4 v202, s[32:35], s66 offen  lds
    s_add_u32 m0, s95, 9216
    s_nop 0
    buffer_load_dwordx4 v203, s[32:35], s74 offen  lds
    s_add_u32 s73, s69, 2
    s_sub_u32 s65, s73, 18
    s_min_u32 s73, s73, s65
    s_mul_i32 s73, s73, 294912
    s_add_u32 s73, s73, s70
    s_add_u32 s74, s73, 294912
    s_cmp_ge_u32 s57, 2
    s_cbranch_scc1 Lx_84
    s_add_u32 m0, s96, 27648
    s_nop 0
    buffer_load_dwordx4 v204, s[32:35], s74 offen  lds
Lx_84:
    s_add_u32 m0, s92, 18432
    s_nop 0
    buffer_load_dwordx4 v200, s[32:35], s73 offen  lds
    s_add_u32 m0, s93, 18432
    s_nop 0
    buffer_load_dwordx4 v201, s[32:35], s73 offen  lds
    s_mov_b32 s64, 27648
    s_cmp_eq_u32 s57, 0
    s_cselect_b32 s64, 18432, s64
    s_cselect_b32 s66, s73, s74
    s_add_u32 m0, s94, s64
    s_nop 0
    buffer_load_dwordx4 v202, s[32:35], s66 offen  lds
    s_add_u32 m0, s95, 27648
    s_nop 0
    buffer_load_dwordx4 v203, s[32:35], s74 offen  lds
    s_add_u32 s73, s69, 4
    s_sub_u32 s65, s73, 18
    s_min_u32 s73, s73, s65
    s_mul_i32 s73, s73, 294912
    s_add_u32 s73, s73, s70
    s_add_u32 s74, s73, 294912
    s_cmp_ge_u32 s57, 2
    s_cbranch_scc1 Lx_85
    s_add_u32 m0, s96, 46080
    s_nop 0
    buffer_load_dwordx4 v204, s[32:35], s74 offen  lds
Lx_85:
    s_add_u32 m0, s92, 36864
    s_nop 0
    buffer_load_dwordx4 v200, s[32:35], s73 offen  lds
    s_add_u32 m0, s93, 36864
    s_nop 0
    buffer_load_dwordx4 v201, s[32:35], s73 offen  lds
    s_mov_b32 s64, 46080
    s_cmp_eq_u32 s57, 0
    s_cselect_b32 s64, 36864, s64
    s_cselect_b32 s66, s73, s74
    s_add_u32 m0, s94, s64
    s_nop 0
    buffer_load_dwordx4 v202, s[32:35], s66 offen  lds
    s_add_u32 m0, s95, 46080
    s_nop 0
    buffer_load_dwordx4 v203, s[32:35], s74 offen  lds
    s_add_u32 s73, s69, 12
    s_sub_u32 s65, s73, 18
    s_min_u32 s73, s73, s65
    s_mul_i32 s73, s73, 294912
    s_add_u32 s73, s73, s70
    s_add_u32 s74, s73, 294912
    s_cmp_ge_u32 s57, 2
    s_cbranch_scc1 Lx_86
    s_add_u32 m0, s96, 119808
    s_nop 0
    buffer_load_dwordx4 v204, s[32:35], s74 offen  lds
Lx_86:
    s_add_u32 m0, s92, 110592
    s_nop 0
    buffer_load_dwordx4 v200, s[32:35], s73 offen  lds
    s_add_u32 m0, s93, 110592
    s_nop 0
    buffer_load_dwordx4 v201, s[32:35], s73 offen  lds
    s_mov_b32 s64, 119808
    s_cmp_eq_u32 s57, 0
    s_cselect_b32 s64, 110592, s64
    s_cselect_b32 s66, s73, s74
    s_add_u32 m0, s94, s64
    s_nop 0
    buffer_load_dwordx4 v202, s[32:35], s66 offen  lds
    s_add_u32 m0, s95, 119808
    s_nop 0
    buffer_load_dwordx4 v203, s[32:35], s74 offen  lds
    s_add_u32 s73, s69, 14
    s_sub_u32 s65, s73, 18
    s_min_u32 s73, s73, s65
    s_mul_i32 s73, s73, 294912
    s_add_u32 s73, s73, s70
    s_add_u32 s74, s73, 294912
    s_cmp_ge_u32 s57, 2
    s_cbranch_scc1 Lx_87
    s_add_u32 m0, s96, 138240
    s_nop 0
    buffer_load_dwordx4 v204, s[32:35], s74 offen  lds
Lx_87:
    s_add_u32 m0, s92, 129024
    s_nop 0
    buffer_load_dwordx4 v200, s[32:35], s73 offen  lds
    s_add_u32 m0, s93, 129024
    s_nop 0
    buffer_load_dwordx4 v201, s[32:35], s73 offen  lds
    s_mov_b32 s64, 138240
    s_cmp_eq_u32 s57, 0
    s_cselect_b32 s64, 129024, s64
    s_cselect_b32 s66, s73, s74
    s_add_u32 m0, s94, s64
    s_nop 0
    buffer_load_dwordx4 v202, s[32:35], s66 offen  lds
    s_add_u32 m0, s95, 138240
    s_nop 0
    buffer_load_dwordx4 v203, s[32:35], s74 offen  lds
    s_branch Lq_71
Lq_70:
    s_add_u32 s73, s69, 12
    s_sub_u32 s65, s73, 18
    s_min_u32 s73, s73, s65
    s_mul_i32 s73, s73, 294912
    s_add_u32 s73, s73, s70
    s_add_u32 s74, s73, 294912
    s_cmp_ge_u32 s57, 2
    s_cbranch_scc1 Lx_88
    s_add_u32 m0, s96, 119808
    s_nop 0
    buffer_load_dwordx4 v204, s[32:35], s74 offen nt lds
Lx_88:
    s_add_u32 m0, s92, 110592
    s_nop 0
    buffer_load_dwordx4 v200, s[32:35], s73 offen nt lds
    s_add_u32 m0, s93, 110592
    s_nop 0
    buffer_load_dwordx4 v201, s[32:35], s73 offen nt lds
    s_mov_b32 s64, 119808
    s_cmp_eq_u32 s57, 0
    s_cselect_b32 s64, 110592, s64
    s_cselect_b32 s66, s73, s74
    s_add_u32 m0, s94, s64
    s_nop 0
    buffer_load_dwordx4 v202, s[32:35], s66 offen nt lds
    s_add_u32 m0, s95, 119808
    s_nop 0
    buffer_load_dwordx4 v203, s[32:35], s74 offen nt lds
    s_add_u32 s73, s69, 14
    s_sub_u32 s65, s73, 18
    s_min_u32 s73, s73, s65
    s_mul_i32 s73, s73, 294912
    s_add_u32 s73, s73, s70
    s_add_u32 s74, s73, 294912
    s_cmp_ge_u32 s57, 2
    s_cbranch_scc1 Lx_89
    s_add_u32 m0, s96, 138240
    s_nop 0
    buffer_load_dwordx4 v204, s[32:35], s74 offen nt lds
Lx_89:
    s_add_u32 m0, s92, 129024
    s_nop 0
    buffer_load_dwordx4 v200, s[32:35], s73 offen nt lds
    s_add_u32 m0, s93, 129024
    s_nop 0
    buffer_load_dwordx4 v201, s[32:35], s73 offen nt lds
    s_mov_b32 s64, 138240
    s_cmp_eq_u32 s57, 0
    s_cselect_b32 s64, 129024, s64
    s_cselect_b32 s66, s73, s74
    s_add_u32 m0, s94, s64
    s_nop 0
    buffer_load_dwordx4 v202, s[32:35], s66 offen nt lds
    s_add_u32 m0, s95, 138240
    s_nop 0
    buffer_load_dwordx4 v203, s[32:35], s74 offen nt lds
    s_add_u32 s73, s69, 16
    s_sub_u32 s65, s73, 18
    s_min_u32 s73, s73, s65
    s_mul_i32 s73, s73, 294912
    s_add_u32 s73, s73, s70
    s_add_u32 s74, s73, 294912
    s_cmp_ge_u32 s57, 2
    s_cbranch_scc1 Lx_90
    s_add_u32 m0, s96, 0
    s_nop 0
    buffer_load_dwordx4 v204, s[32:35], s74 offen nt lds
Lx_90:
    s_add_u32 m0, s92, 147456
    s_nop 0
    buffer_load_dwordx4 v200, s[32:35], s73 offen nt lds
    s_add_u32 m0, s93, 147456
    s_nop 0
    buffer_load_dwordx4 v201, s[32:35], s73 offen nt lds
    s_mov_b32 s64, 0
    s_cmp_eq_u32 s57, 0
    s_cselect_b32 s64, 147456, s64
    s_cselect_b32 s66, s73, s74
    s_add_u32 m0, s94, s64
    s_nop 0
    buffer_load_dwordx4 v202, s[32:35], s66 offen nt lds
    s_add_u32 m0, s95, 0
    s_nop 0
    buffer_load_dwordx4 v203, s[32:35], s74 offen nt lds
    s_add_u32 m0, s50, 0
    v_mov_b32 v0, 44
    s_mov_b64 exec, 1
    global_load_lds_dword v0, s[48:49]
    s_mov_b64 exec, -1
    s_add_u32 s73, s69, 2
    s_sub_u32 s65, s73, 18
    s_min_u32 s73, s73, s65
    s_mul_i32 s73, s73, 294912
    s_add_u32 s73, s73, s70
    s_add_u32 s74, s73, 294912
    s_cmp_ge_u32 s57, 2
    s_cbranch_scc1 Lx_91
    s_add_u32 m0, s96, 27648
    s_nop 0
    buffer_load_dwordx4 v204, s[32:35], s74 offen  lds
Lx_91:
    s_add_u32 m0, s92, 18432
    s_nop 0
    buffer_load_dwordx4 v200, s[32:35], s73 offen  lds
    s_add_u32 m0, s93, 18432
    s_nop 0
    buffer_load_dwordx4 v201, s[32:35], s73 offen  lds
    s_mov_b32 s64, 27648
    s_cmp_eq_u32 s57, 0
    s_cselect_b32 s64, 18432, s64
    s_cselect_b32 s66, s73, s74
    s_add_u32 m0, s94, s64
    s_nop 0
    buffer_load_dwordx4 v202, s[32:35], s66 offen  lds
    s_add_u32 m0, s95, 27648
    s_nop 0
    buffer_load_dwordx4 v203, s[32:35], s74 offen  lds
    s_add_u32 s73, s69, 4
    s_sub_u32 s65, s73, 18
    s_min_u32 s73, s73, s65
    s_mul_i32 s73, s73, 294912
    s_add_u32 s73, s73, s70
    s_add_u32 s74, s73, 294912
    s_cmp_ge_u32 s57, 2
    s_cbranch_scc1 Lx_92
    s_add_u32 m0, s96, 46080
    s_nop 0
    buffer_load_dwordx4 v204, s[32:35], s74 offen  lds
Lx_92:
    s_add_u32 m0, s92, 36864
    s_nop 0
    buffer_load_dwordx4 v200, s[32:35], s73 offen  lds
    s_add_u32 m0, s93, 36864
    s_nop 0
    buffer_load_dwordx4 v201, s[32:35], s73 offen  lds
    s_mov_b32 s64, 46080
    s_cmp_eq_u32 s57, 0
    s_cselect_b32 s64, 36864, s64
    s_cselect_b32 s66, s73, s74
    s_add_u32 m0, s94, s64
    s_nop 0
    buffer_load_dwordx4 v202, s[32:35], s66 offen  lds
    s_add_u32 m0, s95, 46080
    s_nop 0
    buffer_load_dwordx4 v203, s[32:35], s74 offen  lds
    s_add_u32 s73, s69, 6
    s_sub_u32 s65, s73, 18
    s_min_u32 s73, s73, s65
    s_mul_i32 s73, s73, 294912
    s_add_u32 s73, s73, s70
    s_add_u32 s74, s73, 294912
    s_cmp_ge_u32 s57, 2
    s_cbranch_scc1 Lx_93
    s_add_u32 m0, s96, 64512
    s_nop 0
    buffer_load_dwordx4 v204, s[32:35], s74 offen  lds
Lx_93:
    s_add_u32 m0, s92, 55296
    s_nop 0
    buffer_load_dwordx4 v200, s[32:35], s73 offen  lds
    s_add_u32 m0, s93, 55296
    s_nop 0
    buffer_load_dwordx4 v201, s[32:35], s73 offen  lds
    s_mov_b32 s64, 64512
    s_cmp_eq_u32 s57, 0
    s_cselect_b32 s64, 55296, s64
    s_cselect_b32 s66, s73, s74
    s_add_u32 m0, s94, s64
    s_nop 0
    buffer_load_dwordx4 v202, s[32:35], s66 offen  lds
    s_add_u32 m0, s95, 64512
    s_nop 0
    buffer_load_dwordx4 v203, s[32:35], s74 offen  lds
    s_add_u32 s73, s69, 8
    s_sub_u32 s65, s73, 18
    s_min_u32 s73, s73, s65
    s_mul_i32 s73, s73, 294912
    s_add_u32 s73, s73, s70
    s_add_u32 s74, s73, 294912
    s_cmp_ge_u32 s57, 2
    s_cbranch_scc1 Lx_94
    s_add_u32 m0, s96, 82944
    s_nop 0
    buffer_load_dwordx4 v204, s[32:35], s74 offen  lds
Lx_94:
    s_add_u32 m0, s92, 73728
    s_nop 0
    buffer_load_dwordx4 v200, s[32:35], s73 offen  lds
    s_add_u32 m0, s93, 73728
    s_nop 0
    buffer_load_dwordx4 v201, s[32:35], s73 offen  lds
    s_mov_b32 s64, 82944
    s_cmp_eq_u32 s57, 0
    s_cselect_b32 s64, 73728, s64
    s_cselect_b32 s66, s73, s74
    s_add_u32 m0, s94, s64
    s_nop 0
    buffer_load_dwordx4 v202, s[32:35], s66 offen  lds
    s_add_u32 m0, s95, 82944
    s_nop 0
    buffer_load_dwordx4 v203, s[32:35], s74 offen  lds
    s_add_u32 s73, s69, 10
    s_sub_u32 s65, s73, 18
    s_min_u32 s73, s73, s65
    s_mul_i32 s73, s73, 294912
    s_add_u32 s73, s73, s70
    s_add_u32 s74, s73, 294912
    s_cmp_ge_u32 s57, 2
    s_cbranch_scc1 Lx_95
    s_add_u32 m0, s96, 101376
    s_nop 0
    buffer_load_dwordx4 v204, s[32:35], s74 offen  lds
Lx_95:
    s_add_u32 m0, s92, 92160
    s_nop 0
    buffer_load_dwordx4 v200, s[32:35], s73 offen  lds
    s_add_u32 m0, s93, 92160
    s_nop 0
    buffer_load_dwordx4 v201, s[32:35], s73 offen  lds
    s_mov_b32 s64, 101376
    s_cmp_eq_u32 s57, 0
    s_cselect_b32 s64, 92160, s64
    s_cselect_b32 s66, s73, s74
    s_add_u32 m0, s94, s64
    s_nop 0
    buffer_load_dwordx4 v202, s[32:35], s66 offen  lds
    s_add_u32 m0, s95, 101376
    s_nop 0
    buffer_load_dwordx4 v203, s[32:35], s74 offen  lds
    s_mov_b32 s89, 0
    s_branch Lw_97
Lw_96:
    s_sleep 2
Lw_97:
    ds_read_b128 v[12:15], v11 offset:0
    s_add_u32 s89, s89, 1
    s_cmp_gt_u32 s89, 1000000
    s_cbranch_scc1 L_end
    s_waitcnt lgkmcnt(0)
    v_min_u32 v12, v12, v13
    v_min3_u32 v12, v12, v14, v15
    s_nop 0
    v_readfirstlane_b32 s64, v12
    s_nop 0
    s_cmp_lt_u32 s64, 10
    s_nop 1
    s_cbranch_scc1 Lw_96
    s_add_u32 s73, s69, 0
    s_sub_u32 s65, s73, 18
    s_min_u32 s73, s73, s65
    s_mul_i32 s73, s73, 294912
    s_add_u32 s73, s73, s70
    s_add_u32 s74, s73, 294912
    s_cmp_ge_u32 s57, 2
    s_cbranch_scc1 Lx_98
    s_add_u32 m0, s96, 9216
    s_nop 0
    buffer_load_dwordx4 v204, s[32:35], s74 offen  lds
Lx_98:
    s_add_u32 m0, s92, 0
    s_nop 0
    buffer_load_dwordx4 v200, s[32:35], s73 offen  lds
    s_add_u32 m0, s93, 0
    s_nop 0
    buffer_load_dwordx4 v201, s[32:35], s73 offen  lds
    s_mov_b32 s64, 9216
    s_cmp_eq_u32 s57, 0
    s_cselect_b32 s64, 0, s64
    s_cselect_b32 s66, s73, s74
    s_add_u32 m0, s94, s64
    s_nop 0
    buffer_load_dwordx4 v202, s[32:35], s66 offen  lds
    s_add_u32 m0, s95, 9216
    s_nop 0
    buffer_load_dwordx4 v203, s[32:35], s74 offen  lds
Lq_71:
    s_add_u32 m0, s50, 0
    v_mov_b32 v0, 48
    s_mov_b64 exec, 1
    global_load_lds_dword v0, s[48:49]
    s_mov_b64 exec, -1
    s_sub_u32 s64, s59, 18
    s_lshl_b32 s64, s64, 2
    s_add_u32 s64, s64, s57
    s_mul_i32 s64, s64, 11904
    s_min_u32 s64, s64, 651648
    s_mul_i32 s65, s58, 663552
    s_add_u32 s66, s64, s65
    v_lshlrev_b32 v12, 7, v1
    v_min_u32 v13, 3584, v12
    buffer_load_dword v7, v12, s[36:39], s66 offen
    s_add_u32 s66, s66, 8192
    buffer_load_dword v7, v13, s[36:39], s66 offen
    s_branch Learly_67
Learly_66:
    s_mov_b32 s89, 0
    s_branch Lw_100
Lw_99:
    s_sleep 2
Lw_100:
    ds_read_b128 v[12:15], v11 offset:0
    s_add_u32 s89, s89, 1
    s_cmp_gt_u32 s89, 1000000
    s_cbranch_scc1 L_end
    s_waitcnt lgkmcnt(0)
    v_min_u32 v12, v12, v13
    v_min3_u32 v12, v12, v14, v15
    s_nop 0
    v_readfirstlane_b32 s64, v12
    s_nop 0
    s_cmp_lt_u32 s64, 3
    s_nop 1
    s_cbranch_scc1 Lw_99
    s_add_u32 s73, s69, 0
    s_sub_u32 s65, s73, 18
    s_min_u32 s73, s73, s65
    s_mul_i32 s73, s73, 294912
    s_add_u32 s73, s73, s70
    s_add_u32 s74, s73, 294912
    s_cmp_ge_u32 s57, 2
    s_cbranch_scc1 Lx_101
    s_add_u32 m0, s96, 9216
    s_nop 0
    buffer_load_dwordx4 v204, s[32:35], s74 offen  lds
Lx_101:
    s_add_u32 m0, s92, 0
    s_nop 0
    buffer_load_dwordx4 v200, s[32:35], s73 offen  lds
    s_waitcnt vmcnt(1)
    s_add_u32 m0, s93, 0
    s_nop 0
    buffer_load_dwordx4 v201, s[32:35], s73 offen  lds
    s_waitcnt vmcnt(1)
    s_mov_b32 s64, 9216
    s_cmp_eq_u32 s57, 0
    s_cselect_b32 s64, 0, s64
    s_cselect_b32 s66, s73, s74
    s_add_u32 m0, s94, s64
    s_nop 0
    buffer_load_dwordx4 v202, s[32:35], s66 offen  lds
    s_waitcnt vmcnt(1)
    s_add_u32 m0, s95, 9216
    s_nop 0
    buffer_load_dwordx4 v203, s[32:35], s74 offen  lds
    s_waitcnt vmcnt(1)
    s_add_u32 s73, s69, 2
    s_sub_u32 s65, s73, 18
    s_min_u32 s73, s73, s65
    s_mul_i32 s73, s73, 294912
    s_add_u32 s73, s73, s70
    s_add_u32 s74, s73, 294912
    s_cmp_ge_u32 s57, 2
    s_cbranch_scc1 Lx_102
    s_add_u32 m0, s96, 27648
    s_nop 0
    buffer_load_dwordx4 v204, s[32:35], s74 offen  lds
Lx_102:
    s_add_u32 m0, s92, 18432
    s_nop 0
    buffer_load_dwordx4 v200, s[32:35], s73 offen  lds
    s_waitcnt vmcnt(1)
    s_add_u32 m0, s93, 18432
    s_nop 0
    buffer_load_dwordx4 v201, s[32:35], s73 offen  lds
    s_waitcnt vmcnt(1)
    s_mov_b32 s64, 27648
    s_cmp_eq_u32 s57, 0
    s_cselect_b32 s64, 18432, s64
    s_cselect_b32 s66, s73, s74
    s_add_u32 m0, s94, s64
    s_nop 0
    buffer_load_dwordx4 v202, s[32:35], s66 offen  lds
    s_waitcnt vmcnt(1)
    s_add_u32 m0, s95, 27648
    s_nop 0
    buffer_load_dwordx4 v203, s[32:35], s74 offen  lds
    s_waitcnt vmcnt(1)
    s_add_u32 s73, s69, 4
    s_sub_u32 s65, s73, 18
    s_min_u32 s73, s73, s65
    s_mul_i32 s73, s73, 294912
    s_add_u32 s73, s73, s70
    s_add_u32 s74, s73, 294912
    s_cmp_ge_u32 s57, 2
    s_cbranch_scc1 Lx_103
    s_add_u32 m0, s96, 46080
    s_nop 0
    buffer_load_dwordx4 v204, s[32:35], s74 offen  lds
Lx_103:
    s_add_u32 m0, s92, 36864
    s_nop 0
    buffer_load_dwordx4 v200, s[32:35], s73 offen  lds
    s_waitcnt vmcnt(1)
    s_add_u32 m0, s93, 36864
    s_nop 0
    buffer_load_dwordx4 v201, s[32:35], s73 offen  lds
    s_waitcnt vmcnt(1)
    s_mov_b32 s64, 46080
    s_cmp_eq_u32 s57, 0
    s_cselect_b32 s64, 36864, s64
    s_cselect_b32 s66, s73, s74
    s_add_u32 m0, s94, s64
    s_nop 0
    buffer_load_dwordx4 v202, s[32:35], s66 offen  lds
    s_waitcnt vmcnt(1)
    s_add_u32 m0, s95, 46080
    s_nop 0
    buffer_load_dwordx4 v203, s[32:35], s74 offen  lds
    s_waitcnt vmcnt(1)
    s_add_u32 s73, s69, 6
    s_sub_u32 s65, s73, 18
    s_min_u32 s73, s73, s65
    s_mul_i32 s73, s73, 294912
    s_add_u32 s73, s73, s70
    s_add_u32 s74, s73, 294912
    s_cmp_ge_u32 s57, 2
    s_cbranch_scc1 Lx_104
    s_add_u32 m0, s96, 64512
    s_nop 0
    buffer_load_dwordx4 v204, s[32:35], s74 offen  lds
Lx_104:
    s_add_u32 m0, s92, 55296
    s_nop 0
    buffer_load_dwordx4 v200, s[32:35], s73 offen  lds
    s_waitcnt vmcnt(1)
    s_add_u32 m0, s93, 55296
    s_nop 0
    buffer_load_dwordx4 v201, s[32:35], s73 offen  lds
    s_waitcnt vmcnt(1)
    s_mov_b32 s64, 64512
    s_cmp_eq_u32 s57, 0
    s_cselect_b32 s64, 55296, s64
    s_cselect_b32 s66, s73, s74
    s_add_u32 m0, s94, s64
    s_nop 0
    buffer_load_dwordx4 v202, s[32:35], s66 offen  lds
    s_waitcnt vmcnt(1)
    s_add_u32 m0, s95, 64512
    s_nop 0
    buffer_load_dwordx4 v203, s[32:35], s74 offen  lds
    s_waitcnt vmcnt(1)
    s_waitcnt vmcnt(0)
    v_mov_b32 v0, 12
    ds_write_b32 v10, v0
    s_mov_b32 s89, 0
    s_branch Lw_106
Lw_105:
    s_sleep 2
Lw_106:
    ds_read_b128 v[12:15], v11 offset:0
    s_add_u32 s89, s89, 1
    s_cmp_gt_u32 s89, 1000000
    s_cbranch_scc1 L_end
    s_waitcnt lgkmcnt(0)
    v_min_u32 v12, v12, v13
    v_min3_u32 v12, v12, v14, v15
    s_nop 0
    v_readfirstlane_b32 s64, v12
    s_nop 0
    s_cmp_lt_u32 s64, 6
    s_nop 1
    s_cbranch_scc1 Lw_105
    s_add_u32 s73, s69, 8
    s_sub_u32 s65, s73, 18
    s_min_u32 s73, s73, s65
    s_mul_i32 s73, s73, 294912
    s_add_u32 s73, s73, s70
    s_add_u32 s74, s73, 294912
    s_cmp_ge_u32 s57, 2
    s_cbranch_scc1 Lx_107
    s_add_u32 m0, s96, 82944
    s_nop 0
    buffer_load_dwordx4 v204, s[32:35], s74 offen  lds
Lx_107:
    s_add_u32 m0, s92, 73728
    s_nop 0
    buffer_load_dwordx4 v200, s[32:35], s73 offen  lds
    s_waitcnt vmcnt(1)
    s_add_u32 m0, s93, 73728
    s_nop 0
    buffer_load_dwordx4 v201, s[32:35], s73 offen  lds
    s_waitcnt vmcnt(1)
    s_mov_b32 s64, 82944
    s_cmp_eq_u32 s57, 0
    s_cselect_b32 s64, 73728, s64
    s_cselect_b32 s66, s73, s74
    s_add_u32 m0, s94, s64
    s_nop 0
    buffer_load_dwordx4 v202, s[32:35], s66 offen  lds
    s_waitcnt vmcnt(1)
    s_add_u32 m0, s95, 82944
    s_nop 0
    buffer_load_dwordx4 v203, s[32:35], s74 offen  lds
    s_waitcnt vmcnt(1)
    s_add_u32 s73, s69, 10
    s_sub_u32 s65, s73, 18
    s_min_u32 s73, s73, s65
    s_mul_i32 s73, s73, 294912
    s_add_u32 s73, s73, s70
    s_add_u32 s74, s73, 294912
    s_cmp_ge_u32 s57, 2
    s_cbranch_scc1 Lx_108
    s_add_u32 m0, s96, 101376
    s_nop 0
    buffer_load_dwordx4 v204, s[32:35], s74 offen  lds
Lx_108:
    s_add_u32 m0, s92, 92160
    s_nop 0
    buffer_load_dwordx4 v200, s[32:35], s73 offen  lds
    s_waitcnt vmcnt(1)
    s_add_u32 m0, s93, 92160
    s_nop 0
    buffer_load_dwordx4 v201, s[32:35], s73 offen  lds
    s_waitcnt vmcnt(1)
    s_mov_b32 s64, 101376
    s_cmp_eq_u32 s57, 0
    s_cselect_b32 s64, 92160, s64
    s_cselect_b32 s66, s73, s74
    s_add_u32 m0, s94, s64
    s_nop 0
    buffer_load_dwordx4 v202, s[32:35], s66 offen  lds
    s_waitcnt vmcnt(1)
    s_add_u32 m0, s95, 101376
    s_nop 0
    buffer_load_dwordx4 v203, s[32:35], s74 offen  lds
    s_waitcnt vmcnt(1)
Learly_67:
    s_waitcnt vmcnt(0)
    v_mov_b32 v0, 13
    ds_write_b32 v10, v0
    s_mov_b32 s89, 0
    s_branch Lw_110
Lw_109:
    s_sleep 3
Lw_110:
    ds_read_b128 v[12:15], v11 offset:0
    s_add_u32 s89, s89, 1
    s_cmp_gt_u32 s89, 1000000
    s_cbranch_scc1 L_end
    s_waitcnt lgkmcnt(0)
    v_min_u32 v12, v12, v13
    v_min3_u32 v12, v12, v14, v15
    s_nop 0
    v_readfirstlane_b32 s64, v12
    s_nop 0
    s_cmp_lt_u32 s64, 11
    s_nop 1
    s_cbranch_scc1 Lw_109
    s_cmp_ge_u32 s59, 18
    s_cbranch_scc1 Llate_111
    s_add_u32 s73, s69, 12
    s_sub_u32 s65, s73, 18
    s_min_u32 s73, s73, s65
    s_mul_i32 s73, s73, 294912
    s_add_u32 s73, s73, s70
    s_add_u32 s74, s73, 294912
    s_cmp_ge_u32 s57, 2
    s_cbranch_scc1 Lx_112
    s_add_u32 m0, s96, 119808
    s_nop 0
    buffer_load_dwordx4 v204, s[32:35], s74 offen  lds
Lx_112:
    s_add_u32 m0, s92, 110592
    s_nop 0
    buffer_load_dwordx4 v200, s[32:35], s73 offen  lds
    s_add_u32 m0, s93, 110592
    s_nop 0
    buffer_load_dwordx4 v201, s[32:35], s73 offen  lds
    s_mov_b32 s64, 119808
    s_cmp_eq_u32 s57, 0
    s_cselect_b32 s64, 110592, s64
    s_cselect_b32 s66, s73, s74
    s_add_u32 m0, s94, s64
    s_nop 0
    buffer_load_dwordx4 v202, s[32:35], s66 offen  lds
    s_add_u32 m0, s95, 119808
    s_nop 0
    buffer_load_dwordx4 v203, s[32:35], s74 offen  lds
    s_add_u32 s73, s69, 14
    s_sub_u32 s65, s73, 18
    s_min_u32 s73, s73, s65
    s_mul_i32 s73, s73, 294912
    s_add_u32 s73, s73, s70
    s_add_u32 s74, s73, 294912
    s_cmp_ge_u32 s57, 2
    s_cbranch_scc1 Lx_113
    s_add_u32 m0, s96, 138240
    s_nop 0
    buffer_load_dwordx4 v204, s[32:35], s74 offen  lds
Lx_113:
    s_add_u32 m0, s92, 129024
    s_nop 0
    buffer_load_dwordx4 v200, s[32:35], s73 offen  lds
    s_add_u32 m0, s93, 129024
    s_nop 0
    buffer_load_dwordx4 v201, s[32:35], s73 offen  lds
    s_mov_b32 s64, 138240
    s_cmp_eq_u32 s57, 0
    s_cselect_b32 s64, 129024, s64
    s_cselect_b32 s66, s73, s74
    s_add_u32 m0, s94, s64
    s_nop 0
    buffer_load_dwordx4 v202, s[32:35], s66 offen  lds
    s_add_u32 m0, s95, 138240
    s_nop 0
    buffer_load_dwordx4 v203, s[32:35], s74 offen  lds
    s_waitcnt vmcnt(0)
    s_branch Llate_111b
Llate_111:
Llate_111b:
    v_mov_b32 v0, 14
    ds_write_b32 v10, v0
    v_lshl_add_u32 v112, v2, 5, v3
    v_lshlrev_b32 v112, 3, v112
    v_lshlrev_b32 v113, 3, v3
    s_lshl_b32 s64, s62, 2
    s_add_u32 s64, s64, s57
    s_mul_i32 s64, s64, 3072
    s_add_u32 s64, s64, 65536
    s_mov_b32 s89, 0
Lst_114:
    buffer_load_dwordx2 v[100:101], v112, s[44:47], s64 offen offset:0 sc1
    buffer_load_dwordx2 v[102:103], v112, s[44:47], s64 offen offset:1024 sc1
    buffer_load_dwordx2 v[104:105], v113, s[44:47], s64 offen offset:2048 sc1
    buffer_load_dwordx2 v[106:107], v112, s[44:47], s64 offen offset:128 sc1
    buffer_load_dwordx2 v[108:109], v112, s[44:47], s64 offen offset:1152 sc1
    buffer_load_dwordx2 v[110:111], v113, s[44:47], s64 offen offset:2176 sc1
    s_add_u32 s89, s89, 1
    s_cmp_gt_u32 s89, 100000
    s_cbranch_scc1 L_end
    s_waitcnt vmcnt(0)
    v_xor_b32 v12, v100, v19
    v_bitop3_b32 v12, v12, v101, v19 bitop3:0xf6
    v_bitop3_b32 v12, v12, v102, v19 bitop3:0xf6
    v_bitop3_b32 v12, v12, v103, v19 bitop3:0xf6
    v_bitop3_b32 v12, v12, v104, v19 bitop3:0xf6
    v_bitop3_b32 v12, v12, v105, v19 bitop3:0xf6
    v_bitop3_b32 v12, v12, v106, v19 bitop3:0xf6
    v_bitop3_b32 v12, v12, v107, v19 bitop3:0xf6
    v_bitop3_b32 v12, v12, v108, v19 bitop3:0xf6
    v_bitop3_b32 v12, v12, v109, v19 bitop3:0xf6
    v_bitop3_b32 v12, v12, v110, v19 bitop3:0xf6
    v_bitop3_b32 v12, v12, v111, v19 bitop3:0xf6
    v_and_b32 v12, 0xff, v12
    v_cmp_ne_u32 vcc, 0, v12
    s_nop 3
    s_cbranch_vccnz Lst_114
    v_and_b32 v100, 0xffffff00, v100
    v_and_b32 v101, 0xffffff00, v101
    v_and_b32 v102, 0xffffff00, v102
    v_and_b32 v103, 0xffffff00, v103
    v_and_b32 v104, 0xffffff00, v104
    v_and_b32 v105, 0xffffff00, v105
    v_and_b32 v106, 0xffffff00, v106
    v_and_b32 v107, 0xffffff00, v107
    v_and_b32 v108, 0xffffff00, v108
    v_and_b32 v109, 0xffffff00, v109
    v_and_b32 v110, 0xffffff00, v110
    v_and_b32 v111, 0xffffff00, v111
    v_add_f32 v100, v100, v102
    v_mov_b32 v12, v100
    s_nop 1
    v_permlane16_swap_b32 v100, v12
    v_add_f32 v100, v100, v12
    v_mov_b32 v12, v100
    s_nop 1
    v_permlane32_swap_b32 v100, v12
    v_add_f32 v100, v100, v12
    v_add_f32 v100, v100, v104
    v_add_f32 v101, v101, v103
    v_mov_b32 v12, v101
    s_nop 1
    v_permlane16_swap_b32 v101, v12
    v_add_f32 v101, v101, v12
    v_mov_b32 v12, v101
    s_nop 1
    v_permlane32_swap_b32 v101, v12
    v_add_f32 v101, v101, v12
    v_add_f32 v101, v101, v105
    v_mul_f32 v100, 0x3ae38e39, v100
    v_mul_f32 v12, v100, v100
    v_mov_b32 v50, 0x3ae38e39
    v_fma_f32 v101, v101, v50, -v12
    v_max_f32 v101, 0, v101
    v_cvt_pk_bf16_f32 v101, v101, v101
    v_lshlrev_b32 v101, 16, v101
    v_add_f32 v101, 0x3727c5ac, v101
    v_cvt_pk_bf16_f32 v101, v101, v101
    v_lshlrev_b32 v101, 16, v101
    v_sqrt_f32 v49, v101
    s_nop 0
    v_cvt_pk_bf16_f32 v49, v49, v49
    v_lshlrev_b32 v49, 16, v49
    v_cvt_pk_bf16_f32 v100, v100, v100
    v_lshlrev_b32 v100, 16, v100
    v_sub_f32 v48, 0, v100
    v_rcp_f32 v12, v49
    s_nop 0
    v_mul_f32 v50, 0xc0135761, v12
    v_mul_f32 v51, v12, v12
    v_mul_f32 v51, v51, v12
    v_mul_f32 v51, 0xbdd2d3e8, v51
    v_add_f32 v106, v106, v108
    v_mov_b32 v12, v106
    s_nop 1
    v_permlane16_swap_b32 v106, v12
    v_add_f32 v106, v106, v12
    v_mov_b32 v12, v106
    s_nop 1
    v_permlane32_swap_b32 v106, v12
    v_add_f32 v106, v106, v12
    v_add_f32 v106, v106, v110
    v_add_f32 v107, v107, v109
    v_mov_b32 v12, v107
    s_nop 1
    v_permlane16_swap_b32 v107, v12
    v_add_f32 v107, v107, v12
    v_mov_b32 v12, v107
    s_nop 1
    v_permlane32_swap_b32 v107, v12
    v_add_f32 v107, v107, v12
    v_add_f32 v107, v107, v111
    v_mul_f32 v106, 0x3ae38e39, v106
    v_mul_f32 v12, v106, v106
    v_mov_b32 v54, 0x3ae38e39
    v_fma_f32 v107, v107, v54, -v12
    v_max_f32 v107, 0, v107
    v_cvt_pk_bf16_f32 v107, v107, v107
    v_lshlrev_b32 v107, 16, v107
    v_add_f32 v107, 0x3727c5ac, v107
    v_cvt_pk_bf16_f32 v107, v107, v107
    v_lshlrev_b32 v107, 16, v107
    v_sqrt_f32 v53, v107
    s_nop 0
    v_cvt_pk_bf16_f32 v53, v53, v53
    v_lshlrev_b32 v53, 16, v53
    v_cvt_pk_bf16_f32 v106, v106, v106
    v_lshlrev_b32 v106, 16, v106
    v_sub_f32 v52, 0, v106
    v_rcp_f32 v12, v53
    s_nop 0
    v_mul_f32 v54, 0xc0135761, v12
    v_mul_f32 v55, v12, v12
    v_mul_f32 v55, v55, v12
    v_mul_f32 v55, 0xbdd2d3e8, v55
    s_lshl_b32 s64, s57, 9
    s_add_u32 s64, s64, 156672
    v_lshl_add_u32 v13, v3, 4, s64
    ds_write_b128 v13, v[48:51] offset:0
    ds_write_b128 v13, v[52:55] offset:256
    s_lshl_b32 s64, s57, 6
    v_add_u32 v13, s64, v1
    v_min_u32 v13, 143, v13
    v_lshlrev_b32 v109, 2, v13
    s_mov_b32 s89, 0
    s_nop 1
Lcs_115:
    s_mul_i32 s64, s58, 6912
    s_mul_i32 s65, s63, 576
    s_add_u32 s64, s64, s65
    s_add_u32 s64, s64, 163840
    buffer_load_dword v100, v109, s[44:47], s64 offen sc1
    s_add_u32 s64, s64, 2304
    buffer_load_dword v101, v109, s[44:47], s64 offen sc1
    s_add_u32 s64, s64, 2304
    buffer_load_dword v102, v109, s[44:47], s64 offen sc1
    s_add_u32 s64, s64, 2304
    s_add_u32 s89, s89, 1
    s_cmp_gt_u32 s89, 100000
    s_cbranch_scc1 L_end
    s_waitcnt vmcnt(0)
    v_xor_b32 v12, v100, v19
    v_bitop3_b32 v12, v12, v101, v19 bitop3:0xf6
    v_bitop3_b32 v12, v12, v102, v19 bitop3:0xf6
    v_and_b32 v12, 0xff, v12
    v_cmp_ne_u32 vcc, 0, v12
    s_nop 3
    s_cbranch_vccnz Lcs_115
    v_and_b32 v100, 0xffffff00, v100
    v_and_b32 v101, 0xffffff00, v101
    v_and_b32 v102, 0xffffff00, v102
    v_add_f32 v100, v100, v101
    v_add_f32 v100, v100, v102
    v_add_u32 v13, v11, v109
    ds_write_b32 v13, v100 offset:256
    s_mov_b32 s89, 0
    s_branch Lw_117
Lw_116:
    s_sleep 3
Lw_117:
    ds_read_b128 v[12:15], v11 offset:0
    s_add_u32 s89, s89, 1
    s_cmp_gt_u32 s89, 1000000
    s_cbranch_scc1 L_end
    s_waitcnt lgkmcnt(0)
    v_min_u32 v12, v12, v13
    v_min3_u32 v12, v12, v14, v15
    s_nop 0
    v_readfirstlane_b32 s64, v12
    s_nop 0
    s_cmp_lt_u32 s64, 12
    s_nop 1
    s_cbranch_scc1 Lw_116
    s_add_u32 s73, s69, 16
    s_sub_u32 s65, s73, 18
    s_min_u32 s73, s73, s65
    s_mul_i32 s73, s73, 294912
    s_add_u32 s73, s73, s70
    s_add_u32 s74, s73, 294912
    s_cmp_ge_u32 s57, 2
    s_cbranch_scc1 Lx_118
    s_add_u32 m0, s96, 0
    s_nop 0
    buffer_load_dwordx4 v204, s[32:35], s74 offen  lds
Lx_118:
    s_add_u32 m0, s92, 147456
    s_nop 0
    buffer_load_dwordx4 v200, s[32:35], s73 offen  lds
    s_add_u32 m0, s93, 147456
    s_nop 0
    buffer_load_dwordx4 v201, s[32:35], s73 offen  lds
    s_mov_b32 s64, 0
    s_cmp_eq_u32 s57, 0
    s_cselect_b32 s64, 147456, s64
    s_cselect_b32 s66, s73, s74
    s_add_u32 m0, s94, s64
    s_nop 0
    buffer_load_dwordx4 v202, s[32:35], s66 offen  lds
    s_add_u32 m0, s95, 0
    s_nop 0
    buffer_load_dwordx4 v203, s[32:35], s74 offen  lds
    s_waitcnt vmcnt(0)
    v_mov_b32 v0, 15
    ds_write_b32 v10, v0
    s_mov_b32 s89, 0
    s_branch Lw_120
Lw_119:
    s_sleep 3
Lw_120:
    ds_read_b128 v[12:15], v11 offset:0
    s_add_u32 s89, s89, 1
    s_cmp_gt_u32 s89, 1000000
    s_cbranch_scc1 L_end
    s_waitcnt lgkmcnt(0)
    v_min_u32 v12, v12, v13
    v_min3_u32 v12, v12, v14, v15
    s_nop 0
    v_readfirstlane_b32 s64, v12
    s_nop 0
    s_cmp_lt_u32 s64, 14
    s_nop 1
    s_cbranch_scc1 Lw_119
    s_add_u32 s73, s97, 0
    s_add_u32 s74, s97, 36864
    s_cmp_ge_u32 s57, 2
    s_cbranch_scc1 Lx_121
    s_add_u32 m0, s96, 18432
    s_nop 0
    buffer_load_dwordx4 v209, s[36:39], s74 offen  lds
Lx_121:
    s_add_u32 m0, s92, 9216
    s_nop 0
    buffer_load_dwordx4 v205, s[36:39], s73 offen  lds
    s_waitcnt vmcnt(8)
    s_add_u32 m0, s93, 9216
    s_nop 0
    buffer_load_dwordx4 v206, s[36:39], s73 offen  lds
    s_waitcnt vmcnt(8)
    s_mov_b32 s64, 18432
    s_cmp_eq_u32 s57, 0
    s_cselect_b32 s64, 9216, s64
    s_cselect_b32 s66, s73, s74
    s_add_u32 m0, s94, s64
    s_nop 0
    buffer_load_dwordx4 v207, s[36:39], s66 offen  lds
    s_waitcnt vmcnt(8)
    s_add_u32 m0, s95, 18432
    s_nop 0
    buffer_load_dwordx4 v208, s[36:39], s74 offen  lds
    s_waitcnt vmcnt(8)
    s_add_u32 s73, s97, 73728
    s_add_u32 s74, s97, 110592
    s_cmp_ge_u32 s57, 2
    s_cbranch_scc1 Lx_122
    s_add_u32 m0, s96, 36864
    s_nop 0
    buffer_load_dwordx4 v209, s[36:39], s74 offen  lds
Lx_122:
    s_add_u32 m0, s92, 27648
    s_nop 0
    buffer_load_dwordx4 v205, s[36:39], s73 offen  lds
    s_waitcnt vmcnt(8)
    s_add_u32 m0, s93, 27648
    s_nop 0
    buffer_load_dwordx4 v206, s[36:39], s73 offen  lds
    s_waitcnt vmcnt(8)
    s_mov_b32 s64, 36864
    s_cmp_eq_u32 s57, 0
    s_cselect_b32 s64, 27648, s64
    s_cselect_b32 s66, s73, s74
    s_add_u32 m0, s94, s64
    s_nop 0
    buffer_load_dwordx4 v207, s[36:39], s66 offen  lds
    s_waitcnt vmcnt(8)
    s_add_u32 m0, s95, 36864
    s_nop 0
    buffer_load_dwordx4 v208, s[36:39], s74 offen  lds
    s_waitcnt vmcnt(8)
    s_add_u32 s73, s98, 0
    s_add_u32 s74, s99, 0
    s_cmp_ge_u32 s57, 2
    s_cbranch_scc1 Lx_123
    s_add_u32 m0, s96, 55296
    s_nop 0
    buffer_load_dwordx4 v209, s[36:39], s74 offen  lds
Lx_123:
    s_add_u32 m0, s92, 46080
    s_nop 0
    buffer_load_dwordx4 v205, s[36:39], s73 offen  lds
    s_waitcnt vmcnt(8)
    s_add_u32 m0, s93, 46080
    s_nop 0
    buffer_load_dwordx4 v206, s[36:39], s73 offen  lds
    s_waitcnt vmcnt(8)
    s_mov_b32 s64, 55296
    s_cmp_eq_u32 s57, 0
    s_cselect_b32 s64, 46080, s64
    s_cselect_b32 s66, s73, s74
    s_add_u32 m0, s94, s64
    s_nop 0
    buffer_load_dwordx4 v207, s[36:39], s66 offen  lds
    s_waitcnt vmcnt(8)
    s_add_u32 m0, s95, 55296
    s_nop 0
    buffer_load_dwordx4 v208, s[36:39], s74 offen  lds
    s_waitcnt vmcnt(8)
    s_add_u32 s73, s100, 0
    s_add_u32 s74, s98, 36864
    s_cmp_ge_u32 s57, 2
    s_cbranch_scc1 Lx_124
    s_add_u32 m0, s96, 73728
    s_nop 0
    buffer_load_dwordx4 v209, s[36:39], s74 offen  lds
Lx_124:
    s_add_u32 m0, s92, 64512
    s_nop 0
    buffer_load_dwordx4 v205, s[36:39], s73 offen  lds
    s_waitcnt vmcnt(8)
    s_add_u32 m0, s93, 64512
    s_nop 0
    buffer_load_dwordx4 v206, s[36:39], s73 offen  lds
    s_waitcnt vmcnt(8)
    s_mov_b32 s64, 73728
    s_cmp_eq_u32 s57, 0
    s_cselect_b32 s64, 64512, s64
    s_cselect_b32 s66, s73, s74
    s_add_u32 m0, s94, s64
    s_nop 0
    buffer_load_dwordx4 v207, s[36:39], s66 offen  lds
    s_waitcnt vmcnt(8)
    s_add_u32 m0, s95, 73728
    s_nop 0
    buffer_load_dwordx4 v208, s[36:39], s74 offen  lds
    s_waitcnt vmcnt(8)
    s_add_u32 m0, s50, 0
    v_mov_b32 v0, 68
    s_mov_b64 exec, 1
    global_load_lds_dword v0, s[48:49]
    s_mov_b64 exec, -1
    s_add_u32 s73, s99, 36864
    s_add_u32 s74, s100, 36864
    s_cmp_ge_u32 s57, 2
    s_cbranch_scc1 Lx_125
    s_add_u32 m0, s96, 92160
    s_nop 0
    buffer_load_dwordx4 v209, s[36:39], s74 offen  lds
Lx_125:
    s_add_u32 m0, s92, 82944
    s_nop 0
    buffer_load_dwordx4 v205, s[36:39], s73 offen  lds
    s_waitcnt vmcnt(8)
    s_add_u32 m0, s93, 82944
    s_nop 0
    buffer_load_dwordx4 v206, s[36:39], s73 offen  lds
    s_waitcnt vmcnt(8)
    s_mov_b32 s64, 92160
    s_cmp_eq_u32 s57, 0
    s_cselect_b32 s64, 82944, s64
    s_cselect_b32 s66, s73, s74
    s_add_u32 m0, s94, s64
    s_nop 0
    buffer_load_dwordx4 v207, s[36:39], s66 offen  lds
    s_waitcnt vmcnt(8)
    s_add_u32 m0, s95, 92160
    s_nop 0
    buffer_load_dwordx4 v208, s[36:39], s74 offen  lds
    s_waitcnt vmcnt(8)
    s_add_u32 s73, s98, 73728
    s_add_u32 s74, s99, 73728
    s_cmp_ge_u32 s57, 2
    s_cbranch_scc1 Lx_126
    s_add_u32 m0, s96, 110592
    s_nop 0
    buffer_load_dwordx4 v209, s[36:39], s74 offen  lds
Lx_126:
    s_add_u32 m0, s92, 101376
    s_nop 0
    buffer_load_dwordx4 v205, s[36:39], s73 offen  lds
    s_waitcnt vmcnt(8)
    s_add_u32 m0, s93, 101376
    s_nop 0
    buffer_load_dwordx4 v206, s[36:39], s73 offen  lds
    s_waitcnt vmcnt(8)
    s_mov_b32 s64, 110592
    s_cmp_eq_u32 s57, 0
    s_cselect_b32 s64, 101376, s64
    s_cselect_b32 s66, s73, s74
    s_add_u32 m0, s94, s64
    s_nop 0
    buffer_load_dwordx4 v207, s[36:39], s66 offen  lds
    s_waitcnt vmcnt(8)
    s_add_u32 m0, s95, 110592
    s_nop 0
    buffer_load_dwordx4 v208, s[36:39], s74 offen  lds
    s_waitcnt vmcnt(8)
    s_cmp_lg_u32 s2, 255
    s_cbranch_scc1 Lep_127
    s_cmp_lg_u32 s57, 3
    s_cbranch_scc1 Lep_127
    s_mov_b32 s89, 0
Lep_128:
    v_lshlrev_b32 v247, 7, v1
    s_mov_b32 s64, 4096
    buffer_load_dword v12, v247, s[44:47], s64 offen sc1
    s_add_u32 s64, s64, 8192
    buffer_load_dword v13, v247, s[44:47], s64 offen sc1
    s_add_u32 s64, s64, 8192
    buffer_load_dword v14, v247, s[44:47], s64 offen sc1
    s_add_u32 s64, s64, 8192
    buffer_load_dword v15, v247, s[44:47], s64 offen sc1
    s_add_u32 s64, s64, 8192
    s_add_u32 s89, s89, 1
    s_cmp_gt_u32 s89, 100000
    s_cbranch_scc1 L_end
    s_waitcnt vmcnt(0)
    v_xor_b32 v12, s56, v12
    v_xor_b32 v13, s56, v13
    v_xor_b32 v14, s56, v14
    v_xor_b32 v15, s56, v15
    v_or3_b32 v12, v12, v13, v14
    v_or_b32 v12, v12, v15
    v_cmp_ne_u32 vcc, 0, v12
    s_nop 3
    s_cbranch_vccnz Lep_128
    v_mov_b32 v12, s3
    v_mov_b32 v13, 0
    s_mov_b64 exec, 1
    buffer_store_dword v12, v13, s[44:47], 0 offen sc1
    s_mov_b64 exec, -1
Lep_127:
    s_mov_b32 s89, 0
    s_branch Lw_130
Lw_129:
    s_sleep 3
Lw_130:
    ds_read_b128 v[12:15], v11 offset:0
    s_add_u32 s89, s89, 1
    s_cmp_gt_u32 s89, 1000000
    s_cbranch_scc1 L_end
    s_waitcnt lgkmcnt(0)
    v_min_u32 v12, v12, v13
    v_min3_u32 v12, v12, v14, v15
    s_nop 0
    v_readfirstlane_b32 s64, v12
    s_nop 0
    s_cmp_lt_u32 s64, 15
    s_nop 1
    s_cbranch_scc1 Lw_129
    s_add_u32 s73, s100, 73728
    s_add_u32 s74, s98, 110592
    s_cmp_ge_u32 s57, 2
    s_cbranch_scc1 Lx_131
    s_add_u32 m0, s96, 129024
    s_nop 0
    buffer_load_dwordx4 v209, s[36:39], s74 offen  lds
Lx_131:
    s_add_u32 m0, s92, 119808
    s_nop 0
    buffer_load_dwordx4 v205, s[36:39], s73 offen  lds
    s_waitcnt vmcnt(2)
    s_add_u32 m0, s93, 119808
    s_nop 0
    buffer_load_dwordx4 v206, s[36:39], s73 offen  lds
    s_waitcnt vmcnt(2)
    s_mov_b32 s64, 129024
    s_cmp_eq_u32 s57, 0
    s_cselect_b32 s64, 119808, s64
    s_cselect_b32 s66, s73, s74
    s_add_u32 m0, s94, s64
    s_nop 0
    buffer_load_dwordx4 v207, s[36:39], s66 offen  lds
    s_waitcnt vmcnt(2)
    s_add_u32 m0, s95, 129024
    s_nop 0
    buffer_load_dwordx4 v208, s[36:39], s74 offen  lds
    s_waitcnt vmcnt(2)
    s_add_u32 s73, s99, 110592
    s_add_u32 s74, s100, 110592
    s_cmp_ge_u32 s57, 2
    s_cbranch_scc1 Lx_132
    s_add_u32 m0, s96, 147456
    s_nop 0
    buffer_load_dwordx4 v209, s[36:39], s74 offen  lds
Lx_132:
    s_add_u32 m0, s92, 138240
    s_nop 0
    buffer_load_dwordx4 v205, s[36:39], s73 offen  lds
    s_waitcnt vmcnt(2)
    s_add_u32 m0, s93, 138240
    s_nop 0
    buffer_load_dwordx4 v206, s[36:39], s73 offen  lds
    s_waitcnt vmcnt(2)
    s_mov_b32 s64, 147456
    s_cmp_eq_u32 s57, 0
    s_cselect_b32 s64, 138240, s64
    s_cselect_b32 s66, s73, s74
    s_add_u32 m0, s94, s64
    s_nop 0
    buffer_load_dwordx4 v207, s[36:39], s66 offen  lds
    s_waitcnt vmcnt(2)
    s_add_u32 m0, s95, 147456
    s_nop 0
    buffer_load_dwordx4 v208, s[36:39], s74 offen  lds
    s_waitcnt vmcnt(2)
    s_waitcnt vmcnt(0)
    v_mov_b32 v0, 18
    ds_write_b32 v10, v0
    s_mov_b32 s89, 0
    s_branch Lw_134
Lw_133:
    s_sleep 3
Lw_134:
    ds_read_b128 v[12:15], v11 offset:0
    s_add_u32 s89, s89, 1
    s_cmp_gt_u32 s89, 1000000
    s_cbranch_scc1 L_end
    s_waitcnt lgkmcnt(0)
    v_min_u32 v12, v12, v13
    v_min3_u32 v12, v12, v14, v15
    s_nop 0
    v_readfirstlane_b32 s64, v12
    s_nop 0
    s_cmp_lt_u32 s64, 17
    s_nop 1
    s_cbranch_scc1 Lw_133
    s_lshr_b32 s64, s63, 1
    s_xor_b32 s64, s64, 0
    s_mul_i32 s64, s64, 331776
    s_add_u32 s64, s64, s101
    s_add_u32 s73, s64, 147456
    s_lshr_b32 s64, s63, 1
    s_xor_b32 s64, s64, 1
    s_mul_i32 s64, s64, 331776
    s_add_u32 s64, s64, s101
    s_add_u32 s74, s64, 147456
    s_cmp_ge_u32 s57, 2
    s_cbranch_scc1 Lx_135
    s_add_u32 m0, s96, 9216
    s_nop 0
    buffer_load_dwordx4 v214, s[36:39], s74 offen  lds
Lx_135:
    s_add_u32 m0, s92, 0
    s_nop 0
    buffer_load_dwordx4 v210, s[36:39], s73 offen  lds
    s_add_u32 m0, s93, 0
    s_nop 0
    buffer_load_dwordx4 v211, s[36:39], s73 offen  lds
    s_mov_b32 s64, 9216
    s_cmp_eq_u32 s57, 0
    s_cselect_b32 s64, 0, s64
    s_cselect_b32 s66, s73, s74
    s_add_u32 m0, s94, s64
    s_nop 0
    buffer_load_dwordx4 v212, s[36:39], s66 offen  lds
    s_add_u32 m0, s95, 9216
    s_nop 0
    buffer_load_dwordx4 v213, s[36:39], s74 offen  lds
    s_lshl_b32 s64, s62, 2
    s_add_u32 s64, s64, s63
    s_mul_i32 s64, s64, 294912
    s_add_u32 s73, s64, 14680064
    s_lshl_b32 s64, s57, 11
    v_add_u32 v18, s64, v4
    s_lshl_b32 s65, s58, 12
    s_add_u32 s74, s83, s65
    s_add_u32 s74, s74, s73
    s_and_b32 s64, s3, 0xf0000000
    v_mov_b32 v19, s64
    s_mov_b32 s95, 0x01800000
    s_mov_b32 s96, 0x07800000
    s_mov_b32 s97, 0x1f800000
    s_mov_b32 s75, 0x1fff
    s_mov_b32 s92, 0x03ffffff
    s_mov_b32 s93, 0x0c000000
    s_mov_b32 s94, 0x4b400000
    s_waitcnt vmcnt(0)
    v_mov_b32 v0, 19
    ds_write_b32 v10, v0
    s_mul_i32 s64, s63, 9
    s_add_u32 s76, s64, s58
    s_lshl_b32 s64, s62, 3
    s_lshl_b32 s65, s57, 1
    s_add_u32 s77, s64, s65
    s_mul_i32 s64, s77, 9
    s_lshr_b32 s65, s76, 2
    s_add_u32 s64, s64, s65
    s_mul_i32 s64, s64, 2304
    s_and_b32 s65, s76, 2
    s_lshl_b32 s65, s65, 9
    s_add_u32 s64, s64, s65
    s_and_b32 s65, s76, 1
    s_lshl_b32 s65, s65, 3
    s_add_u32 s64, s64, s65
    s_add_u32 s64, s64, 2097152
    v_add_u32 v13, 20736, v4
    buffer_load_dwordx2 v[100:101], v4, s[44:47], s64 offen sc1
    buffer_load_dwordx2 v[102:103], v13, s[44:47], s64 offen sc1
    v_mul_u32_u24 v106, 1152, v3
    v_lshl_add_u32 v106, v2, 3, v106
    s_lshl_b32 s64, s58, 15
    s_add_u32 s68, s64, s73
    s_add_u32 s68, s68, s83
    s_add_u32 s69, s73, 262144
    s_add_u32 s69, s69, s83
    v_mov_b32 v56, 0
    v_mov_b32 v57, 0
    v_mov_b32 v58, 0
    v_mov_b32 v59, 0
    v_mov_b32 v60, 0
    v_mov_b32 v61, 0
    v_mov_b32 v62, 0
    v_mov_b32 v63, 0
    v_mov_b32 v64, 0
    v_mov_b32 v65, 0
    v_mov_b32 v66, 0
    v_mov_b32 v67, 0
    v_mov_b32 v68, 0
    v_mov_b32 v69, 0
    v_mov_b32 v70, 0
    v_mov_b32 v71, 0
    s_setprio 3
    s_mov_b32 s89, 0
    s_branch Lw_137
Lw_136:
    s_sleep 1
Lw_137:
    v_xor_b32 v13, 16, v10
    ds_read_b32 v12, v13
    s_add_u32 s89, s89, 1
    s_cmp_gt_u32 s89, 1000000
    s_cbranch_scc1 L_end
    s_waitcnt lgkmcnt(0)
    v_readfirstlane_b32 s64, v12
    s_nop 0
    s_cmp_lt_u32 s64, 19
    s_nop 1
    s_cbranch_scc1 Lw_136
    ds_read_b128 v[108:111], v18 offset:18432
    ds_read_b128 v[112:115], v18 offset:19456
    s_add_u32 s66, s74, 262144
    s_waitcnt lgkmcnt(0)
    v_mov_b32 v0, 20
    ds_write_b32 v10, v0
    v_max3_f32 v12, |v108|, |v109|, |v110|
    v_max3_f32 v13, |v111|, |v112|, |v113|
    v_max3_f32 v12, v12, |v114|, |v115|
    v_max_f32 v12, v12, v13
    v_and_b32 v12, 0x7f800000, v12
    v_max_u32 v12, 100663296, v12
    v_sub_u32 v13, 2222977024, v12
    v_fma_f32 v108, v108, v13, s94
    v_fma_f32 v109, v109, v13, s94
    v_fma_f32 v110, v110, v13, s94
    v_fma_f32 v111, v111, v13, s94
    v_fma_f32 v112, v112, v13, s94
    v_fma_f32 v113, v113, v13, s94
    v_fma_f32 v114, v114, v13, s94
    v_fma_f32 v115, v115, v13, s94
    v_lshlrev_b32 v109, 13, v109
    v_bfi_b32 v108, s75, v108, v109
    v_lshlrev_b32 v14, 3, v12
    v_bfi_b32 v14, s93, v14, v19
    v_bfi_b32 v72, s92, v108, v14
    v_lshlrev_b32 v111, 13, v111
    v_bfi_b32 v110, s75, v110, v111
    v_lshlrev_b32 v14, 1, v12
    v_bfi_b32 v14, s93, v14, v19
    v_bfi_b32 v73, s92, v110, v14
    v_lshlrev_b32 v113, 13, v113
    v_bfi_b32 v112, s75, v112, v113
    v_lshrrev_b32 v14, 1, v12
    v_bfi_b32 v14, s93, v14, v19
    v_bfi_b32 v74, s92, v112, v14
    v_lshlrev_b32 v115, 13, v115
    v_bfi_b32 v114, s75, v114, v115
    v_lshrrev_b32 v14, 3, v12
    v_bfi_b32 v14, s93, v14, v19
    v_bfi_b32 v75, s92, v114, v14
    buffer_store_dwordx4 v[72:75], v4, s[44:47], s66 offen sc1
    s_mov_b32 s89, 0
    s_branch Lw_139
Lw_138:
    s_sleep 1
Lw_139:
    v_xor_b32 v13, 16, v10
    ds_read_b32 v12, v13
    s_add_u32 s89, s89, 1
    s_cmp_gt_u32 s89, 1000000
    s_cbranch_scc1 L_end
    s_waitcnt lgkmcnt(0)
    v_readfirstlane_b32 s64, v12
    s_nop 0
    s_cmp_lt_u32 s64, 20
    s_nop 1
    s_cbranch_scc1 Lw_138
    ds_read_b128 v[116:119], v18 offset:27648
    ds_read_b128 v[120:123], v18 offset:28672
    s_add_u32 s64, s58, 1
    s_and_b32 s64, s64, 7
    s_lshl_b32 s64, s64, 15
    s_add_u32 s66, s64, s74
    s_waitcnt lgkmcnt(0)
    v_mov_b32 v0, 21
    ds_write_b32 v10, v0
    v_max3_f32 v12, |v116|, |v117|, |v118|
    v_max3_f32 v13, |v119|, |v120|, |v121|
    v_max3_f32 v12, v12, |v122|, |v123|
    v_max_f32 v12, v12, v13
    v_and_b32 v12, 0x7f800000, v12
    v_max_u32 v12, 100663296, v12
    v_sub_u32 v13, 2222977024, v12
    v_fma_f32 v116, v116, v13, s94
    v_fma_f32 v117, v117, v13, s94
    v_fma_f32 v118, v118, v13, s94
    v_fma_f32 v119, v119, v13, s94
    v_fma_f32 v120, v120, v13, s94
    v_fma_f32 v121, v121, v13, s94
    v_fma_f32 v122, v122, v13, s94
    v_fma_f32 v123, v123, v13, s94
    v_lshlrev_b32 v117, 13, v117
    v_bfi_b32 v116, s75, v116, v117
    v_lshlrev_b32 v14, 3, v12
    v_bfi_b32 v14, s93, v14, v19
    v_bfi_b32 v76, s92, v116, v14
    v_lshlrev_b32 v119, 13, v119
    v_bfi_b32 v118, s75, v118, v119
    v_lshlrev_b32 v14, 1, v12
    v_bfi_b32 v14, s93, v14, v19
    v_bfi_b32 v77, s92, v118, v14
    v_lshlrev_b32 v121, 13, v121
    v_bfi_b32 v120, s75, v120, v121
    v_lshrrev_b32 v14, 1, v12
    v_bfi_b32 v14, s93, v14, v19
    v_bfi_b32 v78, s92, v120, v14
    v_lshlrev_b32 v123, 13, v123
    v_bfi_b32 v122, s75, v122, v123
    v_lshrrev_b32 v14, 3, v12
    v_bfi_b32 v14, s93, v14, v19
    v_bfi_b32 v79, s92, v122, v14
    buffer_store_dwordx4 v[76:79], v4, s[44:47], s66 offen sc1
    s_mov_b32 s89, 0
    s_branch Lw_141
Lw_140:
    s_sleep 1
Lw_141:
    v_xor_b32 v13, 16, v10
    ds_read_b32 v12, v13
    s_add_u32 s89, s89, 1
    s_cmp_gt_u32 s89, 1000000
    s_cbranch_scc1 L_end
    s_waitcnt lgkmcnt(0)
    v_readfirstlane_b32 s64, v12
    s_nop 0
    s_cmp_lt_u32 s64, 21
    s_nop 1
    s_cbranch_scc1 Lw_140
    ds_read_b128 v[108:111], v18 offset:36864
    ds_read_b128 v[112:115], v18 offset:37888
    s_add_u32 s64, s58, 2
    s_and_b32 s64, s64, 7
    s_lshl_b32 s64, s64, 15
    s_add_u32 s66, s64, s74
    s_waitcnt lgkmcnt(0)
    v_mov_b32 v0, 22
    ds_write_b32 v10, v0
    v_max3_f32 v12, |v108|, |v109|, |v110|
    v_max3_f32 v13, |v111|, |v112|, |v113|
    v_max3_f32 v12, v12, |v114|, |v115|
    v_max_f32 v12, v12, v13
    v_and_b32 v12, 0x7f800000, v12
    v_max_u32 v12, 100663296, v12
    v_sub_u32 v13, 2222977024, v12
    v_fma_f32 v108, v108, v13, s94
    v_fma_f32 v109, v109, v13, s94
    v_fma_f32 v110, v110, v13, s94
    v_fma_f32 v111, v111, v13, s94
    v_fma_f32 v112, v112, v13, s94
    v_fma_f32 v113, v113, v13, s94
    v_fma_f32 v114, v114, v13, s94
    v_fma_f32 v115, v115, v13, s94
    v_lshlrev_b32 v109, 13, v109
    v_bfi_b32 v108, s75, v108, v109
    v_lshlrev_b32 v14, 3, v12
    v_bfi_b32 v14, s93, v14, v19
    v_bfi_b32 v72, s92, v108, v14
    v_lshlrev_b32 v111, 13, v111
    v_bfi_b32 v110, s75, v110, v111
    v_lshlrev_b32 v14, 1, v12
    v_bfi_b32 v14, s93, v14, v19
    v_bfi_b32 v73, s92, v110, v14
    v_lshlrev_b32 v113, 13, v113
    v_bfi_b32 v112, s75, v112, v113
    v_lshrrev_b32 v14, 1, v12
    v_bfi_b32 v14, s93, v14, v19
    v_bfi_b32 v74, s92, v112, v14
    v_lshlrev_b32 v115, 13, v115
    v_bfi_b32 v114, s75, v114, v115
    v_lshrrev_b32 v14, 3, v12
    v_bfi_b32 v14, s93, v14, v19
    v_bfi_b32 v75, s92, v114, v14
    buffer_store_dwordx4 v[72:75], v4, s[44:47], s66 offen sc1
    s_mov_b32 s89, 0
    s_branch Lw_143
Lw_142:
    s_sleep 1
Lw_143:
    v_xor_b32 v13, 16, v10
    ds_read_b32 v12, v13
    s_add_u32 s89, s89, 1
    s_cmp_gt_u32 s89, 1000000
    s_cbranch_scc1 L_end
    s_waitcnt lgkmcnt(0)
    v_readfirstlane_b32 s64, v12
    s_nop 0
    s_cmp_lt_u32 s64, 22
    s_nop 1
    s_cbranch_scc1 Lw_142
    ds_read_b128 v[116:119], v18 offset:18432
    ds_read_b128 v[120:123], v18 offset:19456
    s_add_u32 s64, s58, 3
    s_and_b32 s64, s64, 7
    s_lshl_b32 s64, s64, 15
    s_add_u32 s66, s64, s74
    s_waitcnt lgkmcnt(0)
    v_mov_b32 v0, 23
    ds_write_b32 v10, v0
    v_max3_f32 v12, |v116|, |v117|, |v118|
    v_max3_f32 v13, |v119|, |v120|, |v121|
    v_max3_f32 v12, v12, |v122|, |v123|
    v_max_f32 v12, v12, v13
    v_and_b32 v12, 0x7f800000, v12
    v_max_u32 v12, 100663296, v12
    v_sub_u32 v13, 2222977024, v12
    v_fma_f32 v116, v116, v13, s94
    v_fma_f32 v117, v117, v13, s94
    v_fma_f32 v118, v118, v13, s94
    v_fma_f32 v119, v119, v13, s94
    v_fma_f32 v120, v120, v13, s94
    v_fma_f32 v121, v121, v13, s94
    v_fma_f32 v122, v122, v13, s94
    v_fma_f32 v123, v123, v13, s94
    v_lshlrev_b32 v117, 13, v117
    v_bfi_b32 v116, s75, v116, v117
    v_lshlrev_b32 v14, 3, v12
    v_bfi_b32 v14, s93, v14, v19
    v_bfi_b32 v76, s92, v116, v14
    v_lshlrev_b32 v119, 13, v119
    v_bfi_b32 v118, s75, v118, v119
    v_lshlrev_b32 v14, 1, v12
    v_bfi_b32 v14, s93, v14, v19
    v_bfi_b32 v77, s92, v118, v14
    v_lshlrev_b32 v121, 13, v121
    v_bfi_b32 v120, s75, v120, v121
    v_lshrrev_b32 v14, 1, v12
    v_bfi_b32 v14, s93, v14, v19
    v_bfi_b32 v78, s92, v120, v14
    v_lshlrev_b32 v123, 13, v123
    v_bfi_b32 v122, s75, v122, v123
    v_lshrrev_b32 v14, 3, v12
    v_bfi_b32 v14, s93, v14, v19
    v_bfi_b32 v79, s92, v122, v14
    buffer_store_dwordx4 v[76:79], v4, s[44:47], s66 offen sc1
    s_mov_b32 s89, 0
    s_branch Lw_145
Lw_144:
    s_sleep 1
Lw_145:
    v_xor_b32 v13, 16, v10
    ds_read_b32 v12, v13
    s_add_u32 s89, s89, 1
    s_cmp_gt_u32 s89, 1000000
    s_cbranch_scc1 L_end
    s_waitcnt lgkmcnt(0)
    v_readfirstlane_b32 s64, v12
    s_nop 0
    s_cmp_lt_u32 s64, 23
    s_nop 1
    s_cbranch_scc1 Lw_144
    ds_read_b128 v[108:111], v18 offset:27648
    ds_read_b128 v[112:115], v18 offset:28672
    s_add_u32 s64, s58, 4
    s_and_b32 s64, s64, 7
    s_lshl_b32 s64, s64, 15
    s_add_u32 s66, s64, s74
    s_waitcnt lgkmcnt(0)
    v_mov_b32 v0, 24
    ds_write_b32 v10, v0
    v_max3_f32 v12, |v108|, |v109|, |v110|
    v_max3_f32 v13, |v111|, |v112|, |v113|
    v_max3_f32 v12, v12, |v114|, |v115|
    v_max_f32 v12, v12, v13
    v_and_b32 v12, 0x7f800000, v12
    v_max_u32 v12, 100663296, v12
    v_sub_u32 v13, 2222977024, v12
    v_fma_f32 v108, v108, v13, s94
    v_fma_f32 v109, v109, v13, s94
    v_fma_f32 v110, v110, v13, s94
    v_fma_f32 v111, v111, v13, s94
    v_fma_f32 v112, v112, v13, s94
    v_fma_f32 v113, v113, v13, s94
    v_fma_f32 v114, v114, v13, s94
    v_fma_f32 v115, v115, v13, s94
    v_lshlrev_b32 v109, 13, v109
    v_bfi_b32 v108, s75, v108, v109
    v_lshlrev_b32 v14, 3, v12
    v_bfi_b32 v14, s93, v14, v19
    v_bfi_b32 v72, s92, v108, v14
    v_lshlrev_b32 v111, 13, v111
    v_bfi_b32 v110, s75, v110, v111
    v_lshlrev_b32 v14, 1, v12
    v_bfi_b32 v14, s93, v14, v19
    v_bfi_b32 v73, s92, v110, v14
    v_lshlrev_b32 v113, 13, v113
    v_bfi_b32 v112, s75, v112, v113
    v_lshrrev_b32 v14, 1, v12
    v_bfi_b32 v14, s93, v14, v19
    v_bfi_b32 v74, s92, v112, v14
    v_lshlrev_b32 v115, 13, v115
    v_bfi_b32 v114, s75, v114, v115
    v_lshrrev_b32 v14, 3, v12
    v_bfi_b32 v14, s93, v14, v19
    v_bfi_b32 v75, s92, v114, v14
    buffer_store_dwordx4 v[72:75], v4, s[44:47], s66 offen sc1
    s_sub_u32 s64, s58, 1
    s_and_b32 s64, s64, 7
    s_lshl_b32 s64, s64, 12
    s_add_u32 s64, s64, s68
    buffer_load_dwordx4 v[132:135], v4, s[44:47], s64 offen sc1
    s_mov_b32 s89, 0
    s_branch Lw_147
Lw_146:
    s_sleep 1
Lw_147:
    v_xor_b32 v13, 16, v10
    ds_read_b32 v12, v13
    s_add_u32 s89, s89, 1
    s_cmp_gt_u32 s89, 1000000
    s_cbranch_scc1 L_end
    s_waitcnt lgkmcnt(0)
    v_readfirstlane_b32 s64, v12
    s_nop 0
    s_cmp_lt_u32 s64, 24
    s_nop 1
    s_cbranch_scc1 Lw_146
    ds_read_b128 v[116:119], v18 offset:36864
    ds_read_b128 v[120:123], v18 offset:37888
    s_add_u32 s64, s58, 5
    s_and_b32 s64, s64, 7
    s_lshl_b32 s64, s64, 15
    s_add_u32 s66, s64, s74
    s_waitcnt lgkmcnt(0)
    v_mov_b32 v0, 25
    ds_write_b32 v10, v0
    v_max3_f32 v12, |v116|, |v117|, |v118|
    v_max3_f32 v13, |v119|, |v120|, |v121|
    v_max3_f32 v12, v12, |v122|, |v123|
    v_max_f32 v12, v12, v13
    v_and_b32 v12, 0x7f800000, v12
    v_max_u32 v12, 100663296, v12
    v_sub_u32 v13, 2222977024, v12
    v_fma_f32 v116, v116, v13, s94
    v_fma_f32 v117, v117, v13, s94
    v_fma_f32 v118, v118, v13, s94
    v_fma_f32 v119, v119, v13, s94
    v_fma_f32 v120, v120, v13, s94
    v_fma_f32 v121, v121, v13, s94
    v_fma_f32 v122, v122, v13, s94
    v_fma_f32 v123, v123, v13, s94
    v_lshlrev_b32 v117, 13, v117
    v_bfi_b32 v116, s75, v116, v117
    v_lshlrev_b32 v14, 3, v12
    v_bfi_b32 v14, s93, v14, v19
    v_bfi_b32 v76, s92, v116, v14
    v_lshlrev_b32 v119, 13, v119
    v_bfi_b32 v118, s75, v118, v119
    v_lshlrev_b32 v14, 1, v12
    v_bfi_b32 v14, s93, v14, v19
    v_bfi_b32 v77, s92, v118, v14
    v_lshlrev_b32 v121, 13, v121
    v_bfi_b32 v120, s75, v120, v121
    v_lshrrev_b32 v14, 1, v12
    v_bfi_b32 v14, s93, v14, v19
    v_bfi_b32 v78, s92, v120, v14
    v_lshlrev_b32 v123, 13, v123
    v_bfi_b32 v122, s75, v122, v123
    v_lshrrev_b32 v14, 3, v12
    v_bfi_b32 v14, s93, v14, v19
    v_bfi_b32 v79, s92, v122, v14
    buffer_store_dwordx4 v[76:79], v4, s[44:47], s66 offen sc1
    s_sub_u32 s64, s58, 2
    s_and_b32 s64, s64, 7
    s_lshl_b32 s64, s64, 12
    s_add_u32 s64, s64, s68
    buffer_load_dwordx4 v[136:139], v4, s[44:47], s64 offen sc1
    s_mov_b32 s89, 0
    s_branch Lw_149
Lw_148:
    s_sleep 1
Lw_149:
    v_xor_b32 v13, 16, v10
    ds_read_b32 v12, v13
    s_add_u32 s89, s89, 1
    s_cmp_gt_u32 s89, 1000000
    s_cbranch_scc1 L_end
    s_waitcnt lgkmcnt(0)
    v_readfirstlane_b32 s64, v12
    s_nop 0
    s_cmp_lt_u32 s64, 25
    s_nop 1
    s_cbranch_scc1 Lw_148
    ds_read_b128 v[108:111], v18 offset:18432
    ds_read_b128 v[112:115], v18 offset:19456
    s_add_u32 s64, s58, 6
    s_and_b32 s64, s64, 7
    s_lshl_b32 s64, s64, 15
    s_add_u32 s66, s64, s74
    s_waitcnt lgkmcnt(0)
    v_mov_b32 v0, 26
    ds_write_b32 v10, v0
    v_max3_f32 v12, |v108|, |v109|, |v110|
    v_max3_f32 v13, |v111|, |v112|, |v113|
    v_max3_f32 v12, v12, |v114|, |v115|
    v_max_f32 v12, v12, v13
    v_and_b32 v12, 0x7f800000, v12
    v_max_u32 v12, 100663296, v12
    v_sub_u32 v13, 2222977024, v12
    v_fma_f32 v108, v108, v13, s94
    v_fma_f32 v109, v109, v13, s94
    v_fma_f32 v110, v110, v13, s94
    v_fma_f32 v111, v111, v13, s94
    v_fma_f32 v112, v112, v13, s94
    v_fma_f32 v113, v113, v13, s94
    v_fma_f32 v114, v114, v13, s94
    v_fma_f32 v115, v115, v13, s94
    v_lshlrev_b32 v109, 13, v109
    v_bfi_b32 v108, s75, v108, v109
    v_lshlrev_b32 v14, 3, v12
    v_bfi_b32 v14, s93, v14, v19
    v_bfi_b32 v72, s92, v108, v14
    v_lshlrev_b32 v111, 13, v111
    v_bfi_b32 v110, s75, v110, v111
    v_lshlrev_b32 v14, 1, v12
    v_bfi_b32 v14, s93, v14, v19
    v_bfi_b32 v73, s92, v110, v14
    v_lshlrev_b32 v113, 13, v113
    v_bfi_b32 v112, s75, v112, v113
    v_lshrrev_b32 v14, 1, v12
    v_bfi_b32 v14, s93, v14, v19
    v_bfi_b32 v74, s92, v112, v14
    v_lshlrev_b32 v115, 13, v115
    v_bfi_b32 v114, s75, v114, v115
    v_lshrrev_b32 v14, 3, v12
    v_bfi_b32 v14, s93, v14, v19
    v_bfi_b32 v75, s92, v114, v14
    buffer_store_dwordx4 v[72:75], v4, s[44:47], s66 offen sc1
    s_sub_u32 s64, s58, 3
    s_and_b32 s64, s64, 7
    s_lshl_b32 s64, s64, 12
    s_add_u32 s64, s64, s68
    buffer_load_dwordx4 v[140:143], v4, s[44:47], s64 offen sc1
    s_mov_b32 s89, 0
    s_branch Lw_151
Lw_150:
    s_sleep 1
Lw_151:
    v_xor_b32 v13, 16, v10
    ds_read_b32 v12, v13
    s_add_u32 s89, s89, 1
    s_cmp_gt_u32 s89, 1000000
    s_cbranch_scc1 L_end
    s_waitcnt lgkmcnt(0)
    v_readfirstlane_b32 s64, v12
    s_nop 0
    s_cmp_lt_u32 s64, 26
    s_nop 1
    s_cbranch_scc1 Lw_150
    ds_read_b128 v[116:119], v18 offset:27648
    ds_read_b128 v[120:123], v18 offset:28672
    s_add_u32 s64, s58, 7
    s_and_b32 s64, s64, 7
    s_lshl_b32 s64, s64, 15
    s_add_u32 s66, s64, s74
    s_waitcnt lgkmcnt(0)
    v_mov_b32 v0, 27
    ds_write_b32 v10, v0
    v_max3_f32 v12, |v116|, |v117|, |v118|
    v_max3_f32 v13, |v119|, |v120|, |v121|
    v_max3_f32 v12, v12, |v122|, |v123|
    v_max_f32 v12, v12, v13
    v_and_b32 v12, 0x7f800000, v12
    v_max_u32 v12, 100663296, v12
    v_sub_u32 v13, 2222977024, v12
    v_fma_f32 v116, v116, v13, s94
    v_fma_f32 v117, v117, v13, s94
    v_fma_f32 v118, v118, v13, s94
    v_fma_f32 v119, v119, v13, s94
    v_fma_f32 v120, v120, v13, s94
    v_fma_f32 v121, v121, v13, s94
    v_fma_f32 v122, v122, v13, s94
    v_fma_f32 v123, v123, v13, s94
    v_lshlrev_b32 v117, 13, v117
    v_bfi_b32 v116, s75, v116, v117
    v_lshlrev_b32 v14, 3, v12
    v_bfi_b32 v14, s93, v14, v19
    v_bfi_b32 v76, s92, v116, v14
    v_lshlrev_b32 v119, 13, v119
    v_bfi_b32 v118, s75, v118, v119
    v_lshlrev_b32 v14, 1, v12
    v_bfi_b32 v14, s93, v14, v19
    v_bfi_b32 v77, s92, v118, v14
    v_lshlrev_b32 v121, 13, v121
    v_bfi_b32 v120, s75, v120, v121
    v_lshrrev_b32 v14, 1, v12
    v_bfi_b32 v14, s93, v14, v19
    v_bfi_b32 v78, s92, v120, v14
    v_lshlrev_b32 v123, 13, v123
    v_bfi_b32 v122, s75, v122, v123
    v_lshrrev_b32 v14, 3, v12
    v_bfi_b32 v14, s93, v14, v19
    v_bfi_b32 v79, s92, v122, v14
    buffer_store_dwordx4 v[76:79], v4, s[44:47], s66 offen sc1
    s_sub_u32 s64, s58, 4
    s_and_b32 s64, s64, 7
    s_lshl_b32 s64, s64, 12
    s_add_u32 s64, s64, s68
    buffer_load_dwordx4 v[144:147], v4, s[44:47], s64 offen sc1
    s_waitcnt vmcnt(6)
    v_xor_b32 v12, v132, v19
    v_bitop3_b32 v12, v12, v133, v19 bitop3:0xf6
    v_bitop3_b32 v12, v12, v134, v19 bitop3:0xf6
    v_bitop3_b32 v12, v12, v135, v19 bitop3:0xf6
    v_cmp_gt_u32 vcc, 0x10000000, v12
    s_nop 0
    s_cmp_eq_u64 vcc, -1
    s_cbranch_scc0 Ls_s152
Ls_r152:
    v_lshrrev_b32 v12, 3, v132
    v_lshrrev_b32 v13, 1, v133
    v_bfi_b32 v12, s95, v12, v13
    v_lshlrev_b32 v13, 1, v134
    v_bfi_b32 v12, s96, v12, v13
    v_lshlrev_b32 v13, 3, v135
    v_bfi_b32 v12, s97, v12, v13
    v_and_b32 v12, 0x7f800000, v12
    v_add_u32 v12, 4202694656, v12
    v_bfe_i32 v80, v132, 0, 13
    v_bfe_i32 v81, v132, 13, 13
    v_bfe_i32 v82, v133, 0, 13
    v_bfe_i32 v83, v133, 13, 13
    v_bfe_i32 v84, v134, 0, 13
    v_bfe_i32 v85, v134, 13, 13
    v_bfe_i32 v86, v135, 0, 13
    v_bfe_i32 v87, v135, 13, 13
    v_cvt_f32_i32 v80, v80
    v_cvt_f32_i32 v81, v81
    v_cvt_f32_i32 v82, v82
    v_cvt_f32_i32 v83, v83
    v_cvt_f32_i32 v84, v84
    v_cvt_f32_i32 v85, v85
    v_cvt_f32_i32 v86, v86
    v_cvt_f32_i32 v87, v87
    v_fma_f32 v56, v80, v12, v56
    v_fma_f32 v57, v81, v12, v57
    v_fma_f32 v58, v82, v12, v58
    v_fma_f32 v59, v83, v12, v59
    v_fma_f32 v60, v84, v12, v60
    v_fma_f32 v61, v85, v12, v61
    v_fma_f32 v62, v86, v12, v62
    v_fma_f32 v63, v87, v12, v63
    s_waitcnt vmcnt(4)
    v_xor_b32 v12, v136, v19
    v_bitop3_b32 v12, v12, v137, v19 bitop3:0xf6
    v_bitop3_b32 v12, v12, v138, v19 bitop3:0xf6
    v_bitop3_b32 v12, v12, v139, v19 bitop3:0xf6
    v_cmp_gt_u32 vcc, 0x10000000, v12
    s_nop 0
    s_cmp_eq_u64 vcc, -1
    s_cbranch_scc0 Ls_s153
Ls_r153:
    v_lshrrev_b32 v12, 3, v136
    v_lshrrev_b32 v13, 1, v137
    v_bfi_b32 v12, s95, v12, v13
    v_lshlrev_b32 v13, 1, v138
    v_bfi_b32 v12, s96, v12, v13
    v_lshlrev_b32 v13, 3, v139
    v_bfi_b32 v12, s97, v12, v13
    v_and_b32 v12, 0x7f800000, v12
    v_add_u32 v12, 4202694656, v12
    v_bfe_i32 v80, v136, 0, 13
    v_bfe_i32 v81, v136, 13, 13
    v_bfe_i32 v82, v137, 0, 13
    v_bfe_i32 v83, v137, 13, 13
    v_bfe_i32 v84, v138, 0, 13
    v_bfe_i32 v85, v138, 13, 13
    v_bfe_i32 v86, v139, 0, 13
    v_bfe_i32 v87, v139, 13, 13
    v_cvt_f32_i32 v80, v80
    v_cvt_f32_i32 v81, v81
    v_cvt_f32_i32 v82, v82
    v_cvt_f32_i32 v83, v83
    v_cvt_f32_i32 v84, v84
    v_cvt_f32_i32 v85, v85
    v_cvt_f32_i32 v86, v86
    v_cvt_f32_i32 v87, v87
    v_fma_f32 v56, v80, v12, v56
    v_fma_f32 v57, v81, v12, v57
    v_fma_f32 v58, v82, v12, v58
    v_fma_f32 v59, v83, v12, v59
    v_fma_f32 v60, v84, v12, v60
    v_fma_f32 v61, v85, v12, v61
    v_fma_f32 v62, v86, v12, v62
    v_fma_f32 v63, v87, v12, v63
    s_waitcnt vmcnt(2)
    v_xor_b32 v12, v140, v19
    v_bitop3_b32 v12, v12, v141, v19 bitop3:0xf6
    v_bitop3_b32 v12, v12, v142, v19 bitop3:0xf6
    v_bitop3_b32 v12, v12, v143, v19 bitop3:0xf6
    v_cmp_gt_u32 vcc, 0x10000000, v12
    s_nop 0
    s_cmp_eq_u64 vcc, -1
    s_cbranch_scc0 Ls_s154
Ls_r154:
    v_lshrrev_b32 v12, 3, v140
    v_lshrrev_b32 v13, 1, v141
    v_bfi_b32 v12, s95, v12, v13
    v_lshlrev_b32 v13, 1, v142
    v_bfi_b32 v12, s96, v12, v13
    v_lshlrev_b32 v13, 3, v143
    v_bfi_b32 v12, s97, v12, v13
    v_and_b32 v12, 0x7f800000, v12
    v_add_u32 v12, 4202694656, v12
    v_bfe_i32 v80, v140, 0, 13
    v_bfe_i32 v81, v140, 13, 13
    v_bfe_i32 v82, v141, 0, 13
    v_bfe_i32 v83, v141, 13, 13
    v_bfe_i32 v84, v142, 0, 13
    v_bfe_i32 v85, v142, 13, 13
    v_bfe_i32 v86, v143, 0, 13
    v_bfe_i32 v87, v143, 13, 13
    v_cvt_f32_i32 v80, v80
    v_cvt_f32_i32 v81, v81
    v_cvt_f32_i32 v82, v82
    v_cvt_f32_i32 v83, v83
    v_cvt_f32_i32 v84, v84
    v_cvt_f32_i32 v85, v85
    v_cvt_f32_i32 v86, v86
    v_cvt_f32_i32 v87, v87
    v_fma_f32 v56, v80, v12, v56
    v_fma_f32 v57, v81, v12, v57
    v_fma_f32 v58, v82, v12, v58
    v_fma_f32 v59, v83, v12, v59
    v_fma_f32 v60, v84, v12, v60
    v_fma_f32 v61, v85, v12, v61
    v_fma_f32 v62, v86, v12, v62
    v_fma_f32 v63, v87, v12, v63
    s_sub_u32 s64, s58, 5
    s_and_b32 s64, s64, 7
    s_lshl_b32 s64, s64, 12
    s_add_u32 s64, s64, s68
    buffer_load_dwordx4 v[148:151], v4, s[44:47], s64 offen sc1
    s_waitcnt vmcnt(1)
    v_xor_b32 v12, v144, v19
    v_bitop3_b32 v12, v12, v145, v19 bitop3:0xf6
    v_bitop3_b32 v12, v12, v146, v19 bitop3:0xf6
    v_bitop3_b32 v12, v12, v147, v19 bitop3:0xf6
    v_cmp_gt_u32 vcc, 0x10000000, v12
    s_nop 0
    s_cmp_eq_u64 vcc, -1
    s_cbranch_scc0 Ls_s155
Ls_r155:
    v_lshrrev_b32 v12, 3, v144
    v_lshrrev_b32 v13, 1, v145
    v_bfi_b32 v12, s95, v12, v13
    v_lshlrev_b32 v13, 1, v146
    v_bfi_b32 v12, s96, v12, v13
    v_lshlrev_b32 v13, 3, v147
    v_bfi_b32 v12, s97, v12, v13
    v_and_b32 v12, 0x7f800000, v12
    v_add_u32 v12, 4202694656, v12
    v_bfe_i32 v80, v144, 0, 13
    v_bfe_i32 v81, v144, 13, 13
    v_bfe_i32 v82, v145, 0, 13
    v_bfe_i32 v83, v145, 13, 13
    v_bfe_i32 v84, v146, 0, 13
    v_bfe_i32 v85, v146, 13, 13
    v_bfe_i32 v86, v147, 0, 13
    v_bfe_i32 v87, v147, 13, 13
    v_cvt_f32_i32 v80, v80
    v_cvt_f32_i32 v81, v81
    v_cvt_f32_i32 v82, v82
    v_cvt_f32_i32 v83, v83
    v_cvt_f32_i32 v84, v84
    v_cvt_f32_i32 v85, v85
    v_cvt_f32_i32 v86, v86
    v_cvt_f32_i32 v87, v87
    v_fma_f32 v56, v80, v12, v56
    v_fma_f32 v57, v81, v12, v57
    v_fma_f32 v58, v82, v12, v58
    v_fma_f32 v59, v83, v12, v59
    v_fma_f32 v60, v84, v12, v60
    v_fma_f32 v61, v85, v12, v61
    v_fma_f32 v62, v86, v12, v62
    v_fma_f32 v63, v87, v12, v63
    s_sub_u32 s64, s58, 6
    s_and_b32 s64, s64, 7
    s_lshl_b32 s64, s64, 12
    s_add_u32 s64, s64, s68
    buffer_load_dwordx4 v[152:155], v4, s[44:47], s64 offen sc1
    s_mov_b32 s89, 0
    s_branch Lw_157
Lw_156:
    s_sleep 1
Lw_157:
    v_xor_b32 v13, 16, v10
    ds_read_b32 v12, v13
    s_add_u32 s89, s89, 1
    s_cmp_gt_u32 s89, 1000000
    s_cbranch_scc1 L_end
    s_waitcnt lgkmcnt(0)
    v_readfirstlane_b32 s64, v12
    s_nop 0
    s_cmp_lt_u32 s64, 27
    s_nop 1
    s_cbranch_scc1 Lw_156
    ds_read_b128 v[108:111], v18 offset:36864
    ds_read_b128 v[112:115], v18 offset:37888
    s_sub_u32 s64, s58, 7
    s_and_b32 s64, s64, 7
    s_lshl_b32 s64, s64, 12
    s_add_u32 s64, s64, s68
    buffer_load_dwordx4 v[156:159], v4, s[44:47], s64 offen sc1
    s_waitcnt lgkmcnt(0)
    v_add_f32 v56, v56, v108
    v_add_f32 v57, v57, v109
    v_add_f32 v58, v58, v110
    v_add_f32 v59, v59, v111
    v_add_f32 v60, v60, v112
    v_add_f32 v61, v61, v113
    v_add_f32 v62, v62, v114
    v_add_f32 v63, v63, v115
    s_waitcnt vmcnt(2)
    v_xor_b32 v12, v148, v19
    v_bitop3_b32 v12, v12, v149, v19 bitop3:0xf6
    v_bitop3_b32 v12, v12, v150, v19 bitop3:0xf6
    v_bitop3_b32 v12, v12, v151, v19 bitop3:0xf6
    v_cmp_gt_u32 vcc, 0x10000000, v12
    s_nop 0
    s_cmp_eq_u64 vcc, -1
    s_cbranch_scc0 Ls_s158
Ls_r158:
    v_lshrrev_b32 v12, 3, v148
    v_lshrrev_b32 v13, 1, v149
    v_bfi_b32 v12, s95, v12, v13
    v_lshlrev_b32 v13, 1, v150
    v_bfi_b32 v12, s96, v12, v13
    v_lshlrev_b32 v13, 3, v151
    v_bfi_b32 v12, s97, v12, v13
    v_and_b32 v12, 0x7f800000, v12
    v_add_u32 v12, 4202694656, v12
    v_bfe_i32 v80, v148, 0, 13
    v_bfe_i32 v81, v148, 13, 13
    v_bfe_i32 v82, v149, 0, 13
    v_bfe_i32 v83, v149, 13, 13
    v_bfe_i32 v84, v150, 0, 13
    v_bfe_i32 v85, v150, 13, 13
    v_bfe_i32 v86, v151, 0, 13
    v_bfe_i32 v87, v151, 13, 13
    v_cvt_f32_i32 v80, v80
    v_cvt_f32_i32 v81, v81
    v_cvt_f32_i32 v82, v82
    v_cvt_f32_i32 v83, v83
    v_cvt_f32_i32 v84, v84
    v_cvt_f32_i32 v85, v85
    v_cvt_f32_i32 v86, v86
    v_cvt_f32_i32 v87, v87
    v_fma_f32 v56, v80, v12, v56
    v_fma_f32 v57, v81, v12, v57
    v_fma_f32 v58, v82, v12, v58
    v_fma_f32 v59, v83, v12, v59
    v_fma_f32 v60, v84, v12, v60
    v_fma_f32 v61, v85, v12, v61
    v_fma_f32 v62, v86, v12, v62
    v_fma_f32 v63, v87, v12, v63
    s_waitcnt vmcnt(1)
    v_xor_b32 v12, v152, v19
    v_bitop3_b32 v12, v12, v153, v19 bitop3:0xf6
    v_bitop3_b32 v12, v12, v154, v19 bitop3:0xf6
    v_bitop3_b32 v12, v12, v155, v19 bitop3:0xf6
    v_cmp_gt_u32 vcc, 0x10000000, v12
    s_nop 0
    s_cmp_eq_u64 vcc, -1
    s_cbranch_scc0 Ls_s159
Ls_r159:
    v_lshrrev_b32 v12, 3, v152
    v_lshrrev_b32 v13, 1, v153
    v_bfi_b32 v12, s95, v12, v13
    v_lshlrev_b32 v13, 1, v154
    v_bfi_b32 v12, s96, v12, v13
    v_lshlrev_b32 v13, 3, v155
    v_bfi_b32 v12, s97, v12, v13
    v_and_b32 v12, 0x7f800000, v12
    v_add_u32 v12, 4202694656, v12
    v_bfe_i32 v80, v152, 0, 13
    v_bfe_i32 v81, v152, 13, 13
    v_bfe_i32 v82, v153, 0, 13
    v_bfe_i32 v83, v153, 13, 13
    v_bfe_i32 v84, v154, 0, 13
    v_bfe_i32 v85, v154, 13, 13
    v_bfe_i32 v86, v155, 0, 13
    v_bfe_i32 v87, v155, 13, 13
    v_cvt_f32_i32 v80, v80
    v_cvt_f32_i32 v81, v81
    v_cvt_f32_i32 v82, v82
    v_cvt_f32_i32 v83, v83
    v_cvt_f32_i32 v84, v84
    v_cvt_f32_i32 v85, v85
    v_cvt_f32_i32 v86, v86
    v_cvt_f32_i32 v87, v87
    v_fma_f32 v56, v80, v12, v56
    v_fma_f32 v57, v81, v12, v57
    v_fma_f32 v58, v82, v12, v58
    v_fma_f32 v59, v83, v12, v59
    v_fma_f32 v60, v84, v12, v60
    v_fma_f32 v61, v85, v12, v61
    v_fma_f32 v62, v86, v12, v62
    v_fma_f32 v63, v87, v12, v63
    s_waitcnt vmcnt(0)
    v_xor_b32 v12, v156, v19
    v_bitop3_b32 v12, v12, v157, v19 bitop3:0xf6
    v_bitop3_b32 v12, v12, v158, v19 bitop3:0xf6
    v_bitop3_b32 v12, v12, v159, v19 bitop3:0xf6
    v_cmp_gt_u32 vcc, 0x10000000, v12
    s_nop 0
    s_cmp_eq_u64 vcc, -1
    s_cbranch_scc0 Ls_s160
Ls_r160:
    v_lshrrev_b32 v12, 3, v156
    v_lshrrev_b32 v13, 1, v157
    v_bfi_b32 v12, s95, v12, v13
    v_lshlrev_b32 v13, 1, v158
    v_bfi_b32 v12, s96, v12, v13
    v_lshlrev_b32 v13, 3, v159
    v_bfi_b32 v12, s97, v12, v13
    v_and_b32 v12, 0x7f800000, v12
    v_add_u32 v12, 4202694656, v12
    v_bfe_i32 v80, v156, 0, 13
    v_bfe_i32 v81, v156, 13, 13
    v_bfe_i32 v82, v157, 0, 13
    v_bfe_i32 v83, v157, 13, 13
    v_bfe_i32 v84, v158, 0, 13
    v_bfe_i32 v85, v158, 13, 13
    v_bfe_i32 v86, v159, 0, 13
    v_bfe_i32 v87, v159, 13, 13
    v_cvt_f32_i32 v80, v80
    v_cvt_f32_i32 v81, v81
    v_cvt_f32_i32 v82, v82
    v_cvt_f32_i32 v83, v83
    v_cvt_f32_i32 v84, v84
    v_cvt_f32_i32 v85, v85
    v_cvt_f32_i32 v86, v86
    v_cvt_f32_i32 v87, v87
    v_fma_f32 v56, v80, v12, v56
    v_fma_f32 v57, v81, v12, v57
    v_fma_f32 v58, v82, v12, v58
    v_fma_f32 v59, v83, v12, v59
    v_fma_f32 v60, v84, v12, v60
    v_fma_f32 v61, v85, v12, v61
    v_fma_f32 v62, v86, v12, v62
    v_fma_f32 v63, v87, v12, v63
    s_add_u32 s79, s77, 0
    v_cvt_pk_bf16_f32 v12, v56, v57
    v_lshlrev_b32 v13, 16, v12
    v_and_b32 v12, 0xffff0000, v12
    v_lshlrev_b32 v14, 16, v100
    v_and_b32 v15, 0xffff0000, v100
    v_add_f32 v13, v13, v14
    v_add_f32 v12, v12, v15
    v_cvt_pk_bf16_f32 v56, v13, v12
    v_cvt_pk_bf16_f32 v12, v58, v59
    v_lshlrev_b32 v13, 16, v12
    v_and_b32 v12, 0xffff0000, v12
    v_lshlrev_b32 v14, 16, v101
    v_and_b32 v15, 0xffff0000, v101
    v_add_f32 v13, v13, v14
    v_add_f32 v12, v12, v15
    v_cvt_pk_bf16_f32 v57, v13, v12
    s_mul_i32 s64, s79, 18432
    s_lshl_b32 s65, s76, 5
    s_add_u32 s64, s64, s65
    buffer_store_dwordx2 v[56:57], v106, s[40:43], s64 offen
    s_add_u32 s79, s77, 1
    v_cvt_pk_bf16_f32 v12, v60, v61
    v_lshlrev_b32 v13, 16, v12
    v_and_b32 v12, 0xffff0000, v12
    v_lshlrev_b32 v14, 16, v102
    v_and_b32 v15, 0xffff0000, v102
    v_add_f32 v13, v13, v14
    v_add_f32 v12, v12, v15
    v_cvt_pk_bf16_f32 v60, v13, v12
    v_cvt_pk_bf16_f32 v12, v62, v63
    v_lshlrev_b32 v13, 16, v12
    v_and_b32 v12, 0xffff0000, v12
    v_lshlrev_b32 v14, 16, v103
    v_and_b32 v15, 0xffff0000, v103
    v_add_f32 v13, v13, v14
    v_add_f32 v12, v12, v15
    v_cvt_pk_bf16_f32 v61, v13, v12
    s_mul_i32 s64, s79, 18432
    s_lshl_b32 s65, s76, 5
    s_add_u32 s64, s64, s65
    buffer_store_dwordx2 v[60:61], v106, s[40:43], s64 offen
L_fin:
L_end:
    s_endpgm
Ls_s3:
    s_nop 7
    s_nop 3
    s_mov_b32 s89, 0
    s_branch Lw_162
Lw_161:
Lw_162:
    ds_read_b128 v[20:23], v11 offset:48
    s_add_u32 s89, s89, 1
    s_cmp_gt_u32 s89, 1000000
    s_cbranch_scc1 L_end
    s_waitcnt lgkmcnt(0)
    v_min_u32 v20, v20, v21
    v_min3_u32 v20, v20, v22, v23
    s_nop 0
    v_readfirstlane_b32 s64, v20
    s_nop 0
    s_cmp_lt_u32 s64, 8
    s_nop 1
    s_cbranch_scc1 Lw_161
    s_nop 7
    s_branch Ls_r3
Ls_s4:
    s_nop 7
    s_nop 3
    s_mov_b32 s89, 0
    s_branch Lw_164
Lw_163:
Lw_164:
    ds_read_b128 v[20:23], v11 offset:48
    s_add_u32 s89, s89, 1
    s_cmp_gt_u32 s89, 1000000
    s_cbranch_scc1 L_end
    s_waitcnt lgkmcnt(0)
    v_min_u32 v20, v20, v21
    v_min3_u32 v20, v20, v22, v23
    s_nop 0
    v_readfirstlane_b32 s64, v20
    s_nop 0
    s_cmp_lt_u32 s64, 14
    s_nop 1
    s_cbranch_scc1 Lw_163
    s_nop 7
    s_branch Ls_r4
Ls_s5:
    s_nop 7
    s_nop 3
    s_mov_b32 s89, 0
    s_branch Lw_166
Lw_165:
Lw_166:
    ds_read_b128 v[20:23], v11 offset:48
    s_add_u32 s89, s89, 1
    s_cmp_gt_u32 s89, 1000000
    s_cbranch_scc1 L_end
    s_waitcnt lgkmcnt(0)
    v_min_u32 v20, v20, v21
    v_min3_u32 v20, v20, v22, v23
    s_nop 0
    v_readfirstlane_b32 s64, v20
    s_nop 0
    s_cmp_lt_u32 s64, 20
    s_nop 1
    s_cbranch_scc1 Lw_165
    s_nop 7
    s_branch Ls_r5
Ls_s6:
    s_nop 7
    s_nop 3
    s_mov_b32 s89, 0
    s_branch Lw_168
Lw_167:
Lw_168:
    ds_read_b128 v[20:23], v11 offset:48
    s_add_u32 s89, s89, 1
    s_cmp_gt_u32 s89, 1000000
    s_cbranch_scc1 L_end
    s_waitcnt lgkmcnt(0)
    v_min_u32 v20, v20, v21
    v_min3_u32 v20, v20, v22, v23
    s_nop 0
    v_readfirstlane_b32 s64, v20
    s_nop 0
    s_cmp_lt_u32 s64, 26
    s_nop 1
    s_cbranch_scc1 Lw_167
    s_nop 7
    s_branch Ls_r6
Ls_s7:
    s_nop 7
    s_nop 3
    s_mov_b32 s89, 0
    s_branch Lw_170
Lw_169:
Lw_170:
    ds_read_b128 v[20:23], v11 offset:48
    s_add_u32 s89, s89, 1
    s_cmp_gt_u32 s89, 1000000
    s_cbranch_scc1 L_end
    s_waitcnt lgkmcnt(0)
    v_min_u32 v20, v20, v21
    v_min3_u32 v20, v20, v22, v23
    s_nop 0
    v_readfirstlane_b32 s64, v20
    s_nop 0
    s_cmp_lt_u32 s64, 30
    s_nop 1
    s_cbranch_scc1 Lw_169
    s_nop 7
    s_branch Ls_r7
Ls_s8:
    s_nop 7
    s_nop 3
    s_mov_b32 s89, 0
    s_branch Lw_172
Lw_171:
Lw_172:
    ds_read_b128 v[20:23], v11 offset:48
    s_add_u32 s89, s89, 1
    s_cmp_gt_u32 s89, 1000000
    s_cbranch_scc1 L_end
    s_waitcnt lgkmcnt(0)
    v_min_u32 v20, v20, v21
    v_min3_u32 v20, v20, v22, v23
    s_nop 0
    v_readfirstlane_b32 s64, v20
    s_nop 0
    s_cmp_lt_u32 s64, 33
    s_nop 1
    s_cbranch_scc1 Lw_171
    s_nop 7
    s_branch Ls_r8
Ls_s9:
    s_nop 7
    s_nop 3
    s_mov_b32 s89, 0
    s_branch Lw_174
Lw_173:
Lw_174:
    ds_read_b128 v[20:23], v11 offset:48
    s_add_u32 s89, s89, 1
    s_cmp_gt_u32 s89, 1000000
    s_cbranch_scc1 L_end
    s_waitcnt lgkmcnt(0)
    v_min_u32 v20, v20, v21
    v_min3_u32 v20, v20, v22, v23
    s_nop 0
    v_readfirstlane_b32 s64, v20
    s_nop 0
    s_cmp_lt_u32 s64, 36
    s_nop 1
    s_cbranch_scc1 Lw_173
    s_nop 7
    s_branch Ls_r9
Ls_s13:
    s_nop 7
    s_nop 3
    s_mov_b32 s89, 0
    s_branch Lw_176
Lw_175:
Lw_176:
    ds_read_b128 v[20:23], v11 offset:16
    s_add_u32 s89, s89, 1
    s_cmp_gt_u32 s89, 1000000
    s_cbranch_scc1 L_end
    s_waitcnt lgkmcnt(0)
    v_min_u32 v20, v20, v21
    v_min3_u32 v20, v20, v22, v23
    s_nop 0
    v_readfirstlane_b32 s64, v20
    s_nop 0
    s_cmp_lt_u32 s64, 7
    s_nop 1
    s_cbranch_scc1 Lw_175
    s_nop 7
    s_branch Ls_r13
Ls_s32:
    s_nop 7
    s_nop 3
    s_mov_b32 s89, 0
Lxr_177:
    s_add_u32 s89, s89, 1
    s_cmp_gt_u32 s89, 100000
    s_cbranch_scc1 L_end
    buffer_load_dword v184, v7, s[44:47], s92 offen offset:2048 sc1
    buffer_load_dword v185, v19, s[44:47], s92 offen offset:2048 sc1
    buffer_load_dwordx4 v[112:115], v4, s[44:47], s92 offen offset:0 sc1
    buffer_load_dwordx4 v[116:119], v16, s[44:47], s92 offen offset:0 sc1
    buffer_load_dwordx4 v[120:123], v4, s[44:47], s92 offen offset:1024 sc1
    buffer_load_dwordx4 v[124:127], v16, s[44:47], s92 offen offset:1024 sc1
    s_waitcnt vmcnt(0)
    v_bitop3_b32 v184, v184, v112, v113 bitop3:0x96
    v_bitop3_b32 v184, v184, v114, v115 bitop3:0x96
    v_bitop3_b32 v184, v184, v120, v121 bitop3:0x96
    v_bitop3_b32 v184, v184, v122, v123 bitop3:0x96
    v_bitop3_b32 v185, v185, v116, v117 bitop3:0x96
    v_bitop3_b32 v185, v185, v118, v119 bitop3:0x96
    v_bitop3_b32 v185, v185, v124, v125 bitop3:0x96
    v_bitop3_b32 v185, v185, v126, v127 bitop3:0x96
    v_bitop3_b32 v184, v184, v185, s56 bitop3:0x7e
    v_cmp_eq_u32 vcc, 0, v184
    s_nop 0
    s_cmp_eq_u64 vcc, -1
    s_nop 1
    s_cbranch_scc0 Lxr_177
    s_nop 7
    s_branch Ls_r32
Ls_s33:
    s_nop 7
    s_nop 3
    s_mov_b32 s89, 0
Lxr_178:
    s_add_u32 s89, s89, 1
    s_cmp_gt_u32 s89, 100000
    s_cbranch_scc1 L_end
    buffer_load_dword v200, v7, s[44:47], s93 offen offset:2048 sc1
    buffer_load_dword v201, v19, s[44:47], s93 offen offset:2048 sc1
    buffer_load_dwordx4 v[128:131], v4, s[44:47], s93 offen offset:0 sc1
    buffer_load_dwordx4 v[132:135], v16, s[44:47], s93 offen offset:0 sc1
    buffer_load_dwordx4 v[136:139], v4, s[44:47], s93 offen offset:1024 sc1
    buffer_load_dwordx4 v[140:143], v16, s[44:47], s93 offen offset:1024 sc1
    s_waitcnt vmcnt(0)
    v_bitop3_b32 v200, v200, v128, v129 bitop3:0x96
    v_bitop3_b32 v200, v200, v130, v131 bitop3:0x96
    v_bitop3_b32 v200, v200, v136, v137 bitop3:0x96
    v_bitop3_b32 v200, v200, v138, v139 bitop3:0x96
    v_bitop3_b32 v201, v201, v132, v133 bitop3:0x96
    v_bitop3_b32 v201, v201, v134, v135 bitop3:0x96
    v_bitop3_b32 v201, v201, v140, v141 bitop3:0x96
    v_bitop3_b32 v201, v201, v142, v143 bitop3:0x96
    v_bitop3_b32 v200, v200, v201, s56 bitop3:0x7e
    v_cmp_eq_u32 vcc, 0, v200
    s_nop 0
    s_cmp_eq_u64 vcc, -1
    s_nop 1
    s_cbranch_scc0 Lxr_178
    s_nop 7
    s_branch Ls_r33
Ls_s34:
    s_nop 7
    s_nop 3
    s_mov_b32 s89, 0
Lxr_179:
    s_add_u32 s89, s89, 1
    s_cmp_gt_u32 s89, 100000
    s_cbranch_scc1 L_end
    buffer_load_dword v216, v7, s[44:47], s94 offen offset:2048 sc1
    buffer_load_dword v217, v19, s[44:47], s94 offen offset:2048 sc1
    buffer_load_dwordx4 v[144:147], v4, s[44:47], s94 offen offset:0 sc1
    buffer_load_dwordx4 v[148:151], v16, s[44:47], s94 offen offset:0 sc1
    buffer_load_dwordx4 v[152:155], v4, s[44:47], s94 offen offset:1024 sc1
    buffer_load_dwordx4 v[156:159], v16, s[44:47], s94 offen offset:1024 sc1
    s_waitcnt vmcnt(0)
    v_bitop3_b32 v216, v216, v144, v145 bitop3:0x96
    v_bitop3_b32 v216, v216, v146, v147 bitop3:0x96
    v_bitop3_b32 v216, v216, v152, v153 bitop3:0x96
    v_bitop3_b32 v216, v216, v154, v155 bitop3:0x96
    v_bitop3_b32 v217, v217, v148, v149 bitop3:0x96
    v_bitop3_b32 v217, v217, v150, v151 bitop3:0x96
    v_bitop3_b32 v217, v217, v156, v157 bitop3:0x96
    v_bitop3_b32 v217, v217, v158, v159 bitop3:0x96
    v_bitop3_b32 v216, v216, v217, s56 bitop3:0x7e
    v_cmp_eq_u32 vcc, 0, v216
    s_nop 0
    s_cmp_eq_u64 vcc, -1
    s_nop 1
    s_cbranch_scc0 Lxr_179
    s_nop 7
    s_branch Ls_r34
Ls_s35:
    s_nop 7
    s_nop 3
    s_mov_b32 s89, 0
Lxr_180:
    s_add_u32 s89, s89, 1
    s_cmp_gt_u32 s89, 100000
    s_cbranch_scc1 L_end
    buffer_load_dword v232, v7, s[44:47], s95 offen offset:2048 sc1
    buffer_load_dword v233, v19, s[44:47], s95 offen offset:2048 sc1
    buffer_load_dwordx4 v[160:163], v4, s[44:47], s95 offen offset:0 sc1
    buffer_load_dwordx4 v[164:167], v16, s[44:47], s95 offen offset:0 sc1
    buffer_load_dwordx4 v[168:171], v4, s[44:47], s95 offen offset:1024 sc1
    buffer_load_dwordx4 v[172:175], v16, s[44:47], s95 offen offset:1024 sc1
    s_waitcnt vmcnt(0)
    v_bitop3_b32 v232, v232, v160, v161 bitop3:0x96
    v_bitop3_b32 v232, v232, v162, v163 bitop3:0x96
    v_bitop3_b32 v232, v232, v168, v169 bitop3:0x96
    v_bitop3_b32 v232, v232, v170, v171 bitop3:0x96
    v_bitop3_b32 v233, v233, v164, v165 bitop3:0x96
    v_bitop3_b32 v233, v233, v166, v167 bitop3:0x96
    v_bitop3_b32 v233, v233, v172, v173 bitop3:0x96
    v_bitop3_b32 v233, v233, v174, v175 bitop3:0x96
    v_bitop3_b32 v232, v232, v233, s56 bitop3:0x7e
    v_cmp_eq_u32 vcc, 0, v232
    s_nop 0
    s_cmp_eq_u64 vcc, -1
    s_nop 1
    s_cbranch_scc0 Lxr_180
    s_nop 7
    s_branch Ls_r35
Ls_s36:
    s_nop 7
    s_nop 3
    s_mov_b32 s89, 0
    s_branch Lw_182
Lw_181:
    s_sleep 1
Lw_182:
    ds_read_b128 v[152:155], v11 offset:16
    s_add_u32 s89, s89, 1
    s_cmp_gt_u32 s89, 1000000
    s_cbranch_scc1 L_end
    s_waitcnt lgkmcnt(0)
    v_min_u32 v152, v152, v153
    v_min3_u32 v152, v152, v154, v155
    s_nop 0
    v_readfirstlane_b32 s64, v152
    s_nop 0
    s_cmp_lt_u32 s64, 13
    s_nop 1
    s_cbranch_scc1 Lw_181
    s_nop 7
    s_branch Ls_r36
Ls_s37:
    s_nop 7
    s_nop 3
    s_mov_b32 s89, 0
Lxr_183:
    s_add_u32 s89, s89, 1
    s_cmp_gt_u32 s89, 100000
    s_cbranch_scc1 L_end
    buffer_load_dword v248, v7, s[44:47], s96 offen offset:2048 sc1
    buffer_load_dword v249, v19, s[44:47], s96 offen offset:2048 sc1
    buffer_load_dwordx4 v[176:179], v4, s[44:47], s96 offen offset:0 sc1
    buffer_load_dwordx4 v[180:183], v16, s[44:47], s96 offen offset:0 sc1
    buffer_load_dwordx4 v[184:187], v4, s[44:47], s96 offen offset:1024 sc1
    buffer_load_dwordx4 v[188:191], v16, s[44:47], s96 offen offset:1024 sc1
    s_waitcnt vmcnt(0)
    v_bitop3_b32 v248, v248, v176, v177 bitop3:0x96
    v_bitop3_b32 v248, v248, v178, v179 bitop3:0x96
    v_bitop3_b32 v248, v248, v184, v185 bitop3:0x96
    v_bitop3_b32 v248, v248, v186, v187 bitop3:0x96
    v_bitop3_b32 v249, v249, v180, v181 bitop3:0x96
    v_bitop3_b32 v249, v249, v182, v183 bitop3:0x96
    v_bitop3_b32 v249, v249, v188, v189 bitop3:0x96
    v_bitop3_b32 v249, v249, v190, v191 bitop3:0x96
    v_bitop3_b32 v248, v248, v249, s56 bitop3:0x7e
    v_cmp_eq_u32 vcc, 0, v248
    s_nop 0
    s_cmp_eq_u64 vcc, -1
    s_nop 1
    s_cbranch_scc0 Lxr_183
    s_nop 7
    s_branch Ls_r37
Ls_s38:
    s_nop 7
    s_nop 3
    s_mov_b32 s89, 0
Lxr_184:
    s_add_u32 s89, s89, 1
    s_cmp_gt_u32 s89, 100000
    s_cbranch_scc1 L_end
    buffer_load_dword v120, v7, s[44:47], s97 offen offset:2048 sc1
    buffer_load_dword v121, v19, s[44:47], s97 offen offset:2048 sc1
    buffer_load_dwordx4 v[192:195], v4, s[44:47], s97 offen offset:0 sc1
    buffer_load_dwordx4 v[196:199], v16, s[44:47], s97 offen offset:0 sc1
    buffer_load_dwordx4 v[200:203], v4, s[44:47], s97 offen offset:1024 sc1
    buffer_load_dwordx4 v[204:207], v16, s[44:47], s97 offen offset:1024 sc1
    s_waitcnt vmcnt(0)
    v_bitop3_b32 v120, v120, v192, v193 bitop3:0x96
    v_bitop3_b32 v120, v120, v194, v195 bitop3:0x96
    v_bitop3_b32 v120, v120, v200, v201 bitop3:0x96
    v_bitop3_b32 v120, v120, v202, v203 bitop3:0x96
    v_bitop3_b32 v121, v121, v196, v197 bitop3:0x96
    v_bitop3_b32 v121, v121, v198, v199 bitop3:0x96
    v_bitop3_b32 v121, v121, v204, v205 bitop3:0x96
    v_bitop3_b32 v121, v121, v206, v207 bitop3:0x96
    v_bitop3_b32 v120, v120, v121, s56 bitop3:0x7e
    v_cmp_eq_u32 vcc, 0, v120
    s_nop 0
    s_cmp_eq_u64 vcc, -1
    s_nop 1
    s_cbranch_scc0 Lxr_184
    s_nop 7
    s_branch Ls_r38
Ls_s39:
    s_nop 7
    s_nop 3
    s_mov_b32 s89, 0
    s_branch Lw_186
Lw_185:
    s_sleep 1
Lw_186:
    ds_read_b128 v[152:155], v11 offset:16
    s_add_u32 s89, s89, 1
    s_cmp_gt_u32 s89, 1000000
    s_cbranch_scc1 L_end
    s_waitcnt lgkmcnt(0)
    v_min_u32 v152, v152, v153
    v_min3_u32 v152, v152, v154, v155
    s_nop 0
    v_readfirstlane_b32 s64, v152
    s_nop 0
    s_cmp_lt_u32 s64, 14
    s_nop 1
    s_cbranch_scc1 Lw_185
    s_nop 7
    s_branch Ls_r39
Ls_s40:
    s_nop 7
    s_nop 3
    s_mov_b32 s89, 0
Lxr_187:
    s_add_u32 s89, s89, 1
    s_cmp_gt_u32 s89, 100000
    s_cbranch_scc1 L_end
    buffer_load_dword v128, v7, s[44:47], s98 offen offset:2048 sc1
    buffer_load_dword v129, v19, s[44:47], s98 offen offset:2048 sc1
    buffer_load_dwordx4 v[208:211], v4, s[44:47], s98 offen offset:0 sc1
    buffer_load_dwordx4 v[212:215], v16, s[44:47], s98 offen offset:0 sc1
    buffer_load_dwordx4 v[216:219], v4, s[44:47], s98 offen offset:1024 sc1
    buffer_load_dwordx4 v[220:223], v16, s[44:47], s98 offen offset:1024 sc1
    s_waitcnt vmcnt(0)
    v_bitop3_b32 v128, v128, v208, v209 bitop3:0x96
    v_bitop3_b32 v128, v128, v210, v211 bitop3:0x96
    v_bitop3_b32 v128, v128, v216, v217 bitop3:0x96
    v_bitop3_b32 v128, v128, v218, v219 bitop3:0x96
    v_bitop3_b32 v129, v129, v212, v213 bitop3:0x96
    v_bitop3_b32 v129, v129, v214, v215 bitop3:0x96
    v_bitop3_b32 v129, v129, v220, v221 bitop3:0x96
    v_bitop3_b32 v129, v129, v222, v223 bitop3:0x96
    v_bitop3_b32 v128, v128, v129, s56 bitop3:0x7e
    v_cmp_eq_u32 vcc, 0, v128
    s_nop 0
    s_cmp_eq_u64 vcc, -1
    s_nop 1
    s_cbranch_scc0 Lxr_187
    s_nop 7
    s_branch Ls_r40
Ls_s41:
    s_nop 7
    s_nop 3
    s_mov_b32 s89, 0
Lxr_188:
    s_add_u32 s89, s89, 1
    s_cmp_gt_u32 s89, 100000
    s_cbranch_scc1 L_end
    buffer_load_dword v136, v7, s[44:47], s99 offen offset:2048 sc1
    buffer_load_dword v137, v19, s[44:47], s99 offen offset:2048 sc1
    buffer_load_dwordx4 v[224:227], v4, s[44:47], s99 offen offset:0 sc1
    buffer_load_dwordx4 v[228:231], v16, s[44:47], s99 offen offset:0 sc1
    buffer_load_dwordx4 v[232:235], v4, s[44:47], s99 offen offset:1024 sc1
    buffer_load_dwordx4 v[236:239], v16, s[44:47], s99 offen offset:1024 sc1
    s_waitcnt vmcnt(0)
    v_bitop3_b32 v136, v136, v224, v225 bitop3:0x96
    v_bitop3_b32 v136, v136, v226, v227 bitop3:0x96
    v_bitop3_b32 v136, v136, v232, v233 bitop3:0x96
    v_bitop3_b32 v136, v136, v234, v235 bitop3:0x96
    v_bitop3_b32 v137, v137, v228, v229 bitop3:0x96
    v_bitop3_b32 v137, v137, v230, v231 bitop3:0x96
    v_bitop3_b32 v137, v137, v236, v237 bitop3:0x96
    v_bitop3_b32 v137, v137, v238, v239 bitop3:0x96
    v_bitop3_b32 v136, v136, v137, s56 bitop3:0x7e
    v_cmp_eq_u32 vcc, 0, v136
    s_nop 0
    s_cmp_eq_u64 vcc, -1
    s_nop 1
    s_cbranch_scc0 Lxr_188
    s_nop 7
    s_branch Ls_r41
Ls_s42:
    s_nop 7
    s_nop 3
    s_mov_b32 s89, 0
    s_branch Lw_190
Lw_189:
    s_sleep 1
Lw_190:
    ds_read_b128 v[152:155], v11 offset:16
    s_add_u32 s89, s89, 1
    s_cmp_gt_u32 s89, 1000000
    s_cbranch_scc1 L_end
    s_waitcnt lgkmcnt(0)
    v_min_u32 v152, v152, v153
    v_min3_u32 v152, v152, v154, v155
    s_nop 0
    v_readfirstlane_b32 s64, v152
    s_nop 0
    s_cmp_lt_u32 s64, 15
    s_nop 1
    s_cbranch_scc1 Lw_189
    s_nop 7
    s_branch Ls_r42
Ls_s43:
    s_nop 7
    s_nop 3
    s_mov_b32 s89, 0
Lxr_191:
    s_add_u32 s89, s89, 1
    s_cmp_gt_u32 s89, 100000
    s_cbranch_scc1 L_end
    buffer_load_dword v144, v7, s[44:47], s100 offen offset:2048 sc1
    buffer_load_dword v145, v19, s[44:47], s100 offen offset:2048 sc1
    buffer_load_dwordx4 v[240:243], v4, s[44:47], s100 offen offset:0 sc1
    buffer_load_dwordx4 v[244:247], v16, s[44:47], s100 offen offset:0 sc1
    buffer_load_dwordx4 v[248:251], v4, s[44:47], s100 offen offset:1024 sc1
    buffer_load_dwordx4 v[252:255], v16, s[44:47], s100 offen offset:1024 sc1
    s_waitcnt vmcnt(0)
    v_bitop3_b32 v144, v144, v240, v241 bitop3:0x96
    v_bitop3_b32 v144, v144, v242, v243 bitop3:0x96
    v_bitop3_b32 v144, v144, v248, v249 bitop3:0x96
    v_bitop3_b32 v144, v144, v250, v251 bitop3:0x96
    v_bitop3_b32 v145, v145, v244, v245 bitop3:0x96
    v_bitop3_b32 v145, v145, v246, v247 bitop3:0x96
    v_bitop3_b32 v145, v145, v252, v253 bitop3:0x96
    v_bitop3_b32 v145, v145, v254, v255 bitop3:0x96
    v_bitop3_b32 v144, v144, v145, s56 bitop3:0x7e
    v_cmp_eq_u32 vcc, 0, v144
    s_nop 0
    s_cmp_eq_u64 vcc, -1
    s_nop 1
    s_cbranch_scc0 Lxr_191
    s_nop 7
    s_branch Ls_r43
Ls_s44:
    s_nop 7
    s_nop 3
    s_mov_b32 s89, 0
    s_branch Lw_193
Lw_192:
    s_sleep 1
Lw_193:
    ds_read_b128 v[216:219], v11 offset:16
    s_add_u32 s89, s89, 1
    s_cmp_gt_u32 s89, 1000000
    s_cbranch_scc1 L_end
    s_waitcnt lgkmcnt(0)
    v_min_u32 v216, v216, v217
    v_min3_u32 v216, v216, v218, v219
    s_nop 0
    v_readfirstlane_b32 s64, v216
    s_nop 0
    s_cmp_lt_u32 s64, 17
    s_nop 1
    s_cbranch_scc1 Lw_192
    s_nop 7
    s_branch Ls_r44
Ls_s45:
    s_nop 7
    s_nop 3
    s_mov_b32 s89, 0
    s_branch Lpoll_195
Lpoll_194:
    s_sleep 1
Lpoll_195:
    s_and_b32 s65, s89, 7
    s_cmp_eq_u32 s65, 7
    s_cselect_b32 s67, 25165824, 0
    s_add_u32 s65, s77, s67
    buffer_load_dword v12, v18, s[44:47], s65 offen sc1
    s_add_u32 s89, s89, 1
    s_cmp_gt_u32 s89, 100000
    s_cbranch_scc1 L_end
    s_waitcnt vmcnt(0)
    s_mov_b32 s65, s56
    s_mov_b32 s66, 16
    v_subrev_u32 v12, s65, v12
    v_cmp_le_u32 vcc, s66, v12
    s_nop 0
    s_and_b32 vcc_lo, vcc_lo, 85
    s_nop 1
    s_cbranch_scc1 Lpoll_194
    s_nop 7
    s_branch Ls_r45
Ls_s46:
    s_nop 7
    s_nop 3
    s_mov_b32 s89, 0
    s_branch Lpoll_198
Lpoll_197:
    s_sleep 1
Lpoll_198:
    s_and_b32 s65, s89, 7
    s_cmp_eq_u32 s65, 7
    s_cselect_b32 s67, 25165824, 0
    s_add_u32 s65, s77, s67
    buffer_load_dword v12, v18, s[44:47], s65 offen sc1
    s_add_u32 s89, s89, 1
    s_cmp_gt_u32 s89, 100000
    s_cbranch_scc1 L_end
    s_waitcnt vmcnt(0)
    s_mov_b32 s65, s56
    s_mov_b32 s66, 16
    v_subrev_u32 v12, s65, v12
    v_cmp_le_u32 vcc, s66, v12
    s_nop 0
    s_and_b32 vcc_lo, vcc_lo, 255
    s_nop 1
    s_cbranch_scc1 Lpoll_197
    s_nop 7
    s_branch Ls_r46
Ls_s47:
    s_nop 7
    s_nop 3
    s_mov_b32 s89, 0
    s_branch Lw_201
Lw_200:
    s_sleep 1
Lw_201:
    ds_read_b128 v[120:123], v11 offset:16
    s_add_u32 s89, s89, 1
    s_cmp_gt_u32 s89, 1000000
    s_cbranch_scc1 L_end
    s_waitcnt lgkmcnt(0)
    v_min_u32 v120, v120, v121
    v_min3_u32 v120, v120, v122, v123
    s_nop 0
    v_readfirstlane_b32 s64, v120
    s_nop 0
    s_cmp_lt_u32 s64, 18
    s_nop 1
    s_cbranch_scc1 Lw_200
    s_nop 7
    s_branch Ls_r47
Ls_s48:
    s_nop 7
    s_nop 3
    s_mov_b32 s89, 0
    s_branch Lw_203
Lw_202:
    s_sleep 1
Lw_203:
    ds_read_b128 v[120:123], v11 offset:16
    s_add_u32 s89, s89, 1
    s_cmp_gt_u32 s89, 1000000
    s_cbranch_scc1 L_end
    s_waitcnt lgkmcnt(0)
    v_min_u32 v120, v120, v121
    v_min3_u32 v120, v120, v122, v123
    s_nop 0
    v_readfirstlane_b32 s64, v120
    s_nop 0
    s_cmp_lt_u32 s64, 19
    s_nop 1
    s_cbranch_scc1 Lw_202
    s_nop 7
    s_branch Ls_r48
Ls_s49:
    s_nop 7
    s_nop 3
    s_mov_b32 s89, 0
    s_branch Lw_205
Lw_204:
    s_sleep 1
Lw_205:
    ds_read_b128 v[124:127], v11 offset:0
    s_add_u32 s89, s89, 1
    s_cmp_gt_u32 s89, 1000000
    s_cbranch_scc1 L_end
    s_waitcnt lgkmcnt(0)
    v_min_u32 v124, v124, v125
    v_min3_u32 v124, v124, v126, v127
    s_nop 0
    v_readfirstlane_b32 s64, v124
    s_nop 0
    s_cmp_lt_u32 s64, 17
    s_nop 1
    s_cbranch_scc1 Lw_204
    s_nop 7
    s_branch Ls_r49
Ls_s50:
    s_nop 7
    s_nop 3
    s_mov_b32 s89, 0
    s_branch Lw_207
Lw_206:
    s_sleep 1
Lw_207:
    v_xor_b32 v137, 16, v10
    ds_read_b32 v136, v137
    s_add_u32 s89, s89, 1
    s_cmp_gt_u32 s89, 1000000
    s_cbranch_scc1 L_end
    s_waitcnt lgkmcnt(0)
    v_readfirstlane_b32 s64, v136
    s_nop 0
    s_cmp_lt_u32 s64, 20
    s_nop 1
    s_cbranch_scc1 Lw_206
    s_nop 7
    s_branch Ls_r50
Ls_s51:
    s_nop 7
    s_nop 3
    s_mov_b32 s89, 0
    s_branch Lw_209
Lw_208:
    s_sleep 1
Lw_209:
    v_xor_b32 v137, 16, v10
    ds_read_b32 v136, v137
    s_add_u32 s89, s89, 1
    s_cmp_gt_u32 s89, 1000000
    s_cbranch_scc1 L_end
    s_waitcnt lgkmcnt(0)
    v_readfirstlane_b32 s64, v136
    s_nop 0
    s_cmp_lt_u32 s64, 21
    s_nop 1
    s_cbranch_scc1 Lw_208
    s_nop 7
    s_branch Ls_r51
Ls_s52:
    s_nop 7
    s_nop 3
    s_mov_b32 s89, 0
    s_branch Lw_211
Lw_210:
    s_sleep 1
Lw_211:
    v_xor_b32 v137, 16, v10
    ds_read_b32 v136, v137
    s_add_u32 s89, s89, 1
    s_cmp_gt_u32 s89, 1000000
    s_cbranch_scc1 L_end
    s_waitcnt lgkmcnt(0)
    v_readfirstlane_b32 s64, v136
    s_nop 0
    s_cmp_lt_u32 s64, 22
    s_nop 1
    s_cbranch_scc1 Lw_210
    s_nop 7
    s_branch Ls_r52
Ls_s53:
    s_nop 7
    s_nop 3
    s_mov_b32 s89, 0
    s_branch Lw_213
Lw_212:
    s_sleep 1
Lw_213:
    v_xor_b32 v137, 16, v10
    ds_read_b32 v136, v137
    s_add_u32 s89, s89, 1
    s_cmp_gt_u32 s89, 1000000
    s_cbranch_scc1 L_end
    s_waitcnt lgkmcnt(0)
    v_readfirstlane_b32 s64, v136
    s_nop 0
    s_cmp_lt_u32 s64, 23
    s_nop 1
    s_cbranch_scc1 Lw_212
    s_nop 7
    s_branch Ls_r53
Ls_s55:
    s_nop 7
    s_nop 3
    s_mov_b32 s89, 0
    s_branch Lw_215
Lw_214:
    s_sleep 1
Lw_215:
    v_xor_b32 v137, 16, v10
    ds_read_b32 v136, v137
    s_add_u32 s89, s89, 1
    s_cmp_gt_u32 s89, 1000000
    s_cbranch_scc1 L_end
    s_waitcnt lgkmcnt(0)
    v_readfirstlane_b32 s64, v136
    s_nop 0
    s_cmp_lt_u32 s64, 24
    s_nop 1
    s_cbranch_scc1 Lw_214
    s_nop 7
    s_branch Ls_r55
Ls_s56:
    s_nop 7
    s_nop 3
    s_mov_b32 s89, 0
    s_branch Lw_217
Lw_216:
    s_sleep 1
Lw_217:
    v_xor_b32 v137, 16, v10
    ds_read_b32 v136, v137
    s_add_u32 s89, s89, 1
    s_cmp_gt_u32 s89, 1000000
    s_cbranch_scc1 L_end
    s_waitcnt lgkmcnt(0)
    v_readfirstlane_b32 s64, v136
    s_nop 0
    s_cmp_lt_u32 s64, 25
    s_nop 1
    s_cbranch_scc1 Lw_216
    s_nop 7
    s_branch Ls_r56
Ls_s58:
    s_nop 7
    s_nop 3
    s_mov_b32 s89, 0
Lg_218:
    s_add_u32 s89, s89, 1
    s_cmp_gt_u32 s89, 100000
    s_cbranch_scc1 L_end
    s_sub_u32 s64, s58, 0
    s_and_b32 s64, s64, 7
    s_lshl_b32 s64, s64, 12
    s_add_u32 s64, s64, s69
    buffer_load_dwordx4 v[40:43], v4, s[44:47], s64 offen sc1
    s_waitcnt vmcnt(0)
    v_xor_b32 v12, v40, v200
    v_bitop3_b32 v12, v12, v41, v200 bitop3:0xf6
    v_bitop3_b32 v12, v12, v42, v200 bitop3:0xf6
    v_bitop3_b32 v12, v12, v43, v200 bitop3:0xf6
    v_cmp_gt_u32 vcc, 0x10000000, v12
    s_nop 0
    s_cmp_eq_u64 vcc, -1
    s_nop 1
    s_cbranch_scc0 Lg_218
    s_nop 7
    s_branch Ls_r58
Ls_s59:
    s_nop 7
    s_nop 3
    s_mov_b32 s89, 0
Lg_219:
    s_add_u32 s89, s89, 1
    s_cmp_gt_u32 s89, 100000
    s_cbranch_scc1 L_end
    s_sub_u32 s64, s58, 1
    s_and_b32 s64, s64, 7
    s_lshl_b32 s64, s64, 12
    s_add_u32 s64, s64, s69
    buffer_load_dwordx4 v[44:47], v4, s[44:47], s64 offen sc1
    s_waitcnt vmcnt(0)
    v_xor_b32 v12, v44, v200
    v_bitop3_b32 v12, v12, v45, v200 bitop3:0xf6
    v_bitop3_b32 v12, v12, v46, v200 bitop3:0xf6
    v_bitop3_b32 v12, v12, v47, v200 bitop3:0xf6
    v_cmp_gt_u32 vcc, 0x10000000, v12
    s_nop 0
    s_cmp_eq_u64 vcc, -1
    s_nop 1
    s_cbranch_scc0 Lg_219
    s_nop 7
    s_branch Ls_r59
Ls_s60:
    s_nop 7
    s_nop 3
    s_mov_b32 s89, 0
Lg_220:
    s_add_u32 s89, s89, 1
    s_cmp_gt_u32 s89, 100000
    s_cbranch_scc1 L_end
    s_sub_u32 s64, s58, 2
    s_and_b32 s64, s64, 7
    s_lshl_b32 s64, s64, 12
    s_add_u32 s64, s64, s69
    buffer_load_dwordx4 v[48:51], v4, s[44:47], s64 offen sc1
    s_waitcnt vmcnt(0)
    v_xor_b32 v12, v48, v200
    v_bitop3_b32 v12, v12, v49, v200 bitop3:0xf6
    v_bitop3_b32 v12, v12, v50, v200 bitop3:0xf6
    v_bitop3_b32 v12, v12, v51, v200 bitop3:0xf6
    v_cmp_gt_u32 vcc, 0x10000000, v12
    s_nop 0
    s_cmp_eq_u64 vcc, -1
    s_nop 1
    s_cbranch_scc0 Lg_220
    s_nop 7
    s_branch Ls_r60
Ls_s61:
    s_nop 7
    s_nop 3
    s_mov_b32 s89, 0
Lg_221:
    s_add_u32 s89, s89, 1
    s_cmp_gt_u32 s89, 100000
    s_cbranch_scc1 L_end
    s_sub_u32 s64, s58, 3
    s_and_b32 s64, s64, 7
    s_lshl_b32 s64, s64, 12
    s_add_u32 s64, s64, s69
    buffer_load_dwordx4 v[52:55], v4, s[44:47], s64 offen sc1
    s_waitcnt vmcnt(0)
    v_xor_b32 v12, v52, v200
    v_bitop3_b32 v12, v12, v53, v200 bitop3:0xf6
    v_bitop3_b32 v12, v12, v54, v200 bitop3:0xf6
    v_bitop3_b32 v12, v12, v55, v200 bitop3:0xf6
    v_cmp_gt_u32 vcc, 0x10000000, v12
    s_nop 0
    s_cmp_eq_u64 vcc, -1
    s_nop 1
    s_cbranch_scc0 Lg_221
    s_nop 7
    s_branch Ls_r61
Ls_s62:
    s_nop 7
    s_nop 3
    s_mov_b32 s89, 0
Lg_222:
    s_add_u32 s89, s89, 1
    s_cmp_gt_u32 s89, 100000
    s_cbranch_scc1 L_end
    s_sub_u32 s64, s58, 4
    s_and_b32 s64, s64, 7
    s_lshl_b32 s64, s64, 12
    s_add_u32 s64, s64, s69
    buffer_load_dwordx4 v[56:59], v4, s[44:47], s64 offen sc1
    s_waitcnt vmcnt(0)
    v_xor_b32 v12, v56, v200
    v_bitop3_b32 v12, v12, v57, v200 bitop3:0xf6
    v_bitop3_b32 v12, v12, v58, v200 bitop3:0xf6
    v_bitop3_b32 v12, v12, v59, v200 bitop3:0xf6
    v_cmp_gt_u32 vcc, 0x10000000, v12
    s_nop 0
    s_cmp_eq_u64 vcc, -1
    s_nop 1
    s_cbranch_scc0 Lg_222
    s_nop 7
    s_branch Ls_r62
Ls_s63:
    s_nop 7
    s_nop 3
    s_mov_b32 s89, 0
Lg_223:
    s_add_u32 s89, s89, 1
    s_cmp_gt_u32 s89, 100000
    s_cbranch_scc1 L_end
    s_sub_u32 s64, s58, 5
    s_and_b32 s64, s64, 7
    s_lshl_b32 s64, s64, 12
    s_add_u32 s64, s64, s69
    buffer_load_dwordx4 v[60:63], v4, s[44:47], s64 offen sc1
    s_waitcnt vmcnt(0)
    v_xor_b32 v12, v60, v200
    v_bitop3_b32 v12, v12, v61, v200 bitop3:0xf6
    v_bitop3_b32 v12, v12, v62, v200 bitop3:0xf6
    v_bitop3_b32 v12, v12, v63, v200 bitop3:0xf6
    v_cmp_gt_u32 vcc, 0x10000000, v12
    s_nop 0
    s_cmp_eq_u64 vcc, -1
    s_nop 1
    s_cbranch_scc0 Lg_223
    s_nop 7
    s_branch Ls_r63
Ls_s64:
    s_nop 7
    s_nop 3
    s_mov_b32 s89, 0
Lg_224:
    s_add_u32 s89, s89, 1
    s_cmp_gt_u32 s89, 100000
    s_cbranch_scc1 L_end
    s_sub_u32 s64, s58, 6
    s_and_b32 s64, s64, 7
    s_lshl_b32 s64, s64, 12
    s_add_u32 s64, s64, s69
    buffer_load_dwordx4 v[64:67], v4, s[44:47], s64 offen sc1
    s_waitcnt vmcnt(0)
    v_xor_b32 v12, v64, v200
    v_bitop3_b32 v12, v12, v65, v200 bitop3:0xf6
    v_bitop3_b32 v12, v12, v66, v200 bitop3:0xf6
    v_bitop3_b32 v12, v12, v67, v200 bitop3:0xf6
    v_cmp_gt_u32 vcc, 0x10000000, v12
    s_nop 0
    s_cmp_eq_u64 vcc, -1
    s_nop 1
    s_cbranch_scc0 Lg_224
    s_nop 7
    s_branch Ls_r64
Ls_s65:
    s_nop 7
    s_nop 3
    s_mov_b32 s89, 0
Lg_225:
    s_add_u32 s89, s89, 1
    s_cmp_gt_u32 s89, 100000
    s_cbranch_scc1 L_end
    s_sub_u32 s64, s58, 7
    s_and_b32 s64, s64, 7
    s_lshl_b32 s64, s64, 12
    s_add_u32 s64, s64, s69
    buffer_load_dwordx4 v[68:71], v4, s[44:47], s64 offen sc1
    s_waitcnt vmcnt(0)
    v_xor_b32 v12, v68, v200
    v_bitop3_b32 v12, v12, v69, v200 bitop3:0xf6
    v_bitop3_b32 v12, v12, v70, v200 bitop3:0xf6
    v_bitop3_b32 v12, v12, v71, v200 bitop3:0xf6
    v_cmp_gt_u32 vcc, 0x10000000, v12
    s_nop 0
    s_cmp_eq_u64 vcc, -1
    s_nop 1
    s_cbranch_scc0 Lg_225
    s_nop 7
    s_branch Ls_r65
Ls_s152:
    s_nop 7
    s_nop 3
    s_mov_b32 s89, 0
Lg_226:
    s_add_u32 s89, s89, 1
    s_cmp_gt_u32 s89, 100000
    s_cbranch_scc1 L_end
    s_sub_u32 s64, s58, 1
    s_and_b32 s64, s64, 7
    s_lshl_b32 s64, s64, 12
    s_add_u32 s64, s64, s68
    buffer_load_dwordx4 v[132:135], v4, s[44:47], s64 offen sc1
    s_waitcnt vmcnt(0)
    v_xor_b32 v12, v132, v19
    v_bitop3_b32 v12, v12, v133, v19 bitop3:0xf6
    v_bitop3_b32 v12, v12, v134, v19 bitop3:0xf6
    v_bitop3_b32 v12, v12, v135, v19 bitop3:0xf6
    v_cmp_gt_u32 vcc, 0x10000000, v12
    s_nop 0
    s_cmp_eq_u64 vcc, -1
    s_nop 1
    s_cbranch_scc0 Lg_226
    s_nop 7
    s_branch Ls_r152
Ls_s153:
    s_nop 7
    s_nop 3
    s_mov_b32 s89, 0
Lg_227:
    s_add_u32 s89, s89, 1
    s_cmp_gt_u32 s89, 100000
    s_cbranch_scc1 L_end
    s_sub_u32 s64, s58, 2
    s_and_b32 s64, s64, 7
    s_lshl_b32 s64, s64, 12
    s_add_u32 s64, s64, s68
    buffer_load_dwordx4 v[136:139], v4, s[44:47], s64 offen sc1
    s_waitcnt vmcnt(0)
    v_xor_b32 v12, v136, v19
    v_bitop3_b32 v12, v12, v137, v19 bitop3:0xf6
    v_bitop3_b32 v12, v12, v138, v19 bitop3:0xf6
    v_bitop3_b32 v12, v12, v139, v19 bitop3:0xf6
    v_cmp_gt_u32 vcc, 0x10000000, v12
    s_nop 0
    s_cmp_eq_u64 vcc, -1
    s_nop 1
    s_cbranch_scc0 Lg_227
    s_nop 7
    s_branch Ls_r153
Ls_s154:
    s_nop 7
    s_nop 3
    s_mov_b32 s89, 0
Lg_228:
    s_add_u32 s89, s89, 1
    s_cmp_gt_u32 s89, 100000
    s_cbranch_scc1 L_end
    s_sub_u32 s64, s58, 3
    s_and_b32 s64, s64, 7
    s_lshl_b32 s64, s64, 12
    s_add_u32 s64, s64, s68
    buffer_load_dwordx4 v[140:143], v4, s[44:47], s64 offen sc1
    s_waitcnt vmcnt(0)
    v_xor_b32 v12, v140, v19
    v_bitop3_b32 v12, v12, v141, v19 bitop3:0xf6
    v_bitop3_b32 v12, v12, v142, v19 bitop3:0xf6
    v_bitop3_b32 v12, v12, v143, v19 bitop3:0xf6
    v_cmp_gt_u32 vcc, 0x10000000, v12
    s_nop 0
    s_cmp_eq_u64 vcc, -1
    s_nop 1
    s_cbranch_scc0 Lg_228
    s_nop 7
    s_branch Ls_r154
Ls_s155:
    s_nop 7
    s_nop 3
    s_mov_b32 s89, 0
Lg_229:
    s_add_u32 s89, s89, 1
    s_cmp_gt_u32 s89, 100000
    s_cbranch_scc1 L_end
    s_sub_u32 s64, s58, 4
    s_and_b32 s64, s64, 7
    s_lshl_b32 s64, s64, 12
    s_add_u32 s64, s64, s68
    buffer_load_dwordx4 v[144:147], v4, s[44:47], s64 offen sc1
    s_waitcnt vmcnt(0)
    v_xor_b32 v12, v144, v19
    v_bitop3_b32 v12, v12, v145, v19 bitop3:0xf6
    v_bitop3_b32 v12, v12, v146, v19 bitop3:0xf6
    v_bitop3_b32 v12, v12, v147, v19 bitop3:0xf6
    v_cmp_gt_u32 vcc, 0x10000000, v12
    s_nop 0
    s_cmp_eq_u64 vcc, -1
    s_nop 1
    s_cbranch_scc0 Lg_229
    s_nop 7
    s_branch Ls_r155
Ls_s158:
    s_nop 7
    s_nop 3
    s_mov_b32 s89, 0
Lg_230:
    s_add_u32 s89, s89, 1
    s_cmp_gt_u32 s89, 100000
    s_cbranch_scc1 L_end
    s_sub_u32 s64, s58, 5
    s_and_b32 s64, s64, 7
    s_lshl_b32 s64, s64, 12
    s_add_u32 s64, s64, s68
    buffer_load_dwordx4 v[148:151], v4, s[44:47], s64 offen sc1
    s_waitcnt vmcnt(0)
    v_xor_b32 v12, v148, v19
    v_bitop3_b32 v12, v12, v149, v19 bitop3:0xf6
    v_bitop3_b32 v12, v12, v150, v19 bitop3:0xf6
    v_bitop3_b32 v12, v12, v151, v19 bitop3:0xf6
    v_cmp_gt_u32 vcc, 0x10000000, v12
    s_nop 0
    s_cmp_eq_u64 vcc, -1
    s_nop 1
    s_cbranch_scc0 Lg_230
    s_nop 7
    s_branch Ls_r158
Ls_s159:
    s_nop 7
    s_nop 3
    s_mov_b32 s89, 0
Lg_231:
    s_add_u32 s89, s89, 1
    s_cmp_gt_u32 s89, 100000
    s_cbranch_scc1 L_end
    s_sub_u32 s64, s58, 6
    s_and_b32 s64, s64, 7
    s_lshl_b32 s64, s64, 12
    s_add_u32 s64, s64, s68
    buffer_load_dwordx4 v[152:155], v4, s[44:47], s64 offen sc1
    s_waitcnt vmcnt(0)
    v_xor_b32 v12, v152, v19
    v_bitop3_b32 v12, v12, v153, v19 bitop3:0xf6
    v_bitop3_b32 v12, v12, v154, v19 bitop3:0xf6
    v_bitop3_b32 v12, v12, v155, v19 bitop3:0xf6
    v_cmp_gt_u32 vcc, 0x10000000, v12
    s_nop 0
    s_cmp_eq_u64 vcc, -1
    s_nop 1
    s_cbranch_scc0 Lg_231
    s_nop 7
    s_branch Ls_r159
Ls_s160:
    s_nop 7
    s_nop 3
    s_mov_b32 s89, 0
Lg_232:
    s_add_u32 s89, s89, 1
    s_cmp_gt_u32 s89, 100000
    s_cbranch_scc1 L_end
    s_sub_u32 s64, s58, 7
    s_and_b32 s64, s64, 7
    s_lshl_b32 s64, s64, 12
    s_add_u32 s64, s64, s68
    buffer_load_dwordx4 v[156:159], v4, s[44:47], s64 offen sc1
    s_waitcnt vmcnt(0)
    v_xor_b32 v12, v156, v19
    v_bitop3_b32 v12, v12, v157, v19 bitop3:0xf6
    v_bitop3_b32 v12, v12, v158, v19 bitop3:0xf6
    v_bitop3_b32 v12, v12, v159, v19 bitop3:0xf6
    v_cmp_gt_u32 vcc, 0x10000000, v12
    s_nop 0
    s_cmp_eq_u64 vcc, -1
    s_nop 1
    s_cbranch_scc0 Lg_232
    s_nop 7
    s_branch Ls_r160
.p2align 7
.type L_tab,@object
L_tab:
.long 0, 1, 2, 3, 4, 5, 6, 7
.long 8, 9, 10, 11, 12, 13, 14, 15
.long 16, 17, 18, 19, 20, 21, 22, 23
.long 24, 25, 26, 27, 28, 29, 30, 31
.long 32, 33, 34, 35, 36, 37, 38, 39
.long 40, 41, 42, 43, 44, 45, 46, 47
.long 48, 49, 50, 51, 52, 53, 54, 55
.long 56, 57, 58, 59, 60, 61, 62, 63
L_code_end:
.section .rodata,"a"
.p2align 6
.amdhsa_kernel standalone__mixer_s_mlp__sampling_kernel
  .amdhsa_next_free_vgpr 256
  .amdhsa_next_free_sgpr 102
  .amdhsa_accum_offset 256
  .amdhsa_group_segment_fixed_size 0
  .amdhsa_kernarg_size 64
  .amdhsa_user_sgpr_count 2
  .amdhsa_user_sgpr_kernarg_segment_ptr 1
  .amdhsa_system_sgpr_workgroup_id_x 1
  .amdhsa_float_denorm_mode_32 3
.end_amdhsa_kernel
```
